```python
import torch

def _softmax(x, axis=-1):
    return torch.softmax(x, dim=axis)
def _gelu(x):
    return torch.nn.functional.gelu(x, approximate="tanh")
def _silu(x):
    return torch.nn.functional.silu(x)
def _sigmoid(x):
    return torch.sigmoid(x)
def _layernorm(x, axis=-1, eps=1e-5):
    m = x.mean(dim=axis, keepdim=True)
    v = x.var(dim=axis, keepdim=True, unbiased=False)
    return (x - m) / torch.sqrt(v + eps)
def _scatter_add(tgt, idx, src, axis=0):
    return tgt.clone().index_add_(axis, idx, src)
def _segment_sum(src, seg, n):
    out = torch.zeros((n,) + src.shape[1:], dtype=src.dtype)
    return out.index_add_(0, seg, src)
def _pad(x, pw):
    flat = tuple(v for pair in reversed(pw) for v in pair)
    return torch.nn.functional.pad(x, flat)

kernel_name = 'gated_mix__linear_attn_block__ssm_conv_s4d__prompt'

def setup_inputs():

    _w = (lambda a: (lambda t: t.to(torch.bfloat16) if t.is_floating_point() else t)(torch.as_tensor(a)))
    def _A_setup():
        B, S, D = 1, 2048, 640
        return {
            "x": _w((lambda *s: torch.randn(*s, dtype=torch.bfloat16) * 0.05)(B, S, D)),
            "wqkv": _w((lambda *s: torch.randn(*s, dtype=torch.bfloat16) * 0.8)(D, 3 * D)),
            "wo": _w((lambda *s: torch.randn(*s, dtype=torch.bfloat16) * 0.05)(D, D)),
        }
    _A_in = _A_setup()

    def _B_setup():
        Bsz, L, D, N = 1, 2048, 640, 128
        return {
            "u": _w((lambda *s: torch.randn(*s, dtype=torch.bfloat16) * 0.05)(Bsz, L, D)),
            "log_A_real": _w((lambda *s: torch.randn(*s, dtype=torch.bfloat16) * 6.4)(D, N) * 0.5),
            "A_imag": _w((lambda *s: torch.randn(*s, dtype=torch.bfloat16) * 0.1)(D, N) * 3.14),
            "C_real": _w((lambda *s: torch.randn(*s, dtype=torch.bfloat16) * 0.2)(D, N) / N ** 0.5),
            "C_imag": _w((lambda *s: torch.randn(*s, dtype=torch.bfloat16) * 0.2)(D, N) / N ** 0.5),
            "log_dt": _w((lambda *s: torch.randn(*s, dtype=torch.bfloat16) * 0.1)(D) * 0.5 - 4.0),
            "D_skip": _w((lambda *s: torch.randn(*s, dtype=torch.bfloat16) * 0.1)(D)),
        }
    _B_in = _B_setup()

    return {
        "A_x": _A_in["x"],
        "A_wqkv": _A_in["wqkv"],
        "A_wo": _A_in["wo"],
        "B_u": _B_in["u"],
        "B_log_A_real": _B_in["log_A_real"],
        "B_A_imag": _B_in["A_imag"],
        "B_C_real": _B_in["C_real"],
        "B_C_imag": _B_in["C_imag"],
        "B_log_dt": _B_in["log_dt"],
        "B_D_skip": _B_in["D_skip"],
        "gate_w": _w((lambda *s: torch.randn(*s, dtype=torch.bfloat16) * 0.05)(640) * 16.0),
    }

def reference(A_x, A_wqkv, A_wo, B_u, B_log_A_real, B_A_imag, B_C_real, B_C_imag, B_log_dt, B_D_skip, gate_w):
    def _A_ref(x, wqkv, wo):
        B, S, D = x.shape
        H = 32; Dh = D // H
        qkv = (lambda x, *d: x.permute(*d))((x @ wqkv).reshape(B, S, 3, H, Dh), 2, 0, 3, 1, 4)
        q, k, v = qkv[0], qkv[1], qkv[2]
        phi = lambda t: torch.where(t > 0, t + 1, torch.exp(t)) + 1e-6
        pq, pk = phi(q), phi(k)
        kv = torch.einsum("bhsd,bhse->bhde", pk, v)
        z = torch.einsum("bhsd->bhd", pk)
        num = torch.einsum("bhqd,bhde->bhqe", pq, kv)
        den = torch.einsum("bhqd,bhd->bhq", pq, z)[..., None] + 1e-6
        o = num / den
        return (lambda x, *d: x.permute(*d))(o, 0, 2, 1, 3).reshape(B, S, D) @ wo

    def _B_ref(u, log_A_real, A_imag, C_real, C_imag, log_dt, D_skip):
        L = u.shape[1]
        dt = torch.exp(log_dt)
        A = -torch.exp(log_A_real) + 1j * A_imag
        C = (C_real + 1j * C_imag) * dt[:, None]
        pos = (lambda x, dt: x.to(dt))(torch.arange(L), log_dt.dtype)
        P = torch.exp((A * dt[:, None])[:, :, None] * pos[None, None, :])
        K = 2.0 * torch.einsum("dn,dnl->dl", C, P).real
        L2 = 2 * L
        u_t = (lambda x, *d: x.permute(*d))(u, 0, 2, 1)
        Kf = (lambda x, *a, **k: torch.fft.rfft(x.float(), *a, **k))(K, L2)
        Uf = (lambda x, *a, **k: torch.fft.rfft(x.float(), *a, **k))(u_t, L2)
        y = (lambda x, *a, **k: torch.fft.irfft(x, *a, **k).to(torch.bfloat16))(Uf * Kf[None, :, :], L2)[:, :, :L]
        y = (lambda x, *d: x.permute(*d))(y, 0, 2, 1)
        return y + u * D_skip[None, None, :]

    x = A_x
    g = _sigmoid((x * gate_w).sum(-1, keepdims=True))
    a = _A_ref(x, A_wqkv, A_wo)
    b = _B_ref(x, B_log_A_real, B_A_imag, B_C_real, B_C_imag, B_log_dt, B_D_skip)
    return g * a + (1 - g) * b
```

```asm
; @launch grid=(256,1,1) block=(512,1,1) lds=163840
.amdgcn_target "amdgcn-amd-amdhsa--gfx950"
.text
.globl gated_mix__linear_attn_block__ssm_conv_s4d__prompt_kernel
.p2align 8
.type gated_mix__linear_attn_block__ssm_conv_s4d__prompt_kernel,@function
gated_mix__linear_attn_block__ssm_conv_s4d__prompt_kernel:
    s_cmp_ge_u32 s2, 256
    s_cbranch_scc1 L_exit
    s_load_dwordx4 s[4:7], s[0:1], 0
    s_load_dwordx8 s[24:31], s[0:1], 80
    s_load_dwordx2 s[8:9], s[0:1], 16
    s_load_dwordx8 s[12:19], s[0:1], 32
    s_load_dwordx4 s[20:23], s[0:1], 64
    v_lshrrev_b32 v1, 6, v0
    v_and_b32 v0, 63, v0
    s_and_b32 s57, s2, 7
    v_readfirstlane_b32 s56, v1
    s_lshr_b32 s58, s2, 3
    s_cmp_lt_u32 s58, 16
    s_cbranch_scc1 L_nocode
    s_cmp_lt_u32 s58, 26
    s_cbranch_scc1 L_conv
    s_cmp_lg_u32 s56, 0
    s_cbranch_scc1 L_spare
    s_getpc_b64 s[64:65]
L_pc:
    s_lshl_b32 s63, s58, 13
    v_lshlrev_b32 v10, 7, v0
    s_sub_u32 s63, s63, 212992
    s_sub_u32 s64, s64, L_pc-gated_mix__linear_attn_block__ssm_conv_s4d__prompt_kernel
    v_add_u32 v10, s63, v10
    s_subb_u32 s65, s65, 0
    v_min_u32 v10, L_exit-gated_mix__linear_attn_block__ssm_conv_s4d__prompt_kernel, v10
    v_mov_b32 v11, s65
    v_add_co_u32 v10, vcc, s64, v10
    v_addc_co_u32 v11, vcc, 0, v11, vcc
    global_load_dword v4, v[10:11], off
    s_branch L_spare
L_nocode:
    s_lshr_b32 s61, s57, 1
    s_lshl_b32 s61, s61, 2
    s_and_b32 s63, s58, 3
    s_add_u32 s61, s61, s63
    s_and_b32 s62, s57, 1
    s_lshl_b32 s62, s62, 2
    s_lshr_b32 s63, s58, 2
    s_add_u32 s62, s62, s63
    s_mov_b32 s10, 1069066811
    s_mov_b32 s11, 897988541
    s_cmp_lt_u32 s56, 4
    s_cbranch_scc1 L_compute
    s_setprio 3
    s_sub_u32 s68, s56, 4
    v_lshrrev_b32 v16, 4, v0
    v_lshrrev_b32 v17, 3, v0
    v_bitop3_b32 v16, v16, v0, 7 bitop3:0x78
    s_lshl_b32 s63, s61, 2
    v_mul_u32_u24 v17, 1280, v17
    s_add_u32 s63, s63, s68
    v_lshl_add_u32 v2, v16, 4, v17
    s_mul_i32 s59, s63, 40960
    v_xor_b32 v3, 64, v2
    s_lshl_b32 s64, s68, 12
    v_add_u32 v4, 20480, v2
    v_add_u32 v5, 30720, v3
    v_add_u32 v3, 10240, v3
    s_mov_b32 m0, s64
    s_mov_b32 s34, 2621440
    s_mov_b32 s35, 0x20000
    s_mov_b32 s38, 2457600
    s_mov_b32 s39, 0x20000
    s_waitcnt lgkmcnt(0)
    s_mov_b64 s[32:33], s[4:5]
    buffer_load_dwordx4 v2, s[32:35], s59 offen lds
    s_add_u32 m0, s64, 1024
    s_nop 0
    buffer_load_dwordx4 v3, s[32:35], s59 offen lds
    s_add_u32 m0, s64, 2048
    s_nop 0
    buffer_load_dwordx4 v4, s[32:35], s59 offen lds
    s_add_u32 m0, s64, 3072
    s_nop 0
    buffer_load_dwordx4 v5, s[32:35], s59 offen lds
    s_mov_b64 s[36:37], s[6:7]
    s_lshr_b32 s69, s68, 1
    s_and_b32 s63, s68, 1
    v_mul_u32_u24 v16, 6554, v0
    s_mul_i32 s3, s62, 160
    s_mul_i32 s67, s63, 122880
    v_lshlrev_b32 v17, 4, v0
    s_mul_i32 s66, s69, 1280
    s_add_u32 s3, s3, s67
    s_mul_i32 s65, s69, 10256
    s_mul_i32 s63, s63, 5120
    s_add_u32 s66, s66, s3
    s_add_u32 s65, s65, s63
    s_add_u32 s66, s66, 1280
    s_movk_i32 s4, 3840
    s_movk_i32 s5, -160
    v_lshrrev_b32 v18, 16, v16
    v_lshrrev_b32 v19, 17, v16
    s_add_u32 m0, s65, 16384
    v_mad_i32_i24 v20, v18, s5, v17
    v_bitop3_b32 v18, v18, v19, 4 bitop3:0x78
    v_mad_u32_u24 v6, v18, s4, v20
    v_add_u32 v16, 419456, v16
    v_add_u32 v17, 1024, v17
    buffer_load_dwordx4 v6, s[36:39], s66 offen lds
    v_lshrrev_b32 v18, 16, v16
    v_lshrrev_b32 v19, 17, v16
    s_add_u32 m0, s65, 17408
    v_mad_i32_i24 v20, v18, s5, v17
    v_bitop3_b32 v18, v18, v19, 4 bitop3:0x78
    v_mad_u32_u24 v7, v18, s4, v20
    v_add_u32 v16, 419456, v16
    v_add_u32 v17, 1024, v17
    buffer_load_dwordx4 v7, s[36:39], s66 offen lds
    v_lshrrev_b32 v18, 16, v16
    v_lshrrev_b32 v19, 17, v16
    s_add_u32 m0, s65, 18432
    v_mad_i32_i24 v20, v18, s5, v17
    v_bitop3_b32 v18, v18, v19, 4 bitop3:0x78
    v_mad_u32_u24 v8, v18, s4, v20
    v_add_u32 v16, 419456, v16
    v_add_u32 v17, 1024, v17
    buffer_load_dwordx4 v8, s[36:39], s66 offen lds
    v_lshrrev_b32 v18, 16, v16
    v_lshrrev_b32 v19, 17, v16
    s_add_u32 m0, s65, 19456
    v_mad_i32_i24 v20, v18, s5, v17
    v_bitop3_b32 v18, v18, v19, 4 bitop3:0x78
    v_mad_u32_u24 v9, v18, s4, v20
    v_add_u32 v16, 419456, v16
    v_add_u32 v17, 1024, v17
    buffer_load_dwordx4 v9, s[36:39], s66 offen lds
    v_lshrrev_b32 v18, 16, v16
    v_lshrrev_b32 v19, 17, v16
    s_add_u32 m0, s65, 20480
    v_mad_i32_i24 v20, v18, s5, v17
    v_bitop3_b32 v18, v18, v19, 4 bitop3:0x78
    v_mad_u32_u24 v10, v18, s4, v20
    buffer_load_dwordx4 v10, s[36:39], s66 offen lds
    s_add_u32 s66, s66, 245760
    s_mul_i32 s67, s69, 245760
    s_add_u32 s3, s3, s67
    s_mul_i32 s67, s69, 10240
    s_add_u32 s67, s67, s63
    s_mov_b64 s[44:45], s[30:31]
    v_mov_b32 v1, 0
    s_mov_b32 s46, 268435456
    s_mov_b32 s47, 0x20000
    s_add_u32 s63, s59, 128
    s_add_u32 m0, s64, 36880
    s_nop 0
    buffer_load_dwordx4 v2, s[32:35], s63 offen lds
    s_add_u32 m0, s64, 37904
    s_nop 0
    buffer_load_dwordx4 v3, s[32:35], s63 offen lds
    s_add_u32 m0, s64, 38928
    s_nop 0
    buffer_load_dwordx4 v4, s[32:35], s63 offen lds
    s_add_u32 m0, s64, 39952
    s_nop 0
    buffer_load_dwordx4 v5, s[32:35], s63 offen lds
    s_add_u32 m0, s65, 53264
    s_nop 0
    buffer_load_dwordx4 v6, s[36:39], s66 offen lds
    s_add_u32 m0, s65, 54288
    s_nop 0
    buffer_load_dwordx4 v7, s[36:39], s66 offen lds
    s_add_u32 m0, s65, 55312
    s_nop 0
    buffer_load_dwordx4 v8, s[36:39], s66 offen lds
    s_add_u32 m0, s65, 56336
    s_nop 0
    buffer_load_dwordx4 v9, s[36:39], s66 offen lds
    s_add_u32 m0, s65, 57360
    s_nop 0
    buffer_load_dwordx4 v10, s[36:39], s66 offen lds
    s_add_u32 s66, s66, 245760
    s_setprio 0
    v_and_b32 v16, 15, v0
    v_ashrrev_i32 v17, 4, v0
    v_mov_b32 v35, s68
    v_lshlrev_b32 v35, 5, v35
    v_add_u32 v35, v35, v16
    v_lshlrev_b32 v35, 7, v35
    v_add_u32 v34, 0, v17
    v_ashrrev_i32 v33, 1, v16
    v_xor_b32 v33, v34, v33
    v_lshlrev_b32 v33, 4, v33
    v_add_u32 v11, v35, v33
    v_add_u32 v13, 73760, v11
    v_mov_b32 v33, s68
    v_lshlrev_b32 v33, 5, v33
    v_add_u32 v33, v33, v16
    v_lshlrev_b32 v33, 7, v33
    v_add_u32 v35, 4, v17
    v_ashrrev_i32 v34, 1, v16
    v_xor_b32 v34, v35, v34
    v_lshlrev_b32 v34, 4, v34
    v_add_u32 v12, v33, v34
    v_add_u32 v14, 73760, v12
    v_lshlrev_b32 v34, 3, v17
    v_and_b32 v33, 1, v17
    v_xor_b32 v33, 0, v33
    v_lshlrev_b32 v33, 2, v33
    v_add_u32 v33, v34, v33
    v_ashrrev_i32 v34, 2, v16
    v_add_u32 v34, v33, v34
    v_mul_u32_u24 v34, 160, v34
    v_add_u32 v18, 73760, v34
    v_and_b32 v34, 3, v16
    v_lshlrev_b32 v34, 3, v34
    v_add_u32 v56, v18, v34
    v_add_u32 v34, 32, v18
    v_and_b32 v33, 3, v16
    v_mul_u32_u24 v33, 40, v33
    v_add_u32 v58, v34, v33
    v_lshlrev_b32 v33, 3, v17
    v_and_b32 v34, 1, v17
    v_xor_b32 v34, 1, v34
    v_lshlrev_b32 v34, 2, v34
    v_add_u32 v34, v33, v34
    v_ashrrev_i32 v33, 2, v16
    v_add_u32 v33, v34, v33
    v_mul_u32_u24 v33, 160, v33
    v_add_u32 v18, 73760, v33
    v_and_b32 v33, 3, v16
    v_lshlrev_b32 v33, 3, v33
    v_add_u32 v57, v18, v33
    v_add_u32 v33, 32, v18
    v_and_b32 v34, 3, v16
    v_mul_u32_u24 v34, 40, v34
    v_add_u32 v59, v33, v34
    s_waitcnt vmcnt(9) lgkmcnt(0)
    s_barrier
    ds_read_b128 v[96:99], v11 offset:0
    ds_read_b128 v[100:103], v11 offset:2048
    ds_read_b128 v[104:107], v12 offset:0
    ds_read_b128 v[108:111], v12 offset:2048
    s_add_u32 s63, s59, 256
    s_add_u32 m0, s64, 73760
    s_nop 0
    buffer_load_dwordx4 v2, s[32:35], s63 offen lds
    s_add_u32 m0, s64, 74784
    s_nop 0
    buffer_load_dwordx4 v3, s[32:35], s63 offen lds
    s_add_u32 m0, s64, 75808
    s_nop 0
    buffer_load_dwordx4 v4, s[32:35], s63 offen lds
    s_add_u32 m0, s64, 76832
    s_nop 0
    buffer_load_dwordx4 v5, s[32:35], s63 offen lds
    s_add_u32 m0, s65, 90144
    s_nop 0
    buffer_load_dwordx4 v6, s[36:39], s66 offen lds
    s_add_u32 m0, s65, 91168
    s_nop 0
    buffer_load_dwordx4 v7, s[36:39], s66 offen lds
    s_add_u32 m0, s65, 92192
    s_nop 0
    buffer_load_dwordx4 v8, s[36:39], s66 offen lds
    s_add_u32 m0, s65, 93216
    s_nop 0
    buffer_load_dwordx4 v9, s[36:39], s66 offen lds
    s_add_u32 m0, s65, 94240
    s_nop 0
    buffer_load_dwordx4 v10, s[36:39], s66 offen lds
    s_add_u32 s66, s66, 245760
    s_waitcnt vmcnt(9) lgkmcnt(0)
    s_barrier
    ds_read_b128 v[112:115], v11 offset:36880
    ds_read_b128 v[116:119], v11 offset:38928
    ds_read_b128 v[120:123], v12 offset:36880
    ds_read_b128 v[124:127], v12 offset:38928
    s_add_u32 s63, s59, 384
    s_add_u32 m0, s64, 110640
    s_nop 0
    buffer_load_dwordx4 v2, s[32:35], s63 offen lds
    s_add_u32 m0, s64, 111664
    s_nop 0
    buffer_load_dwordx4 v3, s[32:35], s63 offen lds
    s_add_u32 m0, s64, 112688
    s_nop 0
    buffer_load_dwordx4 v4, s[32:35], s63 offen lds
    s_add_u32 m0, s64, 113712
    s_nop 0
    buffer_load_dwordx4 v5, s[32:35], s63 offen lds
    s_add_u32 m0, s65, 127024
    s_nop 0
    buffer_load_dwordx4 v6, s[36:39], s66 offen lds
    s_add_u32 m0, s65, 128048
    s_nop 0
    buffer_load_dwordx4 v7, s[36:39], s66 offen lds
    s_add_u32 m0, s65, 129072
    s_nop 0
    buffer_load_dwordx4 v8, s[36:39], s66 offen lds
    s_add_u32 m0, s65, 130096
    s_nop 0
    buffer_load_dwordx4 v9, s[36:39], s66 offen lds
    s_add_u32 m0, s65, 131120
    s_nop 0
    buffer_load_dwordx4 v10, s[36:39], s66 offen lds
    s_add_u32 s66, s66, 245760
    s_waitcnt vmcnt(9) lgkmcnt(0)
    s_barrier
    ds_read_b128 v[128:131], v13 offset:0
    ds_read_b128 v[132:135], v13 offset:2048
    ds_read_b128 v[136:139], v14 offset:0
    ds_read_b128 v[140:143], v14 offset:2048
    s_add_u32 s63, s59, 512
    s_add_u32 m0, s64, 0
    s_nop 0
    buffer_load_dwordx4 v2, s[32:35], s63 offen lds
    s_add_u32 m0, s64, 1024
    s_nop 0
    buffer_load_dwordx4 v3, s[32:35], s63 offen lds
    s_add_u32 m0, s64, 2048
    s_nop 0
    buffer_load_dwordx4 v4, s[32:35], s63 offen lds
    s_add_u32 m0, s64, 3072
    s_nop 0
    buffer_load_dwordx4 v5, s[32:35], s63 offen lds
    s_add_u32 m0, s65, 16384
    s_nop 0
    buffer_load_dwordx4 v6, s[36:39], s66 offen lds
    s_add_u32 m0, s65, 17408
    s_nop 0
    buffer_load_dwordx4 v7, s[36:39], s66 offen lds
    s_add_u32 m0, s65, 18432
    s_nop 0
    buffer_load_dwordx4 v8, s[36:39], s66 offen lds
    s_add_u32 m0, s65, 19456
    s_nop 0
    buffer_load_dwordx4 v9, s[36:39], s66 offen lds
    s_add_u32 m0, s65, 20480
    s_nop 0
    buffer_load_dwordx4 v10, s[36:39], s66 offen lds
    s_add_u32 s66, s66, 245760
    s_waitcnt vmcnt(9) lgkmcnt(0)
    s_barrier
    ds_read_b128 v[144:147], v13 offset:36880
    ds_read_b128 v[148:151], v13 offset:38928
    ds_read_b128 v[152:155], v14 offset:36880
    ds_read_b128 v[156:159], v14 offset:38928
    s_add_u32 s63, s59, 640
    s_add_u32 m0, s64, 36880
    s_nop 0
    buffer_load_dwordx4 v2, s[32:35], s63 offen lds
    s_add_u32 m0, s64, 37904
    s_nop 0
    buffer_load_dwordx4 v3, s[32:35], s63 offen lds
    s_add_u32 m0, s64, 38928
    s_nop 0
    buffer_load_dwordx4 v4, s[32:35], s63 offen lds
    s_add_u32 m0, s64, 39952
    s_nop 0
    buffer_load_dwordx4 v5, s[32:35], s63 offen lds
    s_add_u32 m0, s65, 53264
    s_nop 0
    buffer_load_dwordx4 v6, s[36:39], s66 offen lds
    s_add_u32 m0, s65, 54288
    s_nop 0
    buffer_load_dwordx4 v7, s[36:39], s66 offen lds
    s_add_u32 m0, s65, 55312
    s_nop 0
    buffer_load_dwordx4 v8, s[36:39], s66 offen lds
    s_add_u32 m0, s65, 56336
    s_nop 0
    buffer_load_dwordx4 v9, s[36:39], s66 offen lds
    s_add_u32 m0, s65, 57360
    s_nop 0
    buffer_load_dwordx4 v10, s[36:39], s66 offen lds
    s_add_u32 s66, s66, 245760
    s_waitcnt vmcnt(9) lgkmcnt(0)
    s_barrier
    ds_read_b128 v[160:163], v11 offset:0
    ds_read_b128 v[164:167], v11 offset:2048
    ds_read_b128 v[168:171], v12 offset:0
    ds_read_b128 v[172:175], v12 offset:2048
    s_add_u32 s63, s59, 768
    s_add_u32 m0, s64, 73760
    s_nop 0
    buffer_load_dwordx4 v2, s[32:35], s63 offen lds
    s_add_u32 m0, s64, 74784
    s_nop 0
    buffer_load_dwordx4 v3, s[32:35], s63 offen lds
    s_add_u32 m0, s64, 75808
    s_nop 0
    buffer_load_dwordx4 v4, s[32:35], s63 offen lds
    s_add_u32 m0, s64, 76832
    s_nop 0
    buffer_load_dwordx4 v5, s[32:35], s63 offen lds
    s_add_u32 m0, s65, 90144
    s_nop 0
    buffer_load_dwordx4 v6, s[36:39], s66 offen lds
    s_add_u32 m0, s65, 91168
    s_nop 0
    buffer_load_dwordx4 v7, s[36:39], s66 offen lds
    s_add_u32 m0, s65, 92192
    s_nop 0
    buffer_load_dwordx4 v8, s[36:39], s66 offen lds
    s_add_u32 m0, s65, 93216
    s_nop 0
    buffer_load_dwordx4 v9, s[36:39], s66 offen lds
    s_add_u32 m0, s65, 94240
    s_nop 0
    buffer_load_dwordx4 v10, s[36:39], s66 offen lds
    s_add_u32 s66, s66, 245760
    s_waitcnt vmcnt(9) lgkmcnt(0)
    s_barrier
    ds_read_b128 v[176:179], v11 offset:36880
    ds_read_b128 v[180:183], v11 offset:38928
    ds_read_b128 v[184:187], v12 offset:36880
    ds_read_b128 v[188:191], v12 offset:38928
    s_add_u32 s63, s59, 896
    s_add_u32 m0, s64, 110640
    s_nop 0
    buffer_load_dwordx4 v2, s[32:35], s63 offen lds
    s_add_u32 m0, s64, 111664
    s_nop 0
    buffer_load_dwordx4 v3, s[32:35], s63 offen lds
    s_add_u32 m0, s64, 112688
    s_nop 0
    buffer_load_dwordx4 v4, s[32:35], s63 offen lds
    s_add_u32 m0, s64, 113712
    s_nop 0
    buffer_load_dwordx4 v5, s[32:35], s63 offen lds
    s_add_u32 m0, s65, 127024
    s_nop 0
    buffer_load_dwordx4 v6, s[36:39], s66 offen lds
    s_add_u32 m0, s65, 128048
    s_nop 0
    buffer_load_dwordx4 v7, s[36:39], s66 offen lds
    s_add_u32 m0, s65, 129072
    s_nop 0
    buffer_load_dwordx4 v8, s[36:39], s66 offen lds
    s_add_u32 m0, s65, 130096
    s_nop 0
    buffer_load_dwordx4 v9, s[36:39], s66 offen lds
    s_add_u32 m0, s65, 131120
    s_nop 0
    buffer_load_dwordx4 v10, s[36:39], s66 offen lds
    s_add_u32 s66, s66, 245760
    s_waitcnt vmcnt(9) lgkmcnt(0)
    s_barrier
    ds_read_b128 v[192:195], v13 offset:0
    ds_read_b128 v[196:199], v13 offset:2048
    ds_read_b128 v[200:203], v14 offset:0
    ds_read_b128 v[204:207], v14 offset:2048
    s_add_u32 s63, s59, 1024
    s_add_u32 m0, s64, 0
    s_nop 0
    buffer_load_dwordx4 v2, s[32:35], s63 offen lds
    s_add_u32 m0, s64, 1024
    s_nop 0
    buffer_load_dwordx4 v3, s[32:35], s63 offen lds
    s_add_u32 m0, s64, 2048
    s_nop 0
    buffer_load_dwordx4 v4, s[32:35], s63 offen lds
    s_add_u32 m0, s64, 3072
    s_nop 0
    buffer_load_dwordx4 v5, s[32:35], s63 offen lds
    s_add_u32 m0, s65, 16384
    s_nop 0
    buffer_load_dwordx4 v6, s[36:39], s66 offen lds
    s_add_u32 m0, s65, 17408
    s_nop 0
    buffer_load_dwordx4 v7, s[36:39], s66 offen lds
    s_add_u32 m0, s65, 18432
    s_nop 0
    buffer_load_dwordx4 v8, s[36:39], s66 offen lds
    s_add_u32 m0, s65, 19456
    s_nop 0
    buffer_load_dwordx4 v9, s[36:39], s66 offen lds
    s_add_u32 m0, s65, 20480
    s_nop 0
    buffer_load_dwordx4 v10, s[36:39], s66 offen lds
    s_add_u32 s66, s66, 245760
    s_waitcnt vmcnt(9) lgkmcnt(0)
    s_barrier
    ds_read_b128 v[208:211], v13 offset:36880
    ds_read_b128 v[212:215], v13 offset:38928
    ds_read_b128 v[216:219], v14 offset:36880
    ds_read_b128 v[220:223], v14 offset:38928
    s_add_u32 s63, s59, 1152
    s_add_u32 m0, s64, 36880
    s_nop 0
    buffer_load_dwordx4 v2, s[32:35], s63 offen lds
    s_add_u32 m0, s64, 37904
    s_nop 0
    buffer_load_dwordx4 v3, s[32:35], s63 offen lds
    s_add_u32 m0, s64, 38928
    s_nop 0
    buffer_load_dwordx4 v4, s[32:35], s63 offen lds
    s_add_u32 m0, s64, 39952
    s_nop 0
    buffer_load_dwordx4 v5, s[32:35], s63 offen lds
    s_add_u32 m0, s65, 53264
    s_nop 0
    buffer_load_dwordx4 v6, s[36:39], s66 offen lds
    s_add_u32 m0, s65, 54288
    s_nop 0
    buffer_load_dwordx4 v7, s[36:39], s66 offen lds
    s_add_u32 m0, s65, 55312
    s_nop 0
    buffer_load_dwordx4 v8, s[36:39], s66 offen lds
    s_add_u32 m0, s65, 56336
    s_nop 0
    buffer_load_dwordx4 v9, s[36:39], s66 offen lds
    s_add_u32 m0, s65, 57360
    s_nop 0
    buffer_load_dwordx4 v10, s[36:39], s66 offen lds
    s_add_u32 s66, s66, 245760
    s_waitcnt vmcnt(9) lgkmcnt(0)
    s_barrier
    ds_read_b128 v[224:227], v11 offset:0
    ds_read_b128 v[228:231], v11 offset:2048
    ds_read_b128 v[232:235], v12 offset:0
    ds_read_b128 v[236:239], v12 offset:2048
    s_add_u32 m0, s67, 73760
    s_nop 0
    buffer_load_dwordx4 v6, s[36:39], s3 offen lds
    s_add_u32 m0, s67, 74784
    s_nop 0
    buffer_load_dwordx4 v7, s[36:39], s3 offen lds
    s_add_u32 m0, s67, 75808
    s_nop 0
    buffer_load_dwordx4 v8, s[36:39], s3 offen lds
    s_add_u32 m0, s67, 76832
    s_nop 0
    buffer_load_dwordx4 v9, s[36:39], s3 offen lds
    s_add_u32 m0, s67, 77856
    s_nop 0
    buffer_load_dwordx4 v10, s[36:39], s3 offen lds
    s_add_u32 s3, s3, 491520
    s_add_u32 m0, s67, 94240
    s_nop 0
    buffer_load_dwordx4 v6, s[36:39], s3 offen lds
    s_add_u32 m0, s67, 95264
    s_nop 0
    buffer_load_dwordx4 v7, s[36:39], s3 offen lds
    s_add_u32 m0, s67, 96288
    s_nop 0
    buffer_load_dwordx4 v8, s[36:39], s3 offen lds
    s_add_u32 m0, s67, 97312
    s_nop 0
    buffer_load_dwordx4 v9, s[36:39], s3 offen lds
    s_add_u32 m0, s67, 98336
    s_nop 0
    buffer_load_dwordx4 v10, s[36:39], s3 offen lds
    s_add_u32 s3, s3, 491520
    s_waitcnt vmcnt(10) lgkmcnt(0)
    s_barrier
    ds_read_b128 v[240:243], v11 offset:36880
    ds_read_b128 v[244:247], v11 offset:38928
    ds_read_b128 v[248:251], v12 offset:36880
    ds_read_b128 v[252:255], v12 offset:38928
    s_add_u32 m0, s67, 114720
    s_nop 0
    buffer_load_dwordx4 v6, s[36:39], s3 offen lds
    s_add_u32 m0, s67, 115744
    s_nop 0
    buffer_load_dwordx4 v7, s[36:39], s3 offen lds
    s_add_u32 m0, s67, 116768
    s_nop 0
    buffer_load_dwordx4 v8, s[36:39], s3 offen lds
    s_add_u32 m0, s67, 117792
    s_nop 0
    buffer_load_dwordx4 v9, s[36:39], s3 offen lds
    s_add_u32 m0, s67, 118816
    s_nop 0
    buffer_load_dwordx4 v10, s[36:39], s3 offen lds
    s_add_u32 s3, s3, 491520
    s_mul_i32 s63, s69, 145440
    s_sub_u32 s63, s67, s63
    s_add_u32 m0, s63, 135200
    s_nop 0
    buffer_load_dwordx4 v6, s[36:39], s3 offen lds
    s_add_u32 m0, s63, 136224
    s_nop 0
    buffer_load_dwordx4 v7, s[36:39], s3 offen lds
    s_add_u32 m0, s63, 137248
    s_nop 0
    buffer_load_dwordx4 v8, s[36:39], s3 offen lds
    s_add_u32 m0, s63, 138272
    s_nop 0
    buffer_load_dwordx4 v9, s[36:39], s3 offen lds
    s_add_u32 m0, s63, 139296
    s_nop 0
    buffer_load_dwordx4 v10, s[36:39], s3 offen lds
    s_add_u32 s3, s3, 491520
    s_lshl_b32 s4, s61, 2
    s_add_u32 s4, s4, s68
    s_mul_i32 s4, s4, 40960
    s_add_u32 s4, s4, 2097152
    s_lshl_b32 s5, s62, 9
    s_add_u32 s5, s5, s4
    s_add_u32 s5, s5, 16384
    s_lshl_b32 s63, s62, 11
    s_add_u32 s4, s4, s63
    s_add_u32 s6, s4, 20480
    s_add_u32 s7, s5, 20480
    s_lshl_b32 s60, s61, 3
    s_add_u32 s60, s60, s62
    s_lshl_b32 s60, s60, 7
    s_add_u32 s60, s60, 8413184
    s_lshl_b64 s[12:13], 1, s56
    s_waitcnt lgkmcnt(0)
    v_mov_b32 v2, v56
    v_mov_b32 v12, s11
    v_mov_b32 v3, v57
    v_mov_b32 v13, s11
    v_mov_b32 v4, v58
    v_mov_b32 v14, s11
    v_mov_b32 v5, v59
    v_mov_b32 v15, s11
    v_mov_b32 v11, 3049366176
    s_waitcnt vmcnt(10)
    s_barrier
    s_setprio 0
    ds_read_b64_tr_b16 v[16:17], v2 offset:0
    ds_read_b64_tr_b16 v[18:19], v3 offset:0
    ds_read_b64_tr_b16 v[20:21], v2 offset:40
    ds_read_b64_tr_b16 v[22:23], v3 offset:40
    ds_read_b64_tr_b16 v[24:25], v2 offset:80
    ds_read_b64_tr_b16 v[26:27], v3 offset:80
    ds_read_b64_tr_b16 v[28:29], v2 offset:120
    ds_read_b64_tr_b16 v[30:31], v3 offset:120
    ds_read_b64_tr_b16 v[32:33], v4 offset:0
    ds_read_b64_tr_b16 v[34:35], v5 offset:0
    s_waitcnt lgkmcnt(8)
    v_mfma_f32_16x16x32_bf16 v[56:59], v[16:19], v[96:99], v[12:15]
    ds_read_b64_tr_b16 v[36:37], v2 offset:5120
    v_mfma_f32_16x16x32_bf16 v[76:79], v[16:19], v[100:103], v[12:15]
    ds_read_b64_tr_b16 v[38:39], v3 offset:5120
    s_add_u32 m0, s67, 10240
    s_nop 0
    buffer_load_dwordx4 v6, s[36:39], s3 offen lds
    s_waitcnt lgkmcnt(8)
    v_mfma_f32_16x16x32_bf16 v[60:63], v[20:23], v[96:99], v[12:15]
    ds_read_b64_tr_b16 v[40:41], v2 offset:5160
    v_mfma_f32_16x16x32_bf16 v[80:83], v[20:23], v[100:103], v[12:15]
    ds_read_b64_tr_b16 v[42:43], v3 offset:5160
    s_add_u32 m0, s67, 11264
    s_nop 0
    buffer_load_dwordx4 v7, s[36:39], s3 offen lds
    s_waitcnt lgkmcnt(8)
    v_mfma_f32_16x16x32_bf16 v[64:67], v[24:27], v[96:99], v[12:15]
    ds_read_b64_tr_b16 v[44:45], v2 offset:5200
    v_mfma_f32_16x16x32_bf16 v[84:87], v[24:27], v[100:103], v[12:15]
    ds_read_b64_tr_b16 v[46:47], v3 offset:5200
    s_add_u32 m0, s67, 12288
    s_nop 0
    buffer_load_dwordx4 v8, s[36:39], s3 offen lds
    s_waitcnt lgkmcnt(8)
    v_mfma_f32_16x16x32_bf16 v[68:71], v[28:31], v[96:99], v[12:15]
    ds_read_b64_tr_b16 v[48:49], v2 offset:5240
    v_mfma_f32_16x16x32_bf16 v[88:91], v[28:31], v[100:103], v[12:15]
    ds_read_b64_tr_b16 v[50:51], v3 offset:5240
    s_add_u32 m0, s67, 13312
    s_nop 0
    buffer_load_dwordx4 v9, s[36:39], s3 offen lds
    s_waitcnt lgkmcnt(8)
    v_mfma_f32_16x16x32_bf16 v[72:75], v[32:35], v[96:99], v[12:15]
    ds_read_b64_tr_b16 v[52:53], v4 offset:5120
    v_mfma_f32_16x16x32_bf16 v[92:95], v[32:35], v[100:103], v[12:15]
    ds_read_b64_tr_b16 v[54:55], v5 offset:5120
    s_add_u32 m0, s67, 14336
    s_nop 0
    buffer_load_dwordx4 v10, s[36:39], s3 offen lds
    s_waitcnt lgkmcnt(8)
    v_mfma_f32_16x16x32_bf16 v[56:59], v[36:39], v[104:107], v[56:59]
    ds_read_b64_tr_b16 v[16:17], v2 offset:10240
    v_mfma_f32_16x16x32_bf16 v[76:79], v[36:39], v[108:111], v[76:79]
    ds_read_b64_tr_b16 v[18:19], v3 offset:10240
    s_add_u32 s3, s3, 491520
    s_waitcnt lgkmcnt(8)
    v_mfma_f32_16x16x32_bf16 v[60:63], v[40:43], v[104:107], v[60:63]
    ds_read_b64_tr_b16 v[20:21], v2 offset:10280
    v_mfma_f32_16x16x32_bf16 v[80:83], v[40:43], v[108:111], v[80:83]
    ds_read_b64_tr_b16 v[22:23], v3 offset:10280
    v_lshlrev_b32 v6, 4, v0
    v_lshlrev_b32 v7, 3, v0
    v_mov_b32 v9, 1
    v_mov_b32 v96, -1
    v_mov_b32 v97, -1
    v_mov_b32 v98, -1
    v_mov_b32 v99, -1
    buffer_store_dwordx4 v[96:99], v6, s[44:47], s4 offen sc1
    s_waitcnt lgkmcnt(8)
    v_mfma_f32_16x16x32_bf16 v[64:67], v[44:47], v[104:107], v[64:67]
    ds_read_b64_tr_b16 v[24:25], v2 offset:10320
    v_mfma_f32_16x16x32_bf16 v[84:87], v[44:47], v[108:111], v[84:87]
    ds_read_b64_tr_b16 v[26:27], v3 offset:10320
    buffer_store_dwordx4 v[96:99], v6, s[44:47], s4 offen offset:1024 sc1
    s_waitcnt lgkmcnt(8)
    v_mfma_f32_16x16x32_bf16 v[68:71], v[48:51], v[104:107], v[68:71]
    ds_read_b64_tr_b16 v[28:29], v2 offset:10360
    v_mfma_f32_16x16x32_bf16 v[88:91], v[48:51], v[108:111], v[88:91]
    ds_read_b64_tr_b16 v[30:31], v3 offset:10360
    buffer_store_dwordx2 v[96:97], v7, s[44:47], s5 offen sc1
    s_waitcnt lgkmcnt(8)
    v_mfma_f32_16x16x32_bf16 v[72:75], v[52:55], v[104:107], v[72:75]
    ds_read_b64_tr_b16 v[32:33], v4 offset:10240
    v_mfma_f32_16x16x32_bf16 v[92:95], v[52:55], v[108:111], v[92:95]
    ds_read_b64_tr_b16 v[34:35], v5 offset:10240
    buffer_store_dwordx4 v[96:99], v6, s[44:47], s6 offen sc1
    s_waitcnt lgkmcnt(8)
    v_mfma_f32_16x16x32_bf16 v[56:59], v[16:19], v[112:115], v[56:59]
    ds_read_b64_tr_b16 v[36:37], v2 offset:15360
    v_mfma_f32_16x16x32_bf16 v[76:79], v[16:19], v[116:119], v[76:79]
    ds_read_b64_tr_b16 v[38:39], v3 offset:15360
    buffer_store_dwordx4 v[96:99], v6, s[44:47], s6 offen offset:1024 sc1
    s_waitcnt lgkmcnt(8)
    v_mfma_f32_16x16x32_bf16 v[60:63], v[20:23], v[112:115], v[60:63]
    ds_read_b64_tr_b16 v[40:41], v2 offset:15400
    v_mfma_f32_16x16x32_bf16 v[80:83], v[20:23], v[116:119], v[80:83]
    ds_read_b64_tr_b16 v[42:43], v3 offset:15400
    buffer_store_dwordx2 v[96:97], v7, s[44:47], s7 offen sc1
    s_waitcnt lgkmcnt(8)
    v_mfma_f32_16x16x32_bf16 v[64:67], v[24:27], v[112:115], v[64:67]
    ds_read_b64_tr_b16 v[44:45], v2 offset:15440
    v_mfma_f32_16x16x32_bf16 v[84:87], v[24:27], v[116:119], v[84:87]
    ds_read_b64_tr_b16 v[46:47], v3 offset:15440
    v_add_u32 v8, 147520, v6
    v_and_b32 v10, 7, v0
    v_lshlrev_b32 v10, 2, v10
    v_add_u32 v10, 163808, v10
    s_waitcnt lgkmcnt(8)
    v_mfma_f32_16x16x32_bf16 v[68:71], v[28:31], v[112:115], v[68:71]
    ds_read_b64_tr_b16 v[48:49], v2 offset:15480
    v_mfma_f32_16x16x32_bf16 v[88:91], v[28:31], v[116:119], v[88:91]
    ds_read_b64_tr_b16 v[50:51], v3 offset:15480
    s_mov_b64 s[40:41], s[8:9]
    s_mov_b32 s42, 819200
    s_mov_b32 s43, 0x20000
    s_movk_i32 s64, 1120
    v_mul_u32_u24 v103, 6554, v0
    v_lshlrev_b32 v104, 4, v0
    v_lshrrev_b32 v100, 16, v103
    v_add_u32 v103, 419456, v103
    s_waitcnt lgkmcnt(8)
    v_mfma_f32_16x16x32_bf16 v[72:75], v[32:35], v[112:115], v[72:75]
    ds_read_b64_tr_b16 v[52:53], v4 offset:15360
    v_mfma_f32_16x16x32_bf16 v[92:95], v[32:35], v[116:119], v[92:95]
    ds_read_b64_tr_b16 v[54:55], v5 offset:15360
    v_mad_u32_u24 v100, v100, s64, v104
    v_add_u32 v104, 1024, v104
    v_lshrrev_b32 v101, 16, v103
    v_add_u32 v103, 419456, v103
    v_mad_u32_u24 v101, v101, s64, v104
    v_add_u32 v104, 1024, v104
    v_lshrrev_b32 v102, 16, v103
    v_add_u32 v103, 419456, v103
    s_waitcnt lgkmcnt(8)
    v_mfma_f32_16x16x32_bf16 v[56:59], v[36:39], v[120:123], v[56:59]
    ds_read_b64_tr_b16 v[16:17], v2 offset:20480
    v_mfma_f32_16x16x32_bf16 v[76:79], v[36:39], v[124:127], v[76:79]
    ds_read_b64_tr_b16 v[18:19], v3 offset:20480
    v_mad_u32_u24 v102, v102, s64, v104
    v_add_u32 v104, 1024, v104
    v_ashrrev_i32 v111, 16, v103
    v_mul_u32_u24 v111, 1120, v111
    v_add_u32 v103, v111, v104
    v_add_u32 v111, 256, v0
    v_mul_u32_u24 v111, 6554, v111
    v_ashrrev_i32 v111, 16, v111
    s_waitcnt lgkmcnt(8)
    v_mfma_f32_16x16x32_bf16 v[60:63], v[40:43], v[120:123], v[60:63]
    ds_read_b64_tr_b16 v[20:21], v2 offset:20520
    v_mfma_f32_16x16x32_bf16 v[80:83], v[40:43], v[124:127], v[80:83]
    ds_read_b64_tr_b16 v[22:23], v3 offset:20520
    v_mul_u32_u24 v111, 1120, v111
    v_add_u32 v111, v111, v104
    v_add_u32 v104, 1024, v111
    s_add_u32 s64, s56, 0
    s_mul_i32 s65, s64, 5120
    s_mul_i32 s64, s64, 40960
    s_lshr_b32 s66, s58, 2
    s_mul_i32 s66, s66, 160
    s_add_u32 s64, s64, s66
    s_add_u32 m0, s65, 32800
    s_nop 0
    buffer_load_dwordx4 v100, s[40:43], s64 offen lds
    s_waitcnt lgkmcnt(8)
    v_mfma_f32_16x16x32_bf16 v[64:67], v[44:47], v[120:123], v[64:67]
    ds_read_b64_tr_b16 v[24:25], v2 offset:20560
    v_mfma_f32_16x16x32_bf16 v[84:87], v[44:47], v[124:127], v[84:87]
    ds_read_b64_tr_b16 v[26:27], v3 offset:20560
    s_add_u32 m0, s65, 33824
    s_nop 0
    buffer_load_dwordx4 v101, s[40:43], s64 offen lds
    s_waitcnt lgkmcnt(8)
    v_mfma_f32_16x16x32_bf16 v[68:71], v[48:51], v[120:123], v[68:71]
    ds_read_b64_tr_b16 v[28:29], v2 offset:20600
    v_mfma_f32_16x16x32_bf16 v[88:91], v[48:51], v[124:127], v[88:91]
    ds_read_b64_tr_b16 v[30:31], v3 offset:20600
    s_add_u32 m0, s65, 34848
    s_nop 0
    buffer_load_dwordx4 v102, s[40:43], s64 offen lds
    s_waitcnt lgkmcnt(8)
    v_mfma_f32_16x16x32_bf16 v[72:75], v[52:55], v[120:123], v[72:75]
    ds_read_b64_tr_b16 v[32:33], v4 offset:20480
    v_mfma_f32_16x16x32_bf16 v[92:95], v[52:55], v[124:127], v[92:95]
    ds_read_b64_tr_b16 v[34:35], v5 offset:20480
    s_add_u32 m0, s65, 35872
    s_nop 0
    buffer_load_dwordx4 v103, s[40:43], s64 offen lds
    s_waitcnt lgkmcnt(8)
    v_mfma_f32_16x16x32_bf16 v[56:59], v[16:19], v[128:131], v[56:59]
    ds_read_b64_tr_b16 v[36:37], v2 offset:25600
    v_mfma_f32_16x16x32_bf16 v[76:79], v[16:19], v[132:135], v[76:79]
    ds_read_b64_tr_b16 v[38:39], v3 offset:25600
    s_add_u32 m0, s65, 36896
    s_nop 0
    buffer_load_dwordx4 v104, s[40:43], s64 offen lds
    s_waitcnt lgkmcnt(8)
    v_mfma_f32_16x16x32_bf16 v[60:63], v[20:23], v[128:131], v[60:63]
    ds_read_b64_tr_b16 v[40:41], v2 offset:25640
    v_mfma_f32_16x16x32_bf16 v[80:83], v[20:23], v[132:135], v[80:83]
    ds_read_b64_tr_b16 v[42:43], v3 offset:25640
    s_waitcnt lgkmcnt(8)
    v_mfma_f32_16x16x32_bf16 v[64:67], v[24:27], v[128:131], v[64:67]
    ds_read_b64_tr_b16 v[44:45], v2 offset:25680
    v_mfma_f32_16x16x32_bf16 v[84:87], v[24:27], v[132:135], v[84:87]
    ds_read_b64_tr_b16 v[46:47], v3 offset:25680
    s_waitcnt lgkmcnt(8)
    v_mfma_f32_16x16x32_bf16 v[68:71], v[28:31], v[128:131], v[68:71]
    ds_read_b64_tr_b16 v[48:49], v2 offset:25720
    v_mfma_f32_16x16x32_bf16 v[88:91], v[28:31], v[132:135], v[88:91]
    ds_read_b64_tr_b16 v[50:51], v3 offset:25720
    s_waitcnt lgkmcnt(8)
    v_mfma_f32_16x16x32_bf16 v[72:75], v[32:35], v[128:131], v[72:75]
    ds_read_b64_tr_b16 v[52:53], v4 offset:25600
    v_mfma_f32_16x16x32_bf16 v[92:95], v[32:35], v[132:135], v[92:95]
    ds_read_b64_tr_b16 v[54:55], v5 offset:25600
    s_waitcnt lgkmcnt(8)
    v_mfma_f32_16x16x32_bf16 v[56:59], v[36:39], v[136:139], v[56:59]
    ds_read_b64_tr_b16 v[16:17], v2 offset:30720
    v_mfma_f32_16x16x32_bf16 v[76:79], v[36:39], v[140:143], v[76:79]
    ds_read_b64_tr_b16 v[18:19], v3 offset:30720
    s_waitcnt lgkmcnt(8)
    v_mfma_f32_16x16x32_bf16 v[60:63], v[40:43], v[136:139], v[60:63]
    ds_read_b64_tr_b16 v[20:21], v2 offset:30760
    v_mfma_f32_16x16x32_bf16 v[80:83], v[40:43], v[140:143], v[80:83]
    ds_read_b64_tr_b16 v[22:23], v3 offset:30760
    s_waitcnt lgkmcnt(8)
    v_mfma_f32_16x16x32_bf16 v[64:67], v[44:47], v[136:139], v[64:67]
    ds_read_b64_tr_b16 v[24:25], v2 offset:30800
    v_mfma_f32_16x16x32_bf16 v[84:87], v[44:47], v[140:143], v[84:87]
    ds_read_b64_tr_b16 v[26:27], v3 offset:30800
    s_waitcnt lgkmcnt(8)
    v_mfma_f32_16x16x32_bf16 v[68:71], v[48:51], v[136:139], v[68:71]
    ds_read_b64_tr_b16 v[28:29], v2 offset:30840
    v_mfma_f32_16x16x32_bf16 v[88:91], v[48:51], v[140:143], v[88:91]
    ds_read_b64_tr_b16 v[30:31], v3 offset:30840
    s_waitcnt lgkmcnt(8)
    v_mfma_f32_16x16x32_bf16 v[72:75], v[52:55], v[136:139], v[72:75]
    ds_read_b64_tr_b16 v[32:33], v4 offset:30720
    v_mfma_f32_16x16x32_bf16 v[92:95], v[52:55], v[140:143], v[92:95]
    ds_read_b64_tr_b16 v[34:35], v5 offset:30720
    s_waitcnt lgkmcnt(8)
    v_mfma_f32_16x16x32_bf16 v[56:59], v[16:19], v[144:147], v[56:59]
    ds_read_b64_tr_b16 v[36:37], v2 offset:35840
    v_mfma_f32_16x16x32_bf16 v[76:79], v[16:19], v[148:151], v[76:79]
    ds_read_b64_tr_b16 v[38:39], v3 offset:35840
    s_waitcnt lgkmcnt(8)
    v_mfma_f32_16x16x32_bf16 v[60:63], v[20:23], v[144:147], v[60:63]
    ds_read_b64_tr_b16 v[40:41], v2 offset:35880
    v_mfma_f32_16x16x32_bf16 v[80:83], v[20:23], v[148:151], v[80:83]
    ds_read_b64_tr_b16 v[42:43], v3 offset:35880
    s_waitcnt lgkmcnt(8)
    v_mfma_f32_16x16x32_bf16 v[64:67], v[24:27], v[144:147], v[64:67]
    ds_read_b64_tr_b16 v[44:45], v2 offset:35920
    v_mfma_f32_16x16x32_bf16 v[84:87], v[24:27], v[148:151], v[84:87]
    ds_read_b64_tr_b16 v[46:47], v3 offset:35920
    s_waitcnt lgkmcnt(8)
    v_mfma_f32_16x16x32_bf16 v[68:71], v[28:31], v[144:147], v[68:71]
    ds_read_b64_tr_b16 v[48:49], v2 offset:35960
    v_mfma_f32_16x16x32_bf16 v[88:91], v[28:31], v[148:151], v[88:91]
    ds_read_b64_tr_b16 v[50:51], v3 offset:35960
    s_waitcnt lgkmcnt(8)
    v_mfma_f32_16x16x32_bf16 v[72:75], v[32:35], v[144:147], v[72:75]
    ds_read_b64_tr_b16 v[52:53], v4 offset:35840
    v_mfma_f32_16x16x32_bf16 v[92:95], v[32:35], v[148:151], v[92:95]
    ds_read_b64_tr_b16 v[54:55], v5 offset:35840
    v_subrev_u32 v106, 32, v10
    s_waitcnt vmcnt(11) lgkmcnt(0)
    s_setprio 1
    v_mov_b32 v107, 1
    s_mov_b64 exec, s[12:13]
    ds_write_b32 v106, v107
    s_mov_b64 exec, -1
    ds_read_b32 v107, v106
    s_waitcnt lgkmcnt(0)
L_rl_1:
    v_cmp_gt_u32 vcc, 1, v107
    s_and_b32 s63, vcc_lo, 0xf0
    s_cbranch_scc0 L_rd_2
    ds_read_b32 v107, v106
    s_waitcnt lgkmcnt(0)
    s_branch L_rl_1
L_rd_2:
    s_waitcnt lgkmcnt(8)
    v_mfma_f32_16x16x32_bf16 v[56:59], v[36:39], v[152:155], v[56:59]
    v_add_u32 v2, 40960, v2
    v_add_u32 v3, 40960, v3
    v_add_u32 v4, 40960, v4
    v_add_u32 v5, 40960, v5
    ds_read_b64_tr_b16 v[16:17], v2 offset:0
    v_mfma_f32_16x16x32_bf16 v[76:79], v[36:39], v[156:159], v[76:79]
    ds_read_b64_tr_b16 v[18:19], v3 offset:0
    s_waitcnt lgkmcnt(8)
    v_mfma_f32_16x16x32_bf16 v[60:63], v[40:43], v[152:155], v[60:63]
    ds_read_b64_tr_b16 v[20:21], v2 offset:40
    v_mfma_f32_16x16x32_bf16 v[80:83], v[40:43], v[156:159], v[80:83]
    ds_read_b64_tr_b16 v[22:23], v3 offset:40
    s_waitcnt lgkmcnt(8)
    v_mfma_f32_16x16x32_bf16 v[64:67], v[44:47], v[152:155], v[64:67]
    ds_read_b64_tr_b16 v[24:25], v2 offset:80
    v_mfma_f32_16x16x32_bf16 v[84:87], v[44:47], v[156:159], v[84:87]
    ds_read_b64_tr_b16 v[26:27], v3 offset:80
    s_waitcnt lgkmcnt(8)
    v_mfma_f32_16x16x32_bf16 v[68:71], v[48:51], v[152:155], v[68:71]
    ds_read_b64_tr_b16 v[28:29], v2 offset:120
    v_mfma_f32_16x16x32_bf16 v[88:91], v[48:51], v[156:159], v[88:91]
    ds_read_b64_tr_b16 v[30:31], v3 offset:120
    s_waitcnt lgkmcnt(8)
    v_mfma_f32_16x16x32_bf16 v[72:75], v[52:55], v[152:155], v[72:75]
    ds_read_b64_tr_b16 v[32:33], v4 offset:0
    v_mfma_f32_16x16x32_bf16 v[92:95], v[52:55], v[156:159], v[92:95]
    ds_read_b64_tr_b16 v[34:35], v5 offset:0
    s_waitcnt lgkmcnt(8)
    v_mfma_f32_16x16x32_bf16 v[56:59], v[16:19], v[160:163], v[56:59]
    ds_read_b64_tr_b16 v[36:37], v2 offset:5120
    v_mfma_f32_16x16x32_bf16 v[76:79], v[16:19], v[164:167], v[76:79]
    ds_read_b64_tr_b16 v[38:39], v3 offset:5120
    s_waitcnt lgkmcnt(8)
    v_mfma_f32_16x16x32_bf16 v[60:63], v[20:23], v[160:163], v[60:63]
    ds_read_b64_tr_b16 v[40:41], v2 offset:5160
    v_mfma_f32_16x16x32_bf16 v[80:83], v[20:23], v[164:167], v[80:83]
    ds_read_b64_tr_b16 v[42:43], v3 offset:5160
    s_waitcnt lgkmcnt(8)
    v_mfma_f32_16x16x32_bf16 v[64:67], v[24:27], v[160:163], v[64:67]
    ds_read_b64_tr_b16 v[44:45], v2 offset:5200
    v_mfma_f32_16x16x32_bf16 v[84:87], v[24:27], v[164:167], v[84:87]
    ds_read_b64_tr_b16 v[46:47], v3 offset:5200
    s_waitcnt lgkmcnt(8)
    v_mfma_f32_16x16x32_bf16 v[68:71], v[28:31], v[160:163], v[68:71]
    ds_read_b64_tr_b16 v[48:49], v2 offset:5240
    v_mfma_f32_16x16x32_bf16 v[88:91], v[28:31], v[164:167], v[88:91]
    ds_read_b64_tr_b16 v[50:51], v3 offset:5240
    s_waitcnt lgkmcnt(8)
    v_mfma_f32_16x16x32_bf16 v[72:75], v[32:35], v[160:163], v[72:75]
    ds_read_b64_tr_b16 v[52:53], v4 offset:5120
    v_mfma_f32_16x16x32_bf16 v[92:95], v[32:35], v[164:167], v[92:95]
    ds_read_b64_tr_b16 v[54:55], v5 offset:5120
    s_waitcnt lgkmcnt(8)
    v_mfma_f32_16x16x32_bf16 v[56:59], v[36:39], v[168:171], v[56:59]
    ds_read_b64_tr_b16 v[16:17], v2 offset:10240
    v_mfma_f32_16x16x32_bf16 v[76:79], v[36:39], v[172:175], v[76:79]
    ds_read_b64_tr_b16 v[18:19], v3 offset:10240
    s_waitcnt lgkmcnt(8)
    v_mfma_f32_16x16x32_bf16 v[60:63], v[40:43], v[168:171], v[60:63]
    ds_read_b64_tr_b16 v[20:21], v2 offset:10280
    v_mfma_f32_16x16x32_bf16 v[80:83], v[40:43], v[172:175], v[80:83]
    ds_read_b64_tr_b16 v[22:23], v3 offset:10280
    s_waitcnt lgkmcnt(8)
    v_mfma_f32_16x16x32_bf16 v[64:67], v[44:47], v[168:171], v[64:67]
    ds_read_b64_tr_b16 v[24:25], v2 offset:10320
    v_mfma_f32_16x16x32_bf16 v[84:87], v[44:47], v[172:175], v[84:87]
    ds_read_b64_tr_b16 v[26:27], v3 offset:10320
    s_waitcnt lgkmcnt(8)
    v_mfma_f32_16x16x32_bf16 v[68:71], v[48:51], v[168:171], v[68:71]
    ds_read_b64_tr_b16 v[28:29], v2 offset:10360
    v_mfma_f32_16x16x32_bf16 v[88:91], v[48:51], v[172:175], v[88:91]
    ds_read_b64_tr_b16 v[30:31], v3 offset:10360
    s_waitcnt lgkmcnt(8)
    v_mfma_f32_16x16x32_bf16 v[72:75], v[52:55], v[168:171], v[72:75]
    ds_read_b64_tr_b16 v[32:33], v4 offset:10240
    v_mfma_f32_16x16x32_bf16 v[92:95], v[52:55], v[172:175], v[92:95]
    ds_read_b64_tr_b16 v[34:35], v5 offset:10240
    s_waitcnt lgkmcnt(8)
    v_mfma_f32_16x16x32_bf16 v[56:59], v[16:19], v[176:179], v[56:59]
    ds_read_b64_tr_b16 v[36:37], v2 offset:15360
    v_mfma_f32_16x16x32_bf16 v[76:79], v[16:19], v[180:183], v[76:79]
    ds_read_b64_tr_b16 v[38:39], v3 offset:15360
    s_waitcnt lgkmcnt(8)
    v_mfma_f32_16x16x32_bf16 v[60:63], v[20:23], v[176:179], v[60:63]
    ds_read_b64_tr_b16 v[40:41], v2 offset:15400
    v_mfma_f32_16x16x32_bf16 v[80:83], v[20:23], v[180:183], v[80:83]
    ds_read_b64_tr_b16 v[42:43], v3 offset:15400
    s_waitcnt lgkmcnt(8)
    v_mfma_f32_16x16x32_bf16 v[64:67], v[24:27], v[176:179], v[64:67]
    ds_read_b64_tr_b16 v[44:45], v2 offset:15440
    v_mfma_f32_16x16x32_bf16 v[84:87], v[24:27], v[180:183], v[84:87]
    ds_read_b64_tr_b16 v[46:47], v3 offset:15440
    s_waitcnt lgkmcnt(8)
    v_mfma_f32_16x16x32_bf16 v[68:71], v[28:31], v[176:179], v[68:71]
    ds_read_b64_tr_b16 v[48:49], v2 offset:15480
    v_mfma_f32_16x16x32_bf16 v[88:91], v[28:31], v[180:183], v[88:91]
    ds_read_b64_tr_b16 v[50:51], v3 offset:15480
    s_waitcnt lgkmcnt(8)
    v_mfma_f32_16x16x32_bf16 v[72:75], v[32:35], v[176:179], v[72:75]
    ds_read_b64_tr_b16 v[52:53], v4 offset:15360
    v_mfma_f32_16x16x32_bf16 v[92:95], v[32:35], v[180:183], v[92:95]
    ds_read_b64_tr_b16 v[54:55], v5 offset:15360
    s_waitcnt lgkmcnt(8)
    v_mfma_f32_16x16x32_bf16 v[56:59], v[36:39], v[184:187], v[56:59]
    ds_read_b64_tr_b16 v[16:17], v2 offset:20480
    v_mfma_f32_16x16x32_bf16 v[76:79], v[36:39], v[188:191], v[76:79]
    ds_read_b64_tr_b16 v[18:19], v3 offset:20480
    s_waitcnt lgkmcnt(8)
    v_mfma_f32_16x16x32_bf16 v[60:63], v[40:43], v[184:187], v[60:63]
    ds_read_b64_tr_b16 v[20:21], v2 offset:20520
    v_mfma_f32_16x16x32_bf16 v[80:83], v[40:43], v[188:191], v[80:83]
    ds_read_b64_tr_b16 v[22:23], v3 offset:20520
    s_waitcnt lgkmcnt(8)
    v_mfma_f32_16x16x32_bf16 v[64:67], v[44:47], v[184:187], v[64:67]
    ds_read_b64_tr_b16 v[24:25], v2 offset:20560
    v_mfma_f32_16x16x32_bf16 v[84:87], v[44:47], v[188:191], v[84:87]
    ds_read_b64_tr_b16 v[26:27], v3 offset:20560
    s_waitcnt lgkmcnt(8)
    v_mfma_f32_16x16x32_bf16 v[68:71], v[48:51], v[184:187], v[68:71]
    ds_read_b64_tr_b16 v[28:29], v2 offset:20600
    v_mfma_f32_16x16x32_bf16 v[88:91], v[48:51], v[188:191], v[88:91]
    ds_read_b64_tr_b16 v[30:31], v3 offset:20600
    s_waitcnt lgkmcnt(8)
    v_mfma_f32_16x16x32_bf16 v[72:75], v[52:55], v[184:187], v[72:75]
    ds_read_b64_tr_b16 v[32:33], v4 offset:20480
    v_mfma_f32_16x16x32_bf16 v[92:95], v[52:55], v[188:191], v[92:95]
    ds_read_b64_tr_b16 v[34:35], v5 offset:20480
    s_waitcnt vmcnt(0)
    s_mov_b64 exec, s[12:13]
    ds_write_b32 v10, v9
    s_mov_b64 exec, -1
    s_waitcnt lgkmcnt(9)
    v_mfma_f32_16x16x32_bf16 v[56:59], v[16:19], v[192:195], v[56:59]
    ds_read_b64_tr_b16 v[36:37], v2 offset:25600
    v_mfma_f32_16x16x32_bf16 v[76:79], v[16:19], v[196:199], v[76:79]
    ds_read_b64_tr_b16 v[38:39], v3 offset:25600
    s_waitcnt lgkmcnt(9)
    v_mfma_f32_16x16x32_bf16 v[60:63], v[20:23], v[192:195], v[60:63]
    ds_read_b64_tr_b16 v[40:41], v2 offset:25640
    v_mfma_f32_16x16x32_bf16 v[80:83], v[20:23], v[196:199], v[80:83]
    ds_read_b64_tr_b16 v[42:43], v3 offset:25640
    s_waitcnt lgkmcnt(9)
    v_mfma_f32_16x16x32_bf16 v[64:67], v[24:27], v[192:195], v[64:67]
    ds_read_b64_tr_b16 v[44:45], v2 offset:25680
    v_mfma_f32_16x16x32_bf16 v[84:87], v[24:27], v[196:199], v[84:87]
    ds_read_b64_tr_b16 v[46:47], v3 offset:25680
    s_waitcnt lgkmcnt(9)
    v_mfma_f32_16x16x32_bf16 v[68:71], v[28:31], v[192:195], v[68:71]
    ds_read_b64_tr_b16 v[48:49], v2 offset:25720
    v_mfma_f32_16x16x32_bf16 v[88:91], v[28:31], v[196:199], v[88:91]
    ds_read_b64_tr_b16 v[50:51], v3 offset:25720
    s_waitcnt lgkmcnt(9)
    v_mfma_f32_16x16x32_bf16 v[72:75], v[32:35], v[192:195], v[72:75]
    ds_read_b64_tr_b16 v[52:53], v4 offset:25600
    v_mfma_f32_16x16x32_bf16 v[92:95], v[32:35], v[196:199], v[92:95]
    ds_read_b64_tr_b16 v[54:55], v5 offset:25600
    s_waitcnt lgkmcnt(8)
    v_mfma_f32_16x16x32_bf16 v[56:59], v[36:39], v[200:203], v[56:59]
    v_add_u32 v2, -114720, v2
    v_add_u32 v3, -114720, v3
    v_add_u32 v4, -114720, v4
    v_add_u32 v5, -114720, v5
    ds_read_b64_tr_b16 v[16:17], v2 offset:0
    v_mfma_f32_16x16x32_bf16 v[76:79], v[36:39], v[204:207], v[76:79]
    ds_read_b64_tr_b16 v[18:19], v3 offset:0
    s_waitcnt lgkmcnt(8)
    v_mfma_f32_16x16x32_bf16 v[60:63], v[40:43], v[200:203], v[60:63]
    ds_read_b64_tr_b16 v[20:21], v2 offset:40
    v_mfma_f32_16x16x32_bf16 v[80:83], v[40:43], v[204:207], v[80:83]
    ds_read_b64_tr_b16 v[22:23], v3 offset:40
    s_waitcnt lgkmcnt(8)
    v_mfma_f32_16x16x32_bf16 v[64:67], v[44:47], v[200:203], v[64:67]
    ds_read_b64_tr_b16 v[24:25], v2 offset:80
    v_mfma_f32_16x16x32_bf16 v[84:87], v[44:47], v[204:207], v[84:87]
    ds_read_b64_tr_b16 v[26:27], v3 offset:80
    s_waitcnt lgkmcnt(8)
    v_mfma_f32_16x16x32_bf16 v[68:71], v[48:51], v[200:203], v[68:71]
    ds_read_b64_tr_b16 v[28:29], v2 offset:120
    v_mfma_f32_16x16x32_bf16 v[88:91], v[48:51], v[204:207], v[88:91]
    ds_read_b64_tr_b16 v[30:31], v3 offset:120
    s_waitcnt lgkmcnt(8)
    v_mfma_f32_16x16x32_bf16 v[72:75], v[52:55], v[200:203], v[72:75]
    ds_read_b64_tr_b16 v[32:33], v4 offset:0
    v_mfma_f32_16x16x32_bf16 v[92:95], v[52:55], v[204:207], v[92:95]
    ds_read_b64_tr_b16 v[34:35], v5 offset:0
    s_waitcnt lgkmcnt(8)
    v_mfma_f32_16x16x32_bf16 v[56:59], v[16:19], v[208:211], v[56:59]
    ds_read_b64_tr_b16 v[36:37], v2 offset:5120
    v_mfma_f32_16x16x32_bf16 v[76:79], v[16:19], v[212:215], v[76:79]
    ds_read_b64_tr_b16 v[38:39], v3 offset:5120
    s_waitcnt lgkmcnt(8)
    v_mfma_f32_16x16x32_bf16 v[60:63], v[20:23], v[208:211], v[60:63]
    ds_read_b64_tr_b16 v[40:41], v2 offset:5160
    v_mfma_f32_16x16x32_bf16 v[80:83], v[20:23], v[212:215], v[80:83]
    ds_read_b64_tr_b16 v[42:43], v3 offset:5160
    s_waitcnt lgkmcnt(8)
    v_mfma_f32_16x16x32_bf16 v[64:67], v[24:27], v[208:211], v[64:67]
    ds_read_b64_tr_b16 v[44:45], v2 offset:5200
    v_mfma_f32_16x16x32_bf16 v[84:87], v[24:27], v[212:215], v[84:87]
    ds_read_b64_tr_b16 v[46:47], v3 offset:5200
    s_waitcnt lgkmcnt(8)
    v_mfma_f32_16x16x32_bf16 v[68:71], v[28:31], v[208:211], v[68:71]
    ds_read_b64_tr_b16 v[48:49], v2 offset:5240
    v_mfma_f32_16x16x32_bf16 v[88:91], v[28:31], v[212:215], v[88:91]
    ds_read_b64_tr_b16 v[50:51], v3 offset:5240
    s_waitcnt lgkmcnt(8)
    v_mfma_f32_16x16x32_bf16 v[72:75], v[32:35], v[208:211], v[72:75]
    ds_read_b64_tr_b16 v[52:53], v4 offset:5120
    v_mfma_f32_16x16x32_bf16 v[92:95], v[32:35], v[212:215], v[92:95]
    ds_read_b64_tr_b16 v[54:55], v5 offset:5120
    s_waitcnt lgkmcnt(8)
    v_mfma_f32_16x16x32_bf16 v[56:59], v[36:39], v[216:219], v[56:59]
    ds_read_b64_tr_b16 v[16:17], v2 offset:10240
    v_mfma_f32_16x16x32_bf16 v[76:79], v[36:39], v[220:223], v[76:79]
    ds_read_b64_tr_b16 v[18:19], v3 offset:10240
    s_waitcnt lgkmcnt(8)
    v_mfma_f32_16x16x32_bf16 v[60:63], v[40:43], v[216:219], v[60:63]
    ds_read_b64_tr_b16 v[20:21], v2 offset:10280
    v_mfma_f32_16x16x32_bf16 v[80:83], v[40:43], v[220:223], v[80:83]
    ds_read_b64_tr_b16 v[22:23], v3 offset:10280
    s_waitcnt lgkmcnt(8)
    v_mfma_f32_16x16x32_bf16 v[64:67], v[44:47], v[216:219], v[64:67]
    ds_read_b64_tr_b16 v[24:25], v2 offset:10320
    v_mfma_f32_16x16x32_bf16 v[84:87], v[44:47], v[220:223], v[84:87]
    ds_read_b64_tr_b16 v[26:27], v3 offset:10320
    s_waitcnt lgkmcnt(8)
    v_mfma_f32_16x16x32_bf16 v[68:71], v[48:51], v[216:219], v[68:71]
    ds_read_b64_tr_b16 v[28:29], v2 offset:10360
    v_mfma_f32_16x16x32_bf16 v[88:91], v[48:51], v[220:223], v[88:91]
    ds_read_b64_tr_b16 v[30:31], v3 offset:10360
    s_waitcnt lgkmcnt(8)
    v_mfma_f32_16x16x32_bf16 v[72:75], v[52:55], v[216:219], v[72:75]
    ds_read_b64_tr_b16 v[32:33], v4 offset:10240
    v_mfma_f32_16x16x32_bf16 v[92:95], v[52:55], v[220:223], v[92:95]
    ds_read_b64_tr_b16 v[34:35], v5 offset:10240
    s_waitcnt lgkmcnt(8)
    v_mfma_f32_16x16x32_bf16 v[56:59], v[16:19], v[224:227], v[56:59]
    ds_read_b64_tr_b16 v[36:37], v2 offset:15360
    v_mfma_f32_16x16x32_bf16 v[76:79], v[16:19], v[228:231], v[76:79]
    ds_read_b64_tr_b16 v[38:39], v3 offset:15360
    s_waitcnt lgkmcnt(8)
    v_mfma_f32_16x16x32_bf16 v[60:63], v[20:23], v[224:227], v[60:63]
    ds_read_b64_tr_b16 v[40:41], v2 offset:15400
    v_mfma_f32_16x16x32_bf16 v[80:83], v[20:23], v[228:231], v[80:83]
    ds_read_b64_tr_b16 v[42:43], v3 offset:15400
    s_waitcnt lgkmcnt(8)
    v_mfma_f32_16x16x32_bf16 v[64:67], v[24:27], v[224:227], v[64:67]
    ds_read_b64_tr_b16 v[44:45], v2 offset:15440
    v_mfma_f32_16x16x32_bf16 v[84:87], v[24:27], v[228:231], v[84:87]
    ds_read_b64_tr_b16 v[46:47], v3 offset:15440
    s_waitcnt lgkmcnt(8)
    v_mfma_f32_16x16x32_bf16 v[68:71], v[28:31], v[224:227], v[68:71]
    ds_read_b64_tr_b16 v[48:49], v2 offset:15480
    v_mfma_f32_16x16x32_bf16 v[88:91], v[28:31], v[228:231], v[88:91]
    ds_read_b64_tr_b16 v[50:51], v3 offset:15480
    s_waitcnt lgkmcnt(8)
    v_mfma_f32_16x16x32_bf16 v[72:75], v[32:35], v[224:227], v[72:75]
    ds_read_b64_tr_b16 v[52:53], v4 offset:15360
    v_mfma_f32_16x16x32_bf16 v[92:95], v[32:35], v[228:231], v[92:95]
    ds_read_b64_tr_b16 v[54:55], v5 offset:15360
    s_waitcnt lgkmcnt(8)
    v_mfma_f32_16x16x32_bf16 v[56:59], v[36:39], v[232:235], v[56:59]
    ds_read_b64_tr_b16 v[16:17], v2 offset:20480
    v_mfma_f32_16x16x32_bf16 v[76:79], v[36:39], v[236:239], v[76:79]
    ds_read_b64_tr_b16 v[18:19], v3 offset:20480
    s_waitcnt lgkmcnt(8)
    v_mfma_f32_16x16x32_bf16 v[60:63], v[40:43], v[232:235], v[60:63]
    ds_read_b64_tr_b16 v[20:21], v2 offset:20520
    v_mfma_f32_16x16x32_bf16 v[80:83], v[40:43], v[236:239], v[80:83]
    ds_read_b64_tr_b16 v[22:23], v3 offset:20520
    s_waitcnt lgkmcnt(8)
    v_mfma_f32_16x16x32_bf16 v[64:67], v[44:47], v[232:235], v[64:67]
    ds_read_b64_tr_b16 v[24:25], v2 offset:20560
    v_mfma_f32_16x16x32_bf16 v[84:87], v[44:47], v[236:239], v[84:87]
    ds_read_b64_tr_b16 v[26:27], v3 offset:20560
    s_waitcnt lgkmcnt(8)
    v_mfma_f32_16x16x32_bf16 v[68:71], v[48:51], v[232:235], v[68:71]
    ds_read_b64_tr_b16 v[28:29], v2 offset:20600
    v_mfma_f32_16x16x32_bf16 v[88:91], v[48:51], v[236:239], v[88:91]
    ds_read_b64_tr_b16 v[30:31], v3 offset:20600
    s_waitcnt lgkmcnt(8)
    v_mfma_f32_16x16x32_bf16 v[72:75], v[52:55], v[232:235], v[72:75]
    ds_read_b64_tr_b16 v[32:33], v4 offset:20480
    v_mfma_f32_16x16x32_bf16 v[92:95], v[52:55], v[236:239], v[92:95]
    ds_read_b64_tr_b16 v[34:35], v5 offset:20480
    s_waitcnt lgkmcnt(8)
    v_mfma_f32_16x16x32_bf16 v[56:59], v[16:19], v[240:243], v[56:59]
    ds_read_b64_tr_b16 v[36:37], v2 offset:25600
    v_mfma_f32_16x16x32_bf16 v[76:79], v[16:19], v[244:247], v[76:79]
    ds_read_b64_tr_b16 v[38:39], v3 offset:25600
    s_waitcnt lgkmcnt(8)
    v_mfma_f32_16x16x32_bf16 v[60:63], v[20:23], v[240:243], v[60:63]
    ds_read_b64_tr_b16 v[40:41], v2 offset:25640
    v_mfma_f32_16x16x32_bf16 v[80:83], v[20:23], v[244:247], v[80:83]
    ds_read_b64_tr_b16 v[42:43], v3 offset:25640
    s_waitcnt lgkmcnt(8)
    v_mfma_f32_16x16x32_bf16 v[64:67], v[24:27], v[240:243], v[64:67]
    ds_read_b64_tr_b16 v[44:45], v2 offset:25680
    v_mfma_f32_16x16x32_bf16 v[84:87], v[24:27], v[244:247], v[84:87]
    ds_read_b64_tr_b16 v[46:47], v3 offset:25680
    s_waitcnt lgkmcnt(8)
    v_mfma_f32_16x16x32_bf16 v[68:71], v[28:31], v[240:243], v[68:71]
    ds_read_b64_tr_b16 v[48:49], v2 offset:25720
    v_mfma_f32_16x16x32_bf16 v[88:91], v[28:31], v[244:247], v[88:91]
    ds_read_b64_tr_b16 v[50:51], v3 offset:25720
    s_waitcnt lgkmcnt(8)
    v_mfma_f32_16x16x32_bf16 v[72:75], v[32:35], v[240:243], v[72:75]
    ds_read_b64_tr_b16 v[52:53], v4 offset:25600
    v_mfma_f32_16x16x32_bf16 v[92:95], v[32:35], v[244:247], v[92:95]
    ds_read_b64_tr_b16 v[54:55], v5 offset:25600
    s_waitcnt lgkmcnt(8)
    v_mfma_f32_16x16x32_bf16 v[56:59], v[36:39], v[248:251], v[56:59]
    v_mfma_f32_16x16x32_bf16 v[76:79], v[36:39], v[252:255], v[76:79]
    s_waitcnt lgkmcnt(6)
    v_mfma_f32_16x16x32_bf16 v[60:63], v[40:43], v[248:251], v[60:63]
    v_mfma_f32_16x16x32_bf16 v[80:83], v[40:43], v[252:255], v[80:83]
    s_waitcnt lgkmcnt(4)
    v_mfma_f32_16x16x32_bf16 v[64:67], v[44:47], v[248:251], v[64:67]
    v_mfma_f32_16x16x32_bf16 v[84:87], v[44:47], v[252:255], v[84:87]
    s_waitcnt lgkmcnt(2)
    v_mfma_f32_16x16x32_bf16 v[68:71], v[48:51], v[248:251], v[68:71]
    v_mfma_f32_16x16x32_bf16 v[88:91], v[48:51], v[252:255], v[88:91]
    s_waitcnt lgkmcnt(0)
    v_mfma_f32_16x16x32_bf16 v[72:75], v[52:55], v[248:251], v[72:75]
    v_mfma_f32_16x16x32_bf16 v[92:95], v[52:55], v[252:255], v[92:95]
    s_mov_b32 s15, s56
    v_fma_f32 v16, v56, s10, v11
    v_fma_f32 v17, v57, s10, v11
    v_fma_f32 v18, v58, s10, v11
    v_fma_f32 v19, v59, s10, v11
    v_fma_f32 v20, v76, s10, v11
    v_fma_f32 v21, v77, s10, v11
    v_fma_f32 v22, v78, s10, v11
    v_fma_f32 v23, v79, s10, v11
    v_exp_f32_e64 v16, v16 clamp
    v_max_f32 v56, s11, v56
    v_exp_f32_e64 v17, v17 clamp
    v_max_f32 v57, s11, v57
    v_exp_f32_e64 v18, v18 clamp
    v_max_f32 v58, s11, v58
    v_exp_f32_e64 v19, v19 clamp
    v_max_f32 v59, s11, v59
    v_exp_f32_e64 v20, v20 clamp
    v_max_f32 v76, s11, v76
    v_exp_f32_e64 v21, v21 clamp
    v_max_f32 v77, s11, v77
    v_exp_f32_e64 v22, v22 clamp
    v_max_f32 v78, s11, v78
    v_exp_f32_e64 v23, v23 clamp
    v_max_f32 v79, s11, v79
    v_add_f32 v56, v56, v16
    v_add_f32 v57, v57, v17
    v_add_f32 v58, v58, v18
    v_add_f32 v59, v59, v19
    v_add_f32 v76, v76, v20
    v_add_f32 v77, v77, v21
    v_add_f32 v78, v78, v22
    v_add_f32 v79, v79, v23
    v_fma_f32 v16, v60, s10, v11
    v_fma_f32 v17, v61, s10, v11
    v_fma_f32 v18, v62, s10, v11
    v_fma_f32 v19, v63, s10, v11
    v_fma_f32 v20, v80, s10, v11
    v_fma_f32 v21, v81, s10, v11
    v_fma_f32 v22, v82, s10, v11
    v_fma_f32 v23, v83, s10, v11
    v_exp_f32_e64 v16, v16 clamp
    v_max_f32 v60, s11, v60
    v_exp_f32_e64 v17, v17 clamp
    v_max_f32 v61, s11, v61
    v_exp_f32_e64 v18, v18 clamp
    v_max_f32 v62, s11, v62
    v_exp_f32_e64 v19, v19 clamp
    v_max_f32 v63, s11, v63
    v_exp_f32_e64 v20, v20 clamp
    v_max_f32 v80, s11, v80
    v_exp_f32_e64 v21, v21 clamp
    v_max_f32 v81, s11, v81
    v_exp_f32_e64 v22, v22 clamp
    v_max_f32 v82, s11, v82
    v_exp_f32_e64 v23, v23 clamp
    v_max_f32 v83, s11, v83
    v_add_f32 v60, v60, v16
    v_add_f32 v61, v61, v17
    v_add_f32 v62, v62, v18
    v_add_f32 v63, v63, v19
    v_add_f32 v80, v80, v20
    v_add_f32 v81, v81, v21
    v_add_f32 v82, v82, v22
    v_add_f32 v83, v83, v23
    v_fma_f32 v16, v64, s10, v11
    v_fma_f32 v17, v65, s10, v11
    v_fma_f32 v18, v66, s10, v11
    v_fma_f32 v19, v67, s10, v11
    v_fma_f32 v20, v84, s10, v11
    v_fma_f32 v21, v85, s10, v11
    v_fma_f32 v22, v86, s10, v11
    v_fma_f32 v23, v87, s10, v11
    v_exp_f32_e64 v16, v16 clamp
    v_max_f32 v64, s11, v64
    v_exp_f32_e64 v17, v17 clamp
    v_max_f32 v65, s11, v65
    v_exp_f32_e64 v18, v18 clamp
    v_max_f32 v66, s11, v66
    v_exp_f32_e64 v19, v19 clamp
    v_max_f32 v67, s11, v67
    v_exp_f32_e64 v20, v20 clamp
    v_max_f32 v84, s11, v84
    v_exp_f32_e64 v21, v21 clamp
    v_max_f32 v85, s11, v85
    v_exp_f32_e64 v22, v22 clamp
    v_max_f32 v86, s11, v86
    v_exp_f32_e64 v23, v23 clamp
    v_max_f32 v87, s11, v87
    v_add_f32 v64, v64, v16
    v_add_f32 v65, v65, v17
    v_add_f32 v66, v66, v18
    v_add_f32 v67, v67, v19
    v_add_f32 v84, v84, v20
    v_add_f32 v85, v85, v21
    v_add_f32 v86, v86, v22
    v_add_f32 v87, v87, v23
    v_fma_f32 v16, v68, s10, v11
    v_fma_f32 v17, v69, s10, v11
    v_fma_f32 v18, v70, s10, v11
    v_fma_f32 v19, v71, s10, v11
    v_fma_f32 v20, v88, s10, v11
    v_fma_f32 v21, v89, s10, v11
    v_fma_f32 v22, v90, s10, v11
    v_fma_f32 v23, v91, s10, v11
    v_exp_f32_e64 v16, v16 clamp
    v_max_f32 v68, s11, v68
    v_exp_f32_e64 v17, v17 clamp
    v_max_f32 v69, s11, v69
    v_exp_f32_e64 v18, v18 clamp
    v_max_f32 v70, s11, v70
    v_exp_f32_e64 v19, v19 clamp
    v_max_f32 v71, s11, v71
    v_exp_f32_e64 v20, v20 clamp
    v_max_f32 v88, s11, v88
    v_exp_f32_e64 v21, v21 clamp
    v_max_f32 v89, s11, v89
    v_exp_f32_e64 v22, v22 clamp
    v_max_f32 v90, s11, v90
    v_exp_f32_e64 v23, v23 clamp
    v_max_f32 v91, s11, v91
    v_add_f32 v68, v68, v16
    v_add_f32 v69, v69, v17
    v_add_f32 v70, v70, v18
    v_add_f32 v71, v71, v19
    v_add_f32 v88, v88, v20
    v_add_f32 v89, v89, v21
    v_add_f32 v90, v90, v22
    v_add_f32 v91, v91, v23
    ds_read_b32 v24, v10
    ds_read_b128 v[160:163], v8 offset:8192
    ds_read_b128 v[164:167], v8 offset:9216
    ds_read_b128 v[168:171], v8 offset:10240
    ds_read_b128 v[172:175], v8 offset:11264
    ds_read_b128 v[128:131], v8 offset:0
    ds_read_b128 v[132:135], v8 offset:1024
    ds_read_b128 v[136:139], v8 offset:2048
    ds_read_b128 v[140:143], v8 offset:3072
    ds_read_b128 v[144:147], v8 offset:4096
    ds_read_b128 v[148:151], v8 offset:5120
    ds_read_b128 v[152:155], v8 offset:6144
    ds_read_b128 v[156:159], v8 offset:7168
    v_fma_f32 v16, v72, s10, v11
    v_fma_f32 v17, v73, s10, v11
    v_fma_f32 v18, v74, s10, v11
    v_fma_f32 v19, v75, s10, v11
    v_fma_f32 v20, v92, s10, v11
    v_fma_f32 v21, v93, s10, v11
    v_fma_f32 v22, v94, s10, v11
    v_fma_f32 v23, v95, s10, v11
    v_exp_f32_e64 v16, v16 clamp
    v_max_f32 v72, s11, v72
    v_exp_f32_e64 v17, v17 clamp
    v_max_f32 v73, s11, v73
    v_exp_f32_e64 v18, v18 clamp
    v_max_f32 v74, s11, v74
    v_exp_f32_e64 v19, v19 clamp
    v_max_f32 v75, s11, v75
    v_exp_f32_e64 v20, v20 clamp
    v_max_f32 v92, s11, v92
    v_exp_f32_e64 v21, v21 clamp
    v_max_f32 v93, s11, v93
    v_exp_f32_e64 v22, v22 clamp
    v_max_f32 v94, s11, v94
    v_exp_f32_e64 v23, v23 clamp
    v_max_f32 v95, s11, v95
    v_add_f32 v72, v72, v16
    v_add_f32 v73, v73, v17
    v_add_f32 v74, v74, v18
    v_add_f32 v75, v75, v19
    v_add_f32 v92, v92, v20
    v_add_f32 v93, v93, v21
    v_add_f32 v94, v94, v22
    v_add_f32 v95, v95, v23
    v_cvt_pk_bf16_f32 v96, v56, v57
    v_cvt_pk_bf16_f32 v98, v72, v73
    v_cvt_pk_bf16_f32 v97, v58, v59
    v_cvt_pk_bf16_f32 v99, v74, v75
    v_cvt_pk_bf16_f32 v100, v60, v61
    v_cvt_pk_bf16_f32 v102, v72, v73
    v_cvt_pk_bf16_f32 v101, v62, v63
    v_cvt_pk_bf16_f32 v103, v74, v75
    v_cvt_pk_bf16_f32 v104, v64, v65
    v_cvt_pk_bf16_f32 v106, v72, v73
    v_cvt_pk_bf16_f32 v105, v66, v67
    v_cvt_pk_bf16_f32 v107, v74, v75
    v_cvt_pk_bf16_f32 v108, v68, v69
    v_cvt_pk_bf16_f32 v110, v72, v73
    v_cvt_pk_bf16_f32 v109, v70, v71
    v_cvt_pk_bf16_f32 v111, v74, v75
    v_cvt_pk_bf16_f32 v112, v76, v77
    v_cvt_pk_bf16_f32 v114, v92, v93
    v_cvt_pk_bf16_f32 v113, v78, v79
    v_cvt_pk_bf16_f32 v115, v94, v95
    v_cvt_pk_bf16_f32 v116, v80, v81
    v_cvt_pk_bf16_f32 v118, v92, v93
    v_cvt_pk_bf16_f32 v117, v82, v83
    v_cvt_pk_bf16_f32 v119, v94, v95
    v_cvt_pk_bf16_f32 v120, v84, v85
    v_cvt_pk_bf16_f32 v122, v92, v93
    v_cvt_pk_bf16_f32 v121, v86, v87
    v_cvt_pk_bf16_f32 v123, v94, v95
    v_cvt_pk_bf16_f32 v124, v88, v89
    v_cvt_pk_bf16_f32 v126, v92, v93
    v_cvt_pk_bf16_f32 v125, v90, v91
    v_cvt_pk_bf16_f32 v127, v94, v95
    s_waitcnt lgkmcnt(12)
    v_cmp_gt_u32 vcc, 1, v24
    s_setprio 3
    s_cbranch_vccz L_ld_have
L_rl_3:
    v_cmp_gt_u32 vcc, 1, v24
    s_and_b32 s63, vcc_lo, 0xff
    s_cbranch_scc0 L_rd_4
    ds_read_b32 v24, v10
    s_waitcnt lgkmcnt(0)
    s_branch L_rl_3
L_rd_4:
    ds_read_b128 v[160:163], v8 offset:8192
    ds_read_b128 v[164:167], v8 offset:9216
    ds_read_b128 v[168:171], v8 offset:10240
    ds_read_b128 v[172:175], v8 offset:11264
    ds_read_b128 v[128:131], v8 offset:0
    ds_read_b128 v[132:135], v8 offset:1024
    ds_read_b128 v[136:139], v8 offset:2048
    ds_read_b128 v[140:143], v8 offset:3072
    ds_read_b128 v[144:147], v8 offset:4096
    ds_read_b128 v[148:151], v8 offset:5120
    ds_read_b128 v[152:155], v8 offset:6144
    ds_read_b128 v[156:159], v8 offset:7168
L_ld_have:
    s_cmp_lg_u32 s15, 4
    s_cbranch_scc1 L_one_5
    s_mov_b64 exec, 1
    buffer_store_dword v9, v1, s[44:47], s60 offen sc1
    s_mov_b64 exec, -1
L_one_5:
    s_waitcnt lgkmcnt(11)
    v_mfma_f32_16x16x32_bf16 v[196:199], v[160:163], v[96:99], v[12:15]
    s_waitcnt lgkmcnt(10)
    v_mfma_f32_16x16x32_bf16 v[196:199], v[164:167], v[100:103], v[196:199]
    s_waitcnt lgkmcnt(9)
    v_mfma_f32_16x16x32_bf16 v[196:199], v[168:171], v[104:107], v[196:199]
    s_waitcnt lgkmcnt(8)
    v_mfma_f32_16x16x32_bf16 v[196:199], v[172:175], v[108:111], v[196:199]
    s_waitcnt lgkmcnt(7)
    v_mfma_f32_16x16x32_bf16 v[176:179], v[128:131], v[96:99], 0
    s_waitcnt lgkmcnt(6)
    v_mfma_f32_16x16x32_bf16 v[180:183], v[132:135], v[100:103], 0
    s_waitcnt lgkmcnt(5)
    v_mfma_f32_16x16x32_bf16 v[184:187], v[136:139], v[104:107], 0
    s_waitcnt lgkmcnt(4)
    v_mfma_f32_16x16x32_bf16 v[188:191], v[140:143], v[108:111], 0
    s_waitcnt lgkmcnt(3)
    v_mfma_f32_16x16x32_bf16 v[192:195], v[144:147], v[96:99], 0
    s_waitcnt lgkmcnt(2)
    v_mfma_f32_16x16x32_bf16 v[192:195], v[148:151], v[100:103], v[192:195]
    s_waitcnt lgkmcnt(1)
    v_mfma_f32_16x16x32_bf16 v[192:195], v[152:155], v[104:107], v[192:195]
    s_waitcnt lgkmcnt(0)
    v_mfma_f32_16x16x32_bf16 v[192:195], v[156:159], v[108:111], v[192:195]
    v_mfma_f32_16x16x32_bf16 v[220:223], v[160:163], v[112:115], v[12:15]
    v_mfma_f32_16x16x32_bf16 v[220:223], v[164:167], v[116:119], v[220:223]
    v_mfma_f32_16x16x32_bf16 v[220:223], v[168:171], v[120:123], v[220:223]
    v_mfma_f32_16x16x32_bf16 v[220:223], v[172:175], v[124:127], v[220:223]
    v_mfma_f32_16x16x32_bf16 v[200:203], v[128:131], v[112:115], 0
    v_mfma_f32_16x16x32_bf16 v[204:207], v[132:135], v[116:119], 0
    v_mfma_f32_16x16x32_bf16 v[208:211], v[136:139], v[120:123], 0
    v_mfma_f32_16x16x32_bf16 v[212:215], v[140:143], v[124:127], 0
    v_mfma_f32_16x16x32_bf16 v[216:219], v[144:147], v[112:115], 0
    v_mfma_f32_16x16x32_bf16 v[216:219], v[148:151], v[116:119], v[216:219]
    v_mfma_f32_16x16x32_bf16 v[216:219], v[152:155], v[120:123], v[216:219]
    v_mfma_f32_16x16x32_bf16 v[216:219], v[156:159], v[124:127], v[216:219]
    v_rcp_f32 v196, v196
    v_rcp_f32 v197, v197
    v_rcp_f32 v198, v198
    v_rcp_f32 v199, v199
    v_mul_f32 v176, v176, v196
    v_mul_f32 v177, v177, v196
    v_mul_f32 v178, v178, v196
    v_mul_f32 v179, v179, v196
    v_mul_f32 v180, v180, v197
    v_mul_f32 v181, v181, v197
    v_mul_f32 v182, v182, v197
    v_mul_f32 v183, v183, v197
    v_mul_f32 v184, v184, v198
    v_mul_f32 v185, v185, v198
    v_mul_f32 v186, v186, v198
    v_mul_f32 v187, v187, v198
    v_mul_f32 v188, v188, v199
    v_mul_f32 v189, v189, v199
    v_mul_f32 v190, v190, v199
    v_mul_f32 v191, v191, v199
    v_mov_b32_dpp v196, v197 quad_perm:[0,1,2,3] row_mask:0x2 bank_mask:0xf
    s_nop 1
    v_mov_b32_dpp v196, v198 quad_perm:[0,1,2,3] row_mask:0x4 bank_mask:0xf
    s_nop 1
    v_mov_b32_dpp v196, v199 quad_perm:[0,1,2,3] row_mask:0x8 bank_mask:0xf
    v_cvt_pk_bf16_f32 v16, v176, v177
    v_cvt_pk_bf16_f32 v17, v178, v179
    v_cvt_pk_bf16_f32 v18, v180, v181
    v_cvt_pk_bf16_f32 v19, v182, v183
    v_cvt_pk_bf16_f32 v20, v184, v185
    v_cvt_pk_bf16_f32 v21, v186, v187
    v_cvt_pk_bf16_f32 v22, v188, v189
    v_cvt_pk_bf16_f32 v23, v190, v191
    v_mul_f32 v192, v192, v196
    v_mul_f32 v193, v193, v196
    v_mul_f32 v194, v194, v196
    v_mul_f32 v195, v195, v196
    buffer_store_dwordx4 v[16:19], v6, s[44:47], s4 offen sc1
    buffer_store_dwordx4 v[20:23], v6, s[44:47], s4 offen offset:1024 sc1
    v_cvt_pk_bf16_f32 v24, v192, v193
    v_cvt_pk_bf16_f32 v25, v194, v195
    buffer_store_dwordx2 v[24:25], v7, s[44:47], s5 offen sc1
    v_rcp_f32 v220, v220
    v_rcp_f32 v221, v221
    v_rcp_f32 v222, v222
    v_rcp_f32 v223, v223
    v_mul_f32 v200, v200, v220
    v_mul_f32 v201, v201, v220
    v_mul_f32 v202, v202, v220
    v_mul_f32 v203, v203, v220
    v_mul_f32 v204, v204, v221
    v_mul_f32 v205, v205, v221
    v_mul_f32 v206, v206, v221
    v_mul_f32 v207, v207, v221
    v_mul_f32 v208, v208, v222
    v_mul_f32 v209, v209, v222
    v_mul_f32 v210, v210, v222
    v_mul_f32 v211, v211, v222
    v_mul_f32 v212, v212, v223
    v_mul_f32 v213, v213, v223
    v_mul_f32 v214, v214, v223
    v_mul_f32 v215, v215, v223
    v_mov_b32_dpp v220, v221 quad_perm:[0,1,2,3] row_mask:0x2 bank_mask:0xf
    s_nop 1
    v_mov_b32_dpp v220, v222 quad_perm:[0,1,2,3] row_mask:0x4 bank_mask:0xf
    s_nop 1
    v_mov_b32_dpp v220, v223 quad_perm:[0,1,2,3] row_mask:0x8 bank_mask:0xf
    v_cvt_pk_bf16_f32 v28, v200, v201
    v_cvt_pk_bf16_f32 v29, v202, v203
    v_cvt_pk_bf16_f32 v30, v204, v205
    v_cvt_pk_bf16_f32 v31, v206, v207
    v_cvt_pk_bf16_f32 v32, v208, v209
    v_cvt_pk_bf16_f32 v33, v210, v211
    v_cvt_pk_bf16_f32 v34, v212, v213
    v_cvt_pk_bf16_f32 v35, v214, v215
    v_mul_f32 v216, v216, v220
    v_mul_f32 v217, v217, v220
    v_mul_f32 v218, v218, v220
    v_mul_f32 v219, v219, v220
    buffer_store_dwordx4 v[28:31], v6, s[44:47], s6 offen sc1
    buffer_store_dwordx4 v[32:35], v6, s[44:47], s6 offen offset:1024 sc1
    v_cvt_pk_bf16_f32 v36, v216, v217
    v_cvt_pk_bf16_f32 v37, v218, v219
    buffer_store_dwordx2 v[36:37], v7, s[44:47], s7 offen sc1
    v_mov_b32 v9, 5
    s_mov_b64 exec, s[12:13]
    ds_write_b32 v10, v9
    s_mov_b64 exec, -1
    s_waitcnt lgkmcnt(0)
    s_endpgm
L_compute:
    v_mov_b32 v1, 0
    v_mov_b32 v2, 1
    v_mul_u32_u24 v172, 1280, v0
    v_mul_u32_u24 v173, 3840, v0
    s_mov_b32 s34, 2621440
    s_mov_b32 s35, 0x20000
    s_mov_b32 s38, 2457600
    s_mov_b32 s39, 0x20000
    s_mov_b32 s46, 268435456
    s_mov_b32 s47, 0x20000
    s_mov_b32 s42, 819200
    s_mov_b32 s43, 0x20000
    s_mov_b32 s50, 256
    s_mov_b32 s51, 0x20000
    s_mov_b32 s54, 2621440
    s_mov_b32 s55, 0x20000
    s_waitcnt lgkmcnt(0)
    s_mov_b64 s[32:33], s[4:5]
    s_mov_b64 s[36:37], s[6:7]
    s_mov_b64 s[44:45], s[30:31]
    s_mov_b64 s[40:41], s[8:9]
    s_mov_b64 s[48:49], s[28:29]
    s_mov_b64 s[52:53], s[26:27]
    s_lshl_b32 s67, s56, 4
    s_add_u32 s67, s67, s58
    s_lshl_b32 s67, s62, 2
    s_add_u32 s67, s67, s56
    s_lshl_b32 s67, s67, 14
    s_add_u32 s67, s67, 1048576
    s_lshl_b32 s8, s61, 10
    s_add_u32 s8, s8, s67
    s_lshl_b32 s60, s62, 11
    s_add_u32 s60, s60, 8396800
    v_lshlrev_b32 v171, 7, v0
    v_add_u32 v21, s60, v171
    s_lshl_b32 s63, s61, 7
    s_add_u32 s60, s60, s63
    s_lshr_b32 s68, s56, 1
    s_and_b32 s69, s56, 1
    v_and_b32 v174, 15, v0
    v_ashrrev_i32 v175, 4, v0
    v_mov_b32 v171, s68
    v_lshlrev_b32 v171, 6, v171
    v_add_u32 v171, v171, v174
    v_lshlrev_b32 v171, 7, v171
    v_add_u32 v170, 0, v175
    v_ashrrev_i32 v169, 1, v174
    v_xor_b32 v169, v170, v169
    v_lshlrev_b32 v169, 4, v169
    v_add_u32 v6, v171, v169
    v_add_u32 v8, 73760, v6
    v_mov_b32 v169, s68
    v_lshlrev_b32 v169, 6, v169
    v_add_u32 v169, v169, v174
    v_lshlrev_b32 v169, 7, v169
    v_add_u32 v171, 4, v175
    v_ashrrev_i32 v170, 1, v174
    v_xor_b32 v170, v171, v170
    v_lshlrev_b32 v170, 4, v170
    v_add_u32 v7, v169, v170
    v_add_u32 v9, 73760, v7
    v_lshlrev_b32 v170, 3, v175
    v_and_b32 v169, 1, v175
    v_xor_b32 v169, 0, v169
    v_lshlrev_b32 v169, 2, v169
    v_add_u32 v169, v170, v169
    v_ashrrev_i32 v170, 2, v174
    v_add_u32 v170, v169, v170
    v_mul_u32_u24 v170, 160, v170
    v_mov_b32 v169, s69
    v_mul_u32_u24 v169, 80, v169
    v_add_u32 v169, v170, v169
    v_add_u32 v172, 16384, v169
    v_and_b32 v169, 3, v174
    v_lshlrev_b32 v169, 3, v169
    v_add_u32 v10, v172, v169
    v_add_u32 v169, 32, v172
    v_and_b32 v170, 1, v174
    v_mul_u32_u24 v170, 40, v170
    v_add_u32 v170, v169, v170
    v_ashrrev_i32 v169, 1, v174
    v_and_b32 v169, 1, v169
    v_mul_u32_u24 v169, 10256, v169
    v_add_u32 v14, v170, v169
    v_add_u32 v12, 73760, v10
    v_add_u32 v16, 73760, v14
    v_lshlrev_b32 v169, 3, v175
    v_and_b32 v170, 1, v175
    v_xor_b32 v170, 1, v170
    v_lshlrev_b32 v170, 2, v170
    v_add_u32 v170, v169, v170
    v_ashrrev_i32 v169, 2, v174
    v_add_u32 v169, v170, v169
    v_mul_u32_u24 v169, 160, v169
    v_mov_b32 v170, s69
    v_mul_u32_u24 v170, 80, v170
    v_add_u32 v170, v169, v170
    v_add_u32 v172, 16384, v170
    v_and_b32 v170, 3, v174
    v_lshlrev_b32 v170, 3, v170
    v_add_u32 v11, v172, v170
    v_add_u32 v170, 32, v172
    v_and_b32 v169, 1, v174
    v_mul_u32_u24 v169, 40, v169
    v_add_u32 v169, v170, v169
    v_ashrrev_i32 v170, 1, v174
    v_and_b32 v170, 1, v170
    v_mul_u32_u24 v170, 10256, v170
    v_add_u32 v15, v169, v170
    v_add_u32 v13, 73760, v11
    v_add_u32 v17, 73760, v15
    v_lshlrev_b32 v20, 4, v0
    s_movk_i32 s64, 1120
    v_mul_u32_u24 v25, 6554, v0
    v_lshlrev_b32 v26, 4, v0
    v_lshrrev_b32 v22, 16, v25
    v_add_u32 v25, 419456, v25
    v_mad_u32_u24 v22, v22, s64, v26
    v_add_u32 v26, 1024, v26
    v_lshrrev_b32 v23, 16, v25
    v_add_u32 v25, 419456, v25
    v_mad_u32_u24 v23, v23, s64, v26
    v_add_u32 v26, 1024, v26
    v_lshrrev_b32 v24, 16, v25
    v_add_u32 v25, 419456, v25
    v_mad_u32_u24 v24, v24, s64, v26
    v_add_u32 v26, 1024, v26
    v_ashrrev_i32 v170, 16, v25
    v_mul_u32_u24 v170, 1120, v170
    v_add_u32 v25, v170, v26
    v_add_u32 v170, 256, v0
    v_mul_u32_u24 v170, 6554, v170
    v_ashrrev_i32 v170, 16, v170
    v_mul_u32_u24 v170, 1120, v170
    v_add_u32 v170, v170, v26
    v_add_u32 v26, 1024, v170
    v_mov_b32 v170, s69
    v_lshlrev_b32 v170, 1, v170
    v_ashrrev_i32 v169, 2, v174
    v_and_b32 v169, 1, v169
    v_add_u32 v172, v170, v169
    v_add_u32 v169, 8, v172
    v_lshlrev_b32 v169, 6, v169
    v_and_b32 v170, 3, v174
    v_lshlrev_b32 v170, 2, v170
    v_add_u32 v170, v169, v170
    v_add_u32 v170, v170, v172
    v_add_u32 v169, 4, v172
    v_lshlrev_b32 v169, 6, v169
    v_lshlrev_b32 v171, 2, v172
    v_add_u32 v171, v169, v171
    v_and_b32 v169, 3, v174
    v_add_u32 v169, v171, v169
    v_cmp_gt_i32 vcc, 8, v174
    s_nop 1
    v_cndmask_b32 v173, v169, v170, vcc
    v_mov_b32 v169, s69
    v_lshlrev_b32 v169, 7, v169
    v_add_u32 v169, v169, v0
    v_lshlrev_b32 v170, 4, v175
    v_add_u32 v170, v173, v170
    v_mov_b32 v171, s68
    v_cmp_eq_i32 vcc, 0, v171
    s_nop 1
    v_cndmask_b32 v170, v170, v169, vcc
    v_lshlrev_b32 v170, 4, v170
    v_add_u32 v18, 147520, v170
    v_mov_b32 v170, s69
    v_lshlrev_b32 v170, 1, v170
    v_and_b32 v169, 1, v175
    v_add_u32 v172, v170, v169
    v_add_u32 v169, 4, v172
    v_lshlrev_b32 v169, 6, v169
    v_mul_u32_u24 v170, 20, v172
    v_add_u32 v170, v169, v170
    v_and_b32 v169, 3, v174
    v_add_u32 v169, v170, v169
    v_ashrrev_i32 v170, 1, v0
    v_add_u32 v170, 768, v170
    v_ashrrev_i32 v171, 2, v174
    v_cmp_eq_i32 vcc, v171, v175
    s_nop 1
    v_cndmask_b32 v173, v170, v169, vcc
    v_add_u32 v170, 8, v172
    v_lshlrev_b32 v170, 6, v170
    v_lshlrev_b32 v169, 2, v174
    v_add_u32 v169, v170, v169
    v_mul_u32_u24 v170, 17, v172
    v_add_u32 v170, v169, v170
    v_cmp_gt_i32 vcc, 4, v174
    s_nop 1
    v_cndmask_b32 v173, v173, v170, vcc
    v_mul_u32_u24 v170, 80, v172
    v_add_u32 v170, v170, v174
    v_cmp_gt_i32 vcc, 2, v175
    s_nop 1
    v_cndmask_b32 v173, v173, v170, vcc
    v_mov_b32 v170, s69
    v_lshlrev_b32 v170, 7, v170
    v_add_u32 v170, 64, v170
    v_add_u32 v170, v170, v0
    v_lshlrev_b32 v170, 4, v170
    v_lshlrev_b32 v169, 4, v173
    v_add_u32 v169, 8, v169
    v_mov_b32 v171, s68
    v_cmp_eq_i32 vcc, 0, v171
    s_nop 1
    v_cndmask_b32 v169, v169, v170, vcc
    v_add_u32 v19, 147520, v169
    v_mov_b32 v5, 3049366176
    v_mov_b32 v169, 897988541
    v_mov_b32 v170, 0
    v_cmp_gt_i32 vcc, 8, v174
    s_nop 1
    v_cndmask_b32 v32, v170, v169, vcc
    v_mov_b32 v28, s11
    v_mov_b32 v29, s11
    v_mov_b32 v33, v32
    v_mov_b32 v30, s11
    v_mov_b32 v34, v32
    v_mov_b32 v31, s11
    v_mov_b32 v35, v32
    v_and_b32 v170, 1, v174
    v_lshlrev_b32 v170, 4, v170
    v_mov_b32 v169, 16256
    v_lshlrev_b32 v170, v170, v169
    v_mov_b32 v169, 0
    v_ashrrev_i32 v171, 2, v174
    v_cmp_eq_i32 vcc, v171, v175
    s_nop 1
    v_cndmask_b32 v172, v169, v170, vcc
    v_mov_b32 v169, 0
    v_and_b32 v170, 2, v174
    v_cmp_eq_i32 vcc, 0, v170
    s_nop 1
    v_cndmask_b32 v38, v169, v172, vcc
    v_mov_b32 v169, 0
    v_and_b32 v170, 2, v174
    v_cmp_ne_i32 vcc, 0, v170
    s_nop 1
    v_cndmask_b32 v39, v169, v172, vcc
    v_mov_b32 v40, v38
    v_mov_b32 v41, v39
    v_mov_b32 v36, 0
    v_mov_b32 v37, 0
    v_mov_b32 v42, 0
    v_mov_b32 v43, 0
    v_mov_b32 v169, 1065369472
    v_mov_b32 v170, 0
    v_cmp_gt_i32 vcc, 4, v174
    s_nop 1
    v_cndmask_b32 v172, v170, v169, vcc
    v_mov_b32 v170, 1065369472
    v_mov_b32 v169, 0
    v_ashrrev_i32 v171, 2, v174
    v_cmp_eq_i32 vcc, 1, v171
    s_nop 1
    v_cndmask_b32 v173, v169, v170, vcc
    v_mov_b32 v44, 0
    v_mov_b32 v45, 0
    v_mov_b32 v46, 0
    v_mov_b32 v47, 0
    v_mov_b32 v48, 0
    v_mov_b32 v49, 0
    v_mov_b32 v50, 0
    v_mov_b32 v51, 0
    v_mov_b32 v52, 0
    v_mov_b32 v53, 0
    v_mov_b32 v54, 0
    v_mov_b32 v55, 0
    v_mov_b32 v56, v172
    v_mov_b32 v57, v172
    v_mov_b32 v58, v172
    v_mov_b32 v59, v172
    v_mov_b32 v60, v173
    v_mov_b32 v61, v173
    v_mov_b32 v62, v173
    v_mov_b32 v63, v173
    v_mov_b32 v64, 0
    v_mov_b32 v65, 0
    v_mov_b32 v66, 0
    v_mov_b32 v67, 0
    v_mov_b32 v68, 0
    v_mov_b32 v69, 0
    v_mov_b32 v70, 0
    v_mov_b32 v71, 0
    v_mov_b32 v72, 0
    v_mov_b32 v73, 0
    v_mov_b32 v74, 0
    v_mov_b32 v75, 0
    v_mov_b32 v76, v172
    v_mov_b32 v77, v172
    v_mov_b32 v78, v172
    v_mov_b32 v79, v172
    v_mov_b32 v80, v173
    v_mov_b32 v81, v173
    v_mov_b32 v82, v173
    v_mov_b32 v83, v173
    v_mov_b32 v169, s56
    v_mul_u32_u24 v169, 3072, v169
    v_add_u32 v169, v20, v169
    v_add_u32 v172, 147520, v169
    ds_write_b128 v172, v[44:47] offset:0
    ds_write_b128 v172, v[44:47] offset:1024
    ds_write_b128 v172, v[44:47] offset:2048
    v_and_b32 v169, 7, v0
    v_lshlrev_b32 v169, 2, v169
    v_add_u32 v27, 163808, v169
    ds_write_b32 v27, v1
    v_subrev_u32 v174, 32, v27
    s_lshl_b64 s[12:13], 1, s56
    ds_write_b32 v174, v1
    s_waitcnt lgkmcnt(0)
    s_mul_i32 s63, s69, -4096
    s_mul_i32 s64, s69, 14880
    s_add_u32 s63, s63, 34816
    s_add_u32 s64, s64, 145440
    s_cmp_eq_u32 s68, 0
    s_cselect_b32 s65, s63, s64
    s_cselect_b32 s64, s64, s63
    v_add_u32 v172, s64, v20
    v_add_u32 v173, s65, v20
    s_setprio 2
    v_mov_b32 v156, -1
    v_mov_b32 v157, -1
    v_mov_b32 v158, -1
    v_mov_b32 v159, -1
    buffer_store_dwordx4 v[156:159], v20, s[44:47], s8 offen sc1
    s_barrier
    ds_read_b128 v[84:87], v6 offset:0
    ds_read_b128 v[88:91], v6 offset:2048
    ds_read_b128 v[92:95], v6 offset:4096
    ds_read_b128 v[96:99], v6 offset:6144
    ds_read_b64_tr_b16 v[100:101], v10 offset:0
    ds_read_b64_tr_b16 v[102:103], v11 offset:0
    ds_read_b64_tr_b16 v[104:105], v10 offset:40
    ds_read_b64_tr_b16 v[106:107], v11 offset:40
    ds_read_b64_tr_b16 v[108:109], v10 offset:10256
    ds_read_b64_tr_b16 v[110:111], v11 offset:10256
    ds_read_b64_tr_b16 v[112:113], v10 offset:10296
    ds_read_b64_tr_b16 v[114:115], v11 offset:10296
    ds_read_b64_tr_b16 v[116:117], v14 offset:0
    ds_read_b64_tr_b16 v[118:119], v15 offset:0
    s_waitcnt lgkmcnt(0)
    v_mfma_f32_16x16x32_bf16 v[176:179], v[84:87], v[100:103], v[28:31]
    ds_read_b128 v[120:123], v7 offset:0
    ds_read_b128 v[124:127], v7 offset:2048
    v_mfma_f32_16x16x32_bf16 v[196:199], v[88:91], v[100:103], v[28:31]
    ds_read_b128 v[128:131], v7 offset:4096
    ds_read_b128 v[132:135], v7 offset:6144
    v_mfma_f32_16x16x32_bf16 v[216:219], v[92:95], v[100:103], v[28:31]
    ds_read_b64_tr_b16 v[136:137], v10 offset:5120
    ds_read_b64_tr_b16 v[138:139], v11 offset:5120
    v_mfma_f32_16x16x32_bf16 v[236:239], v[96:99], v[100:103], v[28:31]
    ds_read_b64_tr_b16 v[140:141], v10 offset:5160
    ds_read_b64_tr_b16 v[142:143], v11 offset:5160
    v_mfma_f32_16x16x32_bf16 v[180:183], v[84:87], v[104:107], v[28:31]
    ds_read_b64_tr_b16 v[144:145], v10 offset:15376
    ds_read_b64_tr_b16 v[146:147], v11 offset:15376
    v_mfma_f32_16x16x32_bf16 v[200:203], v[88:91], v[104:107], v[28:31]
    ds_read_b64_tr_b16 v[148:149], v10 offset:15416
    ds_read_b64_tr_b16 v[150:151], v11 offset:15416
    v_mfma_f32_16x16x32_bf16 v[220:223], v[92:95], v[104:107], v[28:31]
    ds_read_b64_tr_b16 v[152:153], v14 offset:5120
    ds_read_b64_tr_b16 v[154:155], v15 offset:5120
    v_mfma_f32_16x16x32_bf16 v[240:243], v[96:99], v[104:107], v[28:31]
    v_mfma_f32_16x16x32_bf16 v[192:195], v[84:87], v[116:119], v[32:35]
    v_mfma_f32_16x16x32_bf16 v[212:215], v[88:91], v[116:119], v[32:35]
    v_mfma_f32_16x16x32_bf16 v[232:235], v[92:95], v[116:119], v[32:35]
    v_mfma_f32_16x16x32_bf16 v[252:255], v[96:99], v[116:119], v[32:35]
    v_mfma_f32_16x16x32_bf16 v[184:187], v[84:87], v[108:111], 0
    v_mfma_f32_16x16x32_bf16 v[204:207], v[88:91], v[108:111], 0
    v_mfma_f32_16x16x32_bf16 v[224:227], v[92:95], v[108:111], 0
    v_mfma_f32_16x16x32_bf16 v[244:247], v[96:99], v[108:111], 0
    v_mfma_f32_16x16x32_bf16 v[188:191], v[84:87], v[112:115], 0
    v_mfma_f32_16x16x32_bf16 v[208:211], v[88:91], v[112:115], 0
    v_mfma_f32_16x16x32_bf16 v[228:231], v[92:95], v[112:115], 0
    s_waitcnt lgkmcnt(0)
    s_barrier
    v_mfma_f32_16x16x32_bf16 v[248:251], v[96:99], v[112:115], 0
    v_mfma_f32_16x16x32_bf16 v[176:179], v[120:123], v[136:139], v[176:179]
    ds_read_b128 v[84:87], v6 offset:36880
    ds_read_b128 v[88:91], v6 offset:38928
    v_mfma_f32_16x16x32_bf16 v[196:199], v[124:127], v[136:139], v[196:199]
    ds_read_b128 v[92:95], v6 offset:40976
    ds_read_b128 v[96:99], v6 offset:43024
    v_mfma_f32_16x16x32_bf16 v[216:219], v[128:131], v[136:139], v[216:219]
    ds_read_b64_tr_b16 v[100:101], v10 offset:36880
    ds_read_b64_tr_b16 v[102:103], v11 offset:36880
    v_mfma_f32_16x16x32_bf16 v[236:239], v[132:135], v[136:139], v[236:239]
    ds_read_b64_tr_b16 v[104:105], v10 offset:36920
    ds_read_b64_tr_b16 v[106:107], v11 offset:36920
    v_mfma_f32_16x16x32_bf16 v[180:183], v[120:123], v[140:143], v[180:183]
    ds_read_b64_tr_b16 v[108:109], v10 offset:47136
    ds_read_b64_tr_b16 v[110:111], v11 offset:47136
    v_mfma_f32_16x16x32_bf16 v[200:203], v[124:127], v[140:143], v[200:203]
    ds_read_b64_tr_b16 v[112:113], v10 offset:47176
    ds_read_b64_tr_b16 v[114:115], v11 offset:47176
    v_mfma_f32_16x16x32_bf16 v[220:223], v[128:131], v[140:143], v[220:223]
    ds_read_b64_tr_b16 v[116:117], v14 offset:36880
    ds_read_b64_tr_b16 v[118:119], v15 offset:36880
    v_mfma_f32_16x16x32_bf16 v[240:243], v[132:135], v[140:143], v[240:243]
    v_mfma_f32_16x16x32_bf16 v[192:195], v[120:123], v[152:155], v[192:195]
    v_mfma_f32_16x16x32_bf16 v[212:215], v[124:127], v[152:155], v[212:215]
    v_mfma_f32_16x16x32_bf16 v[232:235], v[128:131], v[152:155], v[232:235]
    v_mfma_f32_16x16x32_bf16 v[252:255], v[132:135], v[152:155], v[252:255]
    v_mfma_f32_16x16x32_bf16 v[184:187], v[120:123], v[144:147], v[184:187]
    v_mfma_f32_16x16x32_bf16 v[204:207], v[124:127], v[144:147], v[204:207]
    v_mfma_f32_16x16x32_bf16 v[224:227], v[128:131], v[144:147], v[224:227]
    v_mfma_f32_16x16x32_bf16 v[244:247], v[132:135], v[144:147], v[244:247]
    v_mfma_f32_16x16x32_bf16 v[188:191], v[120:123], v[148:151], v[188:191]
    v_mfma_f32_16x16x32_bf16 v[208:211], v[124:127], v[148:151], v[208:211]
    v_mfma_f32_16x16x32_bf16 v[228:231], v[128:131], v[148:151], v[228:231]
    s_waitcnt lgkmcnt(0)
    v_mfma_f32_16x16x32_bf16 v[248:251], v[132:135], v[148:151], v[248:251]
    v_mfma_f32_16x16x32_bf16 v[176:179], v[84:87], v[100:103], v[176:179]
    ds_read_b128 v[120:123], v7 offset:36880
    ds_read_b128 v[124:127], v7 offset:38928
    v_mfma_f32_16x16x32_bf16 v[196:199], v[88:91], v[100:103], v[196:199]
    ds_read_b128 v[128:131], v7 offset:40976
    ds_read_b128 v[132:135], v7 offset:43024
    v_mfma_f32_16x16x32_bf16 v[216:219], v[92:95], v[100:103], v[216:219]
    ds_read_b64_tr_b16 v[136:137], v10 offset:42000
    ds_read_b64_tr_b16 v[138:139], v11 offset:42000
    v_mfma_f32_16x16x32_bf16 v[236:239], v[96:99], v[100:103], v[236:239]
    ds_read_b64_tr_b16 v[140:141], v10 offset:42040
    ds_read_b64_tr_b16 v[142:143], v11 offset:42040
    v_mfma_f32_16x16x32_bf16 v[180:183], v[84:87], v[104:107], v[180:183]
    ds_read_b64_tr_b16 v[144:145], v10 offset:52256
    ds_read_b64_tr_b16 v[146:147], v11 offset:52256
    v_mfma_f32_16x16x32_bf16 v[200:203], v[88:91], v[104:107], v[200:203]
    ds_read_b64_tr_b16 v[148:149], v10 offset:52296
    ds_read_b64_tr_b16 v[150:151], v11 offset:52296
    v_mfma_f32_16x16x32_bf16 v[220:223], v[92:95], v[104:107], v[220:223]
    ds_read_b64_tr_b16 v[152:153], v14 offset:42000
    ds_read_b64_tr_b16 v[154:155], v15 offset:42000
    v_mfma_f32_16x16x32_bf16 v[240:243], v[96:99], v[104:107], v[240:243]
    v_mfma_f32_16x16x32_bf16 v[192:195], v[84:87], v[116:119], v[192:195]
    v_mfma_f32_16x16x32_bf16 v[212:215], v[88:91], v[116:119], v[212:215]
    v_mfma_f32_16x16x32_bf16 v[232:235], v[92:95], v[116:119], v[232:235]
    v_mfma_f32_16x16x32_bf16 v[252:255], v[96:99], v[116:119], v[252:255]
    v_mfma_f32_16x16x32_bf16 v[184:187], v[84:87], v[108:111], v[184:187]
    v_mfma_f32_16x16x32_bf16 v[204:207], v[88:91], v[108:111], v[204:207]
    v_mfma_f32_16x16x32_bf16 v[224:227], v[92:95], v[108:111], v[224:227]
    v_mfma_f32_16x16x32_bf16 v[244:247], v[96:99], v[108:111], v[244:247]
    v_mfma_f32_16x16x32_bf16 v[188:191], v[84:87], v[112:115], v[188:191]
    v_mfma_f32_16x16x32_bf16 v[208:211], v[88:91], v[112:115], v[208:211]
    v_mfma_f32_16x16x32_bf16 v[228:231], v[92:95], v[112:115], v[228:231]
    s_waitcnt lgkmcnt(0)
    s_barrier
    v_mfma_f32_16x16x32_bf16 v[248:251], v[96:99], v[112:115], v[248:251]
    v_mfma_f32_16x16x32_bf16 v[176:179], v[120:123], v[136:139], v[176:179]
    ds_read_b128 v[84:87], v8 offset:0
    ds_read_b128 v[88:91], v8 offset:2048
    v_mfma_f32_16x16x32_bf16 v[196:199], v[124:127], v[136:139], v[196:199]
    ds_read_b128 v[92:95], v8 offset:4096
    ds_read_b128 v[96:99], v8 offset:6144
    v_mfma_f32_16x16x32_bf16 v[216:219], v[128:131], v[136:139], v[216:219]
    ds_read_b64_tr_b16 v[100:101], v12 offset:0
    ds_read_b64_tr_b16 v[102:103], v13 offset:0
    v_mfma_f32_16x16x32_bf16 v[236:239], v[132:135], v[136:139], v[236:239]
    ds_read_b64_tr_b16 v[104:105], v12 offset:40
    ds_read_b64_tr_b16 v[106:107], v13 offset:40
    v_mfma_f32_16x16x32_bf16 v[180:183], v[120:123], v[140:143], v[180:183]
    ds_read_b64_tr_b16 v[108:109], v12 offset:10256
    ds_read_b64_tr_b16 v[110:111], v13 offset:10256
    v_mfma_f32_16x16x32_bf16 v[200:203], v[124:127], v[140:143], v[200:203]
    ds_read_b64_tr_b16 v[112:113], v12 offset:10296
    ds_read_b64_tr_b16 v[114:115], v13 offset:10296
    v_mfma_f32_16x16x32_bf16 v[220:223], v[128:131], v[140:143], v[220:223]
    ds_read_b64_tr_b16 v[116:117], v16 offset:0
    ds_read_b64_tr_b16 v[118:119], v17 offset:0
    v_mfma_f32_16x16x32_bf16 v[240:243], v[132:135], v[140:143], v[240:243]
    v_mfma_f32_16x16x32_bf16 v[192:195], v[120:123], v[152:155], v[192:195]
    v_mfma_f32_16x16x32_bf16 v[212:215], v[124:127], v[152:155], v[212:215]
    v_mfma_f32_16x16x32_bf16 v[232:235], v[128:131], v[152:155], v[232:235]
    v_mfma_f32_16x16x32_bf16 v[252:255], v[132:135], v[152:155], v[252:255]
    v_mfma_f32_16x16x32_bf16 v[184:187], v[120:123], v[144:147], v[184:187]
    v_mfma_f32_16x16x32_bf16 v[204:207], v[124:127], v[144:147], v[204:207]
    v_mfma_f32_16x16x32_bf16 v[224:227], v[128:131], v[144:147], v[224:227]
    v_mfma_f32_16x16x32_bf16 v[244:247], v[132:135], v[144:147], v[244:247]
    v_mfma_f32_16x16x32_bf16 v[188:191], v[120:123], v[148:151], v[188:191]
    v_mfma_f32_16x16x32_bf16 v[208:211], v[124:127], v[148:151], v[208:211]
    v_mfma_f32_16x16x32_bf16 v[228:231], v[128:131], v[148:151], v[228:231]
    s_waitcnt lgkmcnt(0)
    v_mfma_f32_16x16x32_bf16 v[248:251], v[132:135], v[148:151], v[248:251]
    v_mfma_f32_16x16x32_bf16 v[176:179], v[84:87], v[100:103], v[176:179]
    ds_read_b128 v[120:123], v9 offset:0
    ds_read_b128 v[124:127], v9 offset:2048
    v_mfma_f32_16x16x32_bf16 v[196:199], v[88:91], v[100:103], v[196:199]
    ds_read_b128 v[128:131], v9 offset:4096
    ds_read_b128 v[132:135], v9 offset:6144
    v_mfma_f32_16x16x32_bf16 v[216:219], v[92:95], v[100:103], v[216:219]
    ds_read_b64_tr_b16 v[136:137], v12 offset:5120
    ds_read_b64_tr_b16 v[138:139], v13 offset:5120
    v_mfma_f32_16x16x32_bf16 v[236:239], v[96:99], v[100:103], v[236:239]
    ds_read_b64_tr_b16 v[140:141], v12 offset:5160
    ds_read_b64_tr_b16 v[142:143], v13 offset:5160
    v_mfma_f32_16x16x32_bf16 v[180:183], v[84:87], v[104:107], v[180:183]
    ds_read_b64_tr_b16 v[144:145], v12 offset:15376
    ds_read_b64_tr_b16 v[146:147], v13 offset:15376
    v_mfma_f32_16x16x32_bf16 v[200:203], v[88:91], v[104:107], v[200:203]
    ds_read_b64_tr_b16 v[148:149], v12 offset:15416
    ds_read_b64_tr_b16 v[150:151], v13 offset:15416
    v_mfma_f32_16x16x32_bf16 v[220:223], v[92:95], v[104:107], v[220:223]
    ds_read_b64_tr_b16 v[152:153], v16 offset:5120
    ds_read_b64_tr_b16 v[154:155], v17 offset:5120
    v_mfma_f32_16x16x32_bf16 v[240:243], v[96:99], v[104:107], v[240:243]
    v_mfma_f32_16x16x32_bf16 v[192:195], v[84:87], v[116:119], v[192:195]
    v_mfma_f32_16x16x32_bf16 v[212:215], v[88:91], v[116:119], v[212:215]
    v_mfma_f32_16x16x32_bf16 v[232:235], v[92:95], v[116:119], v[232:235]
    v_mfma_f32_16x16x32_bf16 v[252:255], v[96:99], v[116:119], v[252:255]
    v_mfma_f32_16x16x32_bf16 v[184:187], v[84:87], v[108:111], v[184:187]
    v_mfma_f32_16x16x32_bf16 v[204:207], v[88:91], v[108:111], v[204:207]
    v_mfma_f32_16x16x32_bf16 v[224:227], v[92:95], v[108:111], v[224:227]
    v_mfma_f32_16x16x32_bf16 v[244:247], v[96:99], v[108:111], v[244:247]
    v_mfma_f32_16x16x32_bf16 v[188:191], v[84:87], v[112:115], v[188:191]
    v_mfma_f32_16x16x32_bf16 v[208:211], v[88:91], v[112:115], v[208:211]
    v_mfma_f32_16x16x32_bf16 v[228:231], v[92:95], v[112:115], v[228:231]
    s_waitcnt lgkmcnt(0)
    s_barrier
    v_mfma_f32_16x16x32_bf16 v[248:251], v[96:99], v[112:115], v[248:251]
    v_mfma_f32_16x16x32_bf16 v[176:179], v[120:123], v[136:139], v[176:179]
    ds_read_b128 v[84:87], v8 offset:36880
    ds_read_b128 v[88:91], v8 offset:38928
    v_mfma_f32_16x16x32_bf16 v[196:199], v[124:127], v[136:139], v[196:199]
    ds_read_b128 v[92:95], v8 offset:40976
    ds_read_b128 v[96:99], v8 offset:43024
    v_mfma_f32_16x16x32_bf16 v[216:219], v[128:131], v[136:139], v[216:219]
    ds_read_b64_tr_b16 v[100:101], v12 offset:36880
    ds_read_b64_tr_b16 v[102:103], v13 offset:36880
    v_mfma_f32_16x16x32_bf16 v[236:239], v[132:135], v[136:139], v[236:239]
    ds_read_b64_tr_b16 v[104:105], v12 offset:36920
    ds_read_b64_tr_b16 v[106:107], v13 offset:36920
    v_mfma_f32_16x16x32_bf16 v[180:183], v[120:123], v[140:143], v[180:183]
    ds_read_b64_tr_b16 v[108:109], v12 offset:47136
    ds_read_b64_tr_b16 v[110:111], v13 offset:47136
    v_mfma_f32_16x16x32_bf16 v[200:203], v[124:127], v[140:143], v[200:203]
    ds_read_b64_tr_b16 v[112:113], v12 offset:47176
    ds_read_b64_tr_b16 v[114:115], v13 offset:47176
    v_mfma_f32_16x16x32_bf16 v[220:223], v[128:131], v[140:143], v[220:223]
    ds_read_b64_tr_b16 v[116:117], v16 offset:36880
    ds_read_b64_tr_b16 v[118:119], v17 offset:36880
    v_mfma_f32_16x16x32_bf16 v[240:243], v[132:135], v[140:143], v[240:243]
    v_mfma_f32_16x16x32_bf16 v[192:195], v[120:123], v[152:155], v[192:195]
    v_mfma_f32_16x16x32_bf16 v[212:215], v[124:127], v[152:155], v[212:215]
    v_mfma_f32_16x16x32_bf16 v[232:235], v[128:131], v[152:155], v[232:235]
    v_mfma_f32_16x16x32_bf16 v[252:255], v[132:135], v[152:155], v[252:255]
    v_mfma_f32_16x16x32_bf16 v[184:187], v[120:123], v[144:147], v[184:187]
    v_mfma_f32_16x16x32_bf16 v[204:207], v[124:127], v[144:147], v[204:207]
    v_mfma_f32_16x16x32_bf16 v[224:227], v[128:131], v[144:147], v[224:227]
    v_mfma_f32_16x16x32_bf16 v[244:247], v[132:135], v[144:147], v[244:247]
    v_mfma_f32_16x16x32_bf16 v[188:191], v[120:123], v[148:151], v[188:191]
    v_mfma_f32_16x16x32_bf16 v[208:211], v[124:127], v[148:151], v[208:211]
    v_mfma_f32_16x16x32_bf16 v[228:231], v[128:131], v[148:151], v[228:231]
    s_waitcnt lgkmcnt(0)
    v_mfma_f32_16x16x32_bf16 v[248:251], v[132:135], v[148:151], v[248:251]
    v_mfma_f32_16x16x32_bf16 v[176:179], v[84:87], v[100:103], v[176:179]
    ds_read_b128 v[120:123], v9 offset:36880
    ds_read_b128 v[124:127], v9 offset:38928
    v_mfma_f32_16x16x32_bf16 v[196:199], v[88:91], v[100:103], v[196:199]
    ds_read_b128 v[128:131], v9 offset:40976
    ds_read_b128 v[132:135], v9 offset:43024
    v_mfma_f32_16x16x32_bf16 v[216:219], v[92:95], v[100:103], v[216:219]
    ds_read_b64_tr_b16 v[136:137], v12 offset:42000
    ds_read_b64_tr_b16 v[138:139], v13 offset:42000
    v_mfma_f32_16x16x32_bf16 v[236:239], v[96:99], v[100:103], v[236:239]
    ds_read_b64_tr_b16 v[140:141], v12 offset:42040
    ds_read_b64_tr_b16 v[142:143], v13 offset:42040
    v_mfma_f32_16x16x32_bf16 v[180:183], v[84:87], v[104:107], v[180:183]
    ds_read_b64_tr_b16 v[144:145], v12 offset:52256
    ds_read_b64_tr_b16 v[146:147], v13 offset:52256
    v_mfma_f32_16x16x32_bf16 v[200:203], v[88:91], v[104:107], v[200:203]
    ds_read_b64_tr_b16 v[148:149], v12 offset:52296
    ds_read_b64_tr_b16 v[150:151], v13 offset:52296
    v_mfma_f32_16x16x32_bf16 v[220:223], v[92:95], v[104:107], v[220:223]
    ds_read_b64_tr_b16 v[152:153], v16 offset:42000
    ds_read_b64_tr_b16 v[154:155], v17 offset:42000
    v_mfma_f32_16x16x32_bf16 v[240:243], v[96:99], v[104:107], v[240:243]
    v_mfma_f32_16x16x32_bf16 v[192:195], v[84:87], v[116:119], v[192:195]
    v_mfma_f32_16x16x32_bf16 v[212:215], v[88:91], v[116:119], v[212:215]
    v_mfma_f32_16x16x32_bf16 v[232:235], v[92:95], v[116:119], v[232:235]
    v_mfma_f32_16x16x32_bf16 v[252:255], v[96:99], v[116:119], v[252:255]
    v_mfma_f32_16x16x32_bf16 v[184:187], v[84:87], v[108:111], v[184:187]
    v_mfma_f32_16x16x32_bf16 v[204:207], v[88:91], v[108:111], v[204:207]
    v_mfma_f32_16x16x32_bf16 v[224:227], v[92:95], v[108:111], v[224:227]
    v_mfma_f32_16x16x32_bf16 v[244:247], v[96:99], v[108:111], v[244:247]
    v_mfma_f32_16x16x32_bf16 v[188:191], v[84:87], v[112:115], v[188:191]
    v_mfma_f32_16x16x32_bf16 v[208:211], v[88:91], v[112:115], v[208:211]
    v_mfma_f32_16x16x32_bf16 v[228:231], v[92:95], v[112:115], v[228:231]
    s_waitcnt lgkmcnt(0)
    s_barrier
    v_mfma_f32_16x16x32_bf16 v[248:251], v[96:99], v[112:115], v[248:251]
    v_lshlrev_b32 v3, 7, v0
    s_cmp_lg_u32 s56, 0
    s_cbranch_scc1 L_one_6
    s_mov_b64 exec, 3
    buffer_load_dword v4, v3, s[48:51], 0 offen sc1
    s_mov_b64 exec, -1
L_one_6:
    v_mfma_f32_16x16x32_bf16 v[176:179], v[120:123], v[136:139], v[176:179]
    ds_read_b128 v[84:87], v6 offset:0
    ds_read_b128 v[88:91], v6 offset:2048
    v_mfma_f32_16x16x32_bf16 v[196:199], v[124:127], v[136:139], v[196:199]
    ds_read_b128 v[92:95], v6 offset:4096
    ds_read_b128 v[96:99], v6 offset:6144
    v_mfma_f32_16x16x32_bf16 v[216:219], v[128:131], v[136:139], v[216:219]
    ds_read_b64_tr_b16 v[100:101], v10 offset:0
    ds_read_b64_tr_b16 v[102:103], v11 offset:0
    v_mfma_f32_16x16x32_bf16 v[236:239], v[132:135], v[136:139], v[236:239]
    ds_read_b64_tr_b16 v[104:105], v10 offset:40
    ds_read_b64_tr_b16 v[106:107], v11 offset:40
    v_mfma_f32_16x16x32_bf16 v[180:183], v[120:123], v[140:143], v[180:183]
    ds_read_b64_tr_b16 v[108:109], v10 offset:10256
    ds_read_b64_tr_b16 v[110:111], v11 offset:10256
    v_mfma_f32_16x16x32_bf16 v[200:203], v[124:127], v[140:143], v[200:203]
    ds_read_b64_tr_b16 v[112:113], v10 offset:10296
    ds_read_b64_tr_b16 v[114:115], v11 offset:10296
    v_mfma_f32_16x16x32_bf16 v[220:223], v[128:131], v[140:143], v[220:223]
    ds_read_b64_tr_b16 v[116:117], v14 offset:0
    ds_read_b64_tr_b16 v[118:119], v15 offset:0
    v_mfma_f32_16x16x32_bf16 v[240:243], v[132:135], v[140:143], v[240:243]
    v_mfma_f32_16x16x32_bf16 v[192:195], v[120:123], v[152:155], v[192:195]
    v_mfma_f32_16x16x32_bf16 v[212:215], v[124:127], v[152:155], v[212:215]
    v_mfma_f32_16x16x32_bf16 v[232:235], v[128:131], v[152:155], v[232:235]
    v_mfma_f32_16x16x32_bf16 v[252:255], v[132:135], v[152:155], v[252:255]
    v_mfma_f32_16x16x32_bf16 v[184:187], v[120:123], v[144:147], v[184:187]
    v_mfma_f32_16x16x32_bf16 v[204:207], v[124:127], v[144:147], v[204:207]
    v_mfma_f32_16x16x32_bf16 v[224:227], v[128:131], v[144:147], v[224:227]
    v_mfma_f32_16x16x32_bf16 v[244:247], v[132:135], v[144:147], v[244:247]
    v_mfma_f32_16x16x32_bf16 v[188:191], v[120:123], v[148:151], v[188:191]
    v_mfma_f32_16x16x32_bf16 v[208:211], v[124:127], v[148:151], v[208:211]
    v_mfma_f32_16x16x32_bf16 v[228:231], v[128:131], v[148:151], v[228:231]
    s_waitcnt lgkmcnt(0)
    v_mfma_f32_16x16x32_bf16 v[248:251], v[132:135], v[148:151], v[248:251]
    v_mfma_f32_16x16x32_bf16 v[176:179], v[84:87], v[100:103], v[176:179]
    ds_read_b128 v[120:123], v7 offset:0
    ds_read_b128 v[124:127], v7 offset:2048
    v_mfma_f32_16x16x32_bf16 v[196:199], v[88:91], v[100:103], v[196:199]
    ds_read_b128 v[128:131], v7 offset:4096
    ds_read_b128 v[132:135], v7 offset:6144
    v_mfma_f32_16x16x32_bf16 v[216:219], v[92:95], v[100:103], v[216:219]
    ds_read_b64_tr_b16 v[136:137], v10 offset:5120
    ds_read_b64_tr_b16 v[138:139], v11 offset:5120
    v_mfma_f32_16x16x32_bf16 v[236:239], v[96:99], v[100:103], v[236:239]
    ds_read_b64_tr_b16 v[140:141], v10 offset:5160
    ds_read_b64_tr_b16 v[142:143], v11 offset:5160
    v_mfma_f32_16x16x32_bf16 v[180:183], v[84:87], v[104:107], v[180:183]
    ds_read_b64_tr_b16 v[144:145], v10 offset:15376
    ds_read_b64_tr_b16 v[146:147], v11 offset:15376
    v_mfma_f32_16x16x32_bf16 v[200:203], v[88:91], v[104:107], v[200:203]
    ds_read_b64_tr_b16 v[148:149], v10 offset:15416
    ds_read_b64_tr_b16 v[150:151], v11 offset:15416
    v_mfma_f32_16x16x32_bf16 v[220:223], v[92:95], v[104:107], v[220:223]
    ds_read_b64_tr_b16 v[152:153], v14 offset:5120
    ds_read_b64_tr_b16 v[154:155], v15 offset:5120
    v_mfma_f32_16x16x32_bf16 v[240:243], v[96:99], v[104:107], v[240:243]
    v_mfma_f32_16x16x32_bf16 v[192:195], v[84:87], v[116:119], v[192:195]
    v_mfma_f32_16x16x32_bf16 v[212:215], v[88:91], v[116:119], v[212:215]
    v_mfma_f32_16x16x32_bf16 v[232:235], v[92:95], v[116:119], v[232:235]
    v_mfma_f32_16x16x32_bf16 v[252:255], v[96:99], v[116:119], v[252:255]
    v_mfma_f32_16x16x32_bf16 v[184:187], v[84:87], v[108:111], v[184:187]
    v_mfma_f32_16x16x32_bf16 v[204:207], v[88:91], v[108:111], v[204:207]
    v_mfma_f32_16x16x32_bf16 v[224:227], v[92:95], v[108:111], v[224:227]
    v_mfma_f32_16x16x32_bf16 v[244:247], v[96:99], v[108:111], v[244:247]
    v_mfma_f32_16x16x32_bf16 v[188:191], v[84:87], v[112:115], v[188:191]
    v_mfma_f32_16x16x32_bf16 v[208:211], v[88:91], v[112:115], v[208:211]
    v_mfma_f32_16x16x32_bf16 v[228:231], v[92:95], v[112:115], v[228:231]
    s_waitcnt lgkmcnt(0)
    s_barrier
    v_mfma_f32_16x16x32_bf16 v[248:251], v[96:99], v[112:115], v[248:251]
    v_mfma_f32_16x16x32_bf16 v[176:179], v[120:123], v[136:139], v[176:179]
    ds_read_b128 v[84:87], v6 offset:36880
    ds_read_b128 v[88:91], v6 offset:38928
    v_mfma_f32_16x16x32_bf16 v[196:199], v[124:127], v[136:139], v[196:199]
    ds_read_b128 v[92:95], v6 offset:40976
    ds_read_b128 v[96:99], v6 offset:43024
    v_mfma_f32_16x16x32_bf16 v[216:219], v[128:131], v[136:139], v[216:219]
    ds_read_b64_tr_b16 v[100:101], v10 offset:36880
    ds_read_b64_tr_b16 v[102:103], v11 offset:36880
    v_mfma_f32_16x16x32_bf16 v[236:239], v[132:135], v[136:139], v[236:239]
    ds_read_b64_tr_b16 v[104:105], v10 offset:36920
    ds_read_b64_tr_b16 v[106:107], v11 offset:36920
    v_mfma_f32_16x16x32_bf16 v[180:183], v[120:123], v[140:143], v[180:183]
    ds_read_b64_tr_b16 v[108:109], v10 offset:47136
    ds_read_b64_tr_b16 v[110:111], v11 offset:47136
    v_mfma_f32_16x16x32_bf16 v[200:203], v[124:127], v[140:143], v[200:203]
    ds_read_b64_tr_b16 v[112:113], v10 offset:47176
    ds_read_b64_tr_b16 v[114:115], v11 offset:47176
    v_mfma_f32_16x16x32_bf16 v[220:223], v[128:131], v[140:143], v[220:223]
    ds_read_b64_tr_b16 v[116:117], v14 offset:36880
    ds_read_b64_tr_b16 v[118:119], v15 offset:36880
    v_mfma_f32_16x16x32_bf16 v[240:243], v[132:135], v[140:143], v[240:243]
    v_mfma_f32_16x16x32_bf16 v[192:195], v[120:123], v[152:155], v[192:195]
    v_mfma_f32_16x16x32_bf16 v[212:215], v[124:127], v[152:155], v[212:215]
    v_mfma_f32_16x16x32_bf16 v[232:235], v[128:131], v[152:155], v[232:235]
    v_mfma_f32_16x16x32_bf16 v[252:255], v[132:135], v[152:155], v[252:255]
    v_mfma_f32_16x16x32_bf16 v[184:187], v[120:123], v[144:147], v[184:187]
    v_mfma_f32_16x16x32_bf16 v[204:207], v[124:127], v[144:147], v[204:207]
    v_mfma_f32_16x16x32_bf16 v[224:227], v[128:131], v[144:147], v[224:227]
    v_mfma_f32_16x16x32_bf16 v[244:247], v[132:135], v[144:147], v[244:247]
    v_mfma_f32_16x16x32_bf16 v[188:191], v[120:123], v[148:151], v[188:191]
    v_mfma_f32_16x16x32_bf16 v[208:211], v[124:127], v[148:151], v[208:211]
    v_mfma_f32_16x16x32_bf16 v[228:231], v[128:131], v[148:151], v[228:231]
    s_waitcnt lgkmcnt(0)
    v_mfma_f32_16x16x32_bf16 v[248:251], v[132:135], v[148:151], v[248:251]
    v_mfma_f32_16x16x32_bf16 v[176:179], v[84:87], v[100:103], v[176:179]
    ds_read_b128 v[120:123], v7 offset:36880
    ds_read_b128 v[124:127], v7 offset:38928
    v_mfma_f32_16x16x32_bf16 v[196:199], v[88:91], v[100:103], v[196:199]
    ds_read_b128 v[128:131], v7 offset:40976
    ds_read_b128 v[132:135], v7 offset:43024
    v_mfma_f32_16x16x32_bf16 v[216:219], v[92:95], v[100:103], v[216:219]
    ds_read_b64_tr_b16 v[136:137], v10 offset:42000
    ds_read_b64_tr_b16 v[138:139], v11 offset:42000
    v_mfma_f32_16x16x32_bf16 v[236:239], v[96:99], v[100:103], v[236:239]
    ds_read_b64_tr_b16 v[140:141], v10 offset:42040
    ds_read_b64_tr_b16 v[142:143], v11 offset:42040
    v_mfma_f32_16x16x32_bf16 v[180:183], v[84:87], v[104:107], v[180:183]
    ds_read_b64_tr_b16 v[144:145], v10 offset:52256
    ds_read_b64_tr_b16 v[146:147], v11 offset:52256
    v_mfma_f32_16x16x32_bf16 v[200:203], v[88:91], v[104:107], v[200:203]
    ds_read_b64_tr_b16 v[148:149], v10 offset:52296
    ds_read_b64_tr_b16 v[150:151], v11 offset:52296
    v_mfma_f32_16x16x32_bf16 v[220:223], v[92:95], v[104:107], v[220:223]
    ds_read_b64_tr_b16 v[152:153], v14 offset:42000
    ds_read_b64_tr_b16 v[154:155], v15 offset:42000
    v_mfma_f32_16x16x32_bf16 v[240:243], v[96:99], v[104:107], v[240:243]
    v_mfma_f32_16x16x32_bf16 v[192:195], v[84:87], v[116:119], v[192:195]
    v_mfma_f32_16x16x32_bf16 v[212:215], v[88:91], v[116:119], v[212:215]
    v_mfma_f32_16x16x32_bf16 v[232:235], v[92:95], v[116:119], v[232:235]
    v_mfma_f32_16x16x32_bf16 v[252:255], v[96:99], v[116:119], v[252:255]
    v_mfma_f32_16x16x32_bf16 v[184:187], v[84:87], v[108:111], v[184:187]
    v_mfma_f32_16x16x32_bf16 v[204:207], v[88:91], v[108:111], v[204:207]
    v_mfma_f32_16x16x32_bf16 v[224:227], v[92:95], v[108:111], v[224:227]
    v_mfma_f32_16x16x32_bf16 v[244:247], v[96:99], v[108:111], v[244:247]
    v_mfma_f32_16x16x32_bf16 v[188:191], v[84:87], v[112:115], v[188:191]
    v_mfma_f32_16x16x32_bf16 v[208:211], v[88:91], v[112:115], v[208:211]
    v_mfma_f32_16x16x32_bf16 v[228:231], v[92:95], v[112:115], v[228:231]
    s_waitcnt vmcnt(0) lgkmcnt(0)
    s_barrier
    v_mfma_f32_16x16x32_bf16 v[248:251], v[96:99], v[112:115], v[248:251]
    s_cmp_lg_u32 s56, 0
    s_cbranch_scc1 L_one_7
    s_mov_b32 s63, 0
    s_mov_b64 exec, 3
L_fl_8:
    v_cmp_ne_u32 vcc, 1, v4
    s_add_u32 s63, s63, 1
    s_cbranch_vccz L_fd_9
    s_cmp_ge_u32 s63, 200000
    s_cbranch_scc1 L_fd_9
    s_sleep 2
    buffer_load_dword v4, v3, s[48:51], 0 offen sc1
    s_waitcnt vmcnt(0)
    s_branch L_fl_8
L_fd_9:
    s_mov_b64 exec, -1
    s_mov_b64 exec, 1
    buffer_store_dword v2, v1, s[44:47], s60 offen sc1
    s_mov_b64 exec, -1
L_one_7:
    v_mfma_f32_16x16x32_bf16 v[176:179], v[120:123], v[136:139], v[176:179]
    ds_read_b128 v[84:87], v8 offset:0
    ds_read_b128 v[88:91], v8 offset:2048
    v_mfma_f32_16x16x32_bf16 v[196:199], v[124:127], v[136:139], v[196:199]
    ds_read_b128 v[92:95], v8 offset:4096
    ds_read_b128 v[96:99], v8 offset:6144
    v_mfma_f32_16x16x32_bf16 v[216:219], v[128:131], v[136:139], v[216:219]
    ds_read_b64_tr_b16 v[100:101], v12 offset:0
    ds_read_b64_tr_b16 v[102:103], v13 offset:0
    v_mfma_f32_16x16x32_bf16 v[236:239], v[132:135], v[136:139], v[236:239]
    ds_read_b64_tr_b16 v[104:105], v12 offset:40
    ds_read_b64_tr_b16 v[106:107], v13 offset:40
    v_mfma_f32_16x16x32_bf16 v[180:183], v[120:123], v[140:143], v[180:183]
    ds_read_b64_tr_b16 v[108:109], v12 offset:10256
    ds_read_b64_tr_b16 v[110:111], v13 offset:10256
    v_mfma_f32_16x16x32_bf16 v[200:203], v[124:127], v[140:143], v[200:203]
    ds_read_b64_tr_b16 v[112:113], v12 offset:10296
    ds_read_b64_tr_b16 v[114:115], v13 offset:10296
    v_mfma_f32_16x16x32_bf16 v[220:223], v[128:131], v[140:143], v[220:223]
    ds_read_b64_tr_b16 v[116:117], v16 offset:0
    ds_read_b64_tr_b16 v[118:119], v17 offset:0
    v_mfma_f32_16x16x32_bf16 v[240:243], v[132:135], v[140:143], v[240:243]
    v_mfma_f32_16x16x32_bf16 v[192:195], v[120:123], v[152:155], v[192:195]
    v_mfma_f32_16x16x32_bf16 v[212:215], v[124:127], v[152:155], v[212:215]
    v_mfma_f32_16x16x32_bf16 v[232:235], v[128:131], v[152:155], v[232:235]
    v_mfma_f32_16x16x32_bf16 v[252:255], v[132:135], v[152:155], v[252:255]
    v_mfma_f32_16x16x32_bf16 v[184:187], v[120:123], v[144:147], v[184:187]
    v_mfma_f32_16x16x32_bf16 v[204:207], v[124:127], v[144:147], v[204:207]
    v_mfma_f32_16x16x32_bf16 v[224:227], v[128:131], v[144:147], v[224:227]
    v_mfma_f32_16x16x32_bf16 v[244:247], v[132:135], v[144:147], v[244:247]
    v_mfma_f32_16x16x32_bf16 v[188:191], v[120:123], v[148:151], v[188:191]
    v_mfma_f32_16x16x32_bf16 v[208:211], v[124:127], v[148:151], v[208:211]
    v_mfma_f32_16x16x32_bf16 v[228:231], v[128:131], v[148:151], v[228:231]
    s_waitcnt lgkmcnt(0)
    v_mfma_f32_16x16x32_bf16 v[248:251], v[132:135], v[148:151], v[248:251]
    v_mfma_f32_16x16x32_bf16 v[176:179], v[84:87], v[100:103], v[176:179]
    ds_read_b128 v[120:123], v9 offset:0
    ds_read_b128 v[124:127], v9 offset:2048
    v_mfma_f32_16x16x32_bf16 v[196:199], v[88:91], v[100:103], v[196:199]
    ds_read_b128 v[128:131], v9 offset:4096
    ds_read_b128 v[132:135], v9 offset:6144
    v_mfma_f32_16x16x32_bf16 v[216:219], v[92:95], v[100:103], v[216:219]
    ds_read_b64_tr_b16 v[136:137], v12 offset:5120
    ds_read_b64_tr_b16 v[138:139], v13 offset:5120
    v_mfma_f32_16x16x32_bf16 v[236:239], v[96:99], v[100:103], v[236:239]
    ds_read_b64_tr_b16 v[140:141], v12 offset:5160
    ds_read_b64_tr_b16 v[142:143], v13 offset:5160
    v_mfma_f32_16x16x32_bf16 v[180:183], v[84:87], v[104:107], v[180:183]
    ds_read_b64_tr_b16 v[144:145], v12 offset:15376
    ds_read_b64_tr_b16 v[146:147], v13 offset:15376
    v_mfma_f32_16x16x32_bf16 v[200:203], v[88:91], v[104:107], v[200:203]
    ds_read_b64_tr_b16 v[148:149], v12 offset:15416
    ds_read_b64_tr_b16 v[150:151], v13 offset:15416
    v_mfma_f32_16x16x32_bf16 v[220:223], v[92:95], v[104:107], v[220:223]
    ds_read_b64_tr_b16 v[152:153], v16 offset:5120
    ds_read_b64_tr_b16 v[154:155], v17 offset:5120
    v_mfma_f32_16x16x32_bf16 v[240:243], v[96:99], v[104:107], v[240:243]
    v_mfma_f32_16x16x32_bf16 v[192:195], v[84:87], v[116:119], v[192:195]
    v_mfma_f32_16x16x32_bf16 v[212:215], v[88:91], v[116:119], v[212:215]
    v_mfma_f32_16x16x32_bf16 v[232:235], v[92:95], v[116:119], v[232:235]
    v_mfma_f32_16x16x32_bf16 v[252:255], v[96:99], v[116:119], v[252:255]
    v_mfma_f32_16x16x32_bf16 v[184:187], v[84:87], v[108:111], v[184:187]
    v_mfma_f32_16x16x32_bf16 v[204:207], v[88:91], v[108:111], v[204:207]
    v_mfma_f32_16x16x32_bf16 v[224:227], v[92:95], v[108:111], v[224:227]
    v_mfma_f32_16x16x32_bf16 v[244:247], v[96:99], v[108:111], v[244:247]
    v_mfma_f32_16x16x32_bf16 v[188:191], v[84:87], v[112:115], v[188:191]
    v_mfma_f32_16x16x32_bf16 v[208:211], v[88:91], v[112:115], v[208:211]
    v_mfma_f32_16x16x32_bf16 v[228:231], v[92:95], v[112:115], v[228:231]
    s_waitcnt lgkmcnt(0)
    s_barrier
    v_mfma_f32_16x16x32_bf16 v[248:251], v[96:99], v[112:115], v[248:251]
    v_mfma_f32_16x16x32_bf16 v[176:179], v[120:123], v[136:139], v[176:179]
    ds_read_b128 v[84:87], v8 offset:36880
    ds_read_b128 v[88:91], v8 offset:38928
    v_mfma_f32_16x16x32_bf16 v[196:199], v[124:127], v[136:139], v[196:199]
    ds_read_b128 v[92:95], v8 offset:40976
    ds_read_b128 v[96:99], v8 offset:43024
    v_mfma_f32_16x16x32_bf16 v[216:219], v[128:131], v[136:139], v[216:219]
    ds_read_b64_tr_b16 v[100:101], v12 offset:36880
    ds_read_b64_tr_b16 v[102:103], v13 offset:36880
    v_mfma_f32_16x16x32_bf16 v[236:239], v[132:135], v[136:139], v[236:239]
    ds_read_b64_tr_b16 v[104:105], v12 offset:36920
    ds_read_b64_tr_b16 v[106:107], v13 offset:36920
    v_mfma_f32_16x16x32_bf16 v[180:183], v[120:123], v[140:143], v[180:183]
    ds_read_b64_tr_b16 v[108:109], v12 offset:47136
    ds_read_b64_tr_b16 v[110:111], v13 offset:47136
    v_mfma_f32_16x16x32_bf16 v[200:203], v[124:127], v[140:143], v[200:203]
    ds_read_b64_tr_b16 v[112:113], v12 offset:47176
    ds_read_b64_tr_b16 v[114:115], v13 offset:47176
    v_mfma_f32_16x16x32_bf16 v[220:223], v[128:131], v[140:143], v[220:223]
    ds_read_b64_tr_b16 v[116:117], v16 offset:36880
    ds_read_b64_tr_b16 v[118:119], v17 offset:36880
    v_mfma_f32_16x16x32_bf16 v[240:243], v[132:135], v[140:143], v[240:243]
    v_mfma_f32_16x16x32_bf16 v[192:195], v[120:123], v[152:155], v[192:195]
    v_mfma_f32_16x16x32_bf16 v[212:215], v[124:127], v[152:155], v[212:215]
    v_mfma_f32_16x16x32_bf16 v[232:235], v[128:131], v[152:155], v[232:235]
    v_mfma_f32_16x16x32_bf16 v[252:255], v[132:135], v[152:155], v[252:255]
    v_mfma_f32_16x16x32_bf16 v[184:187], v[120:123], v[144:147], v[184:187]
    v_mfma_f32_16x16x32_bf16 v[204:207], v[124:127], v[144:147], v[204:207]
    v_mfma_f32_16x16x32_bf16 v[224:227], v[128:131], v[144:147], v[224:227]
    v_mfma_f32_16x16x32_bf16 v[244:247], v[132:135], v[144:147], v[244:247]
    v_mfma_f32_16x16x32_bf16 v[188:191], v[120:123], v[148:151], v[188:191]
    v_mfma_f32_16x16x32_bf16 v[208:211], v[124:127], v[148:151], v[208:211]
    v_mfma_f32_16x16x32_bf16 v[228:231], v[128:131], v[148:151], v[228:231]
    s_waitcnt lgkmcnt(0)
    v_mfma_f32_16x16x32_bf16 v[248:251], v[132:135], v[148:151], v[248:251]
    v_mfma_f32_16x16x32_bf16 v[176:179], v[84:87], v[100:103], v[176:179]
    ds_read_b128 v[120:123], v9 offset:36880
    ds_read_b128 v[124:127], v9 offset:38928
    v_mfma_f32_16x16x32_bf16 v[196:199], v[88:91], v[100:103], v[196:199]
    ds_read_b128 v[128:131], v9 offset:40976
    ds_read_b128 v[132:135], v9 offset:43024
    v_mfma_f32_16x16x32_bf16 v[216:219], v[92:95], v[100:103], v[216:219]
    ds_read_b64_tr_b16 v[136:137], v12 offset:42000
    ds_read_b64_tr_b16 v[138:139], v13 offset:42000
    v_mfma_f32_16x16x32_bf16 v[236:239], v[96:99], v[100:103], v[236:239]
    ds_read_b64_tr_b16 v[140:141], v12 offset:42040
    ds_read_b64_tr_b16 v[142:143], v13 offset:42040
    v_mfma_f32_16x16x32_bf16 v[180:183], v[84:87], v[104:107], v[180:183]
    ds_read_b64_tr_b16 v[144:145], v12 offset:52256
    ds_read_b64_tr_b16 v[146:147], v13 offset:52256
    v_mfma_f32_16x16x32_bf16 v[200:203], v[88:91], v[104:107], v[200:203]
    ds_read_b64_tr_b16 v[148:149], v12 offset:52296
    ds_read_b64_tr_b16 v[150:151], v13 offset:52296
    v_mfma_f32_16x16x32_bf16 v[220:223], v[92:95], v[104:107], v[220:223]
    ds_read_b64_tr_b16 v[152:153], v16 offset:42000
    ds_read_b64_tr_b16 v[154:155], v17 offset:42000
    v_mfma_f32_16x16x32_bf16 v[240:243], v[96:99], v[104:107], v[240:243]
    v_mfma_f32_16x16x32_bf16 v[192:195], v[84:87], v[116:119], v[192:195]
    v_mfma_f32_16x16x32_bf16 v[212:215], v[88:91], v[116:119], v[212:215]
    v_mfma_f32_16x16x32_bf16 v[232:235], v[92:95], v[116:119], v[232:235]
    v_mfma_f32_16x16x32_bf16 v[252:255], v[96:99], v[116:119], v[252:255]
    v_mfma_f32_16x16x32_bf16 v[184:187], v[84:87], v[108:111], v[184:187]
    v_mfma_f32_16x16x32_bf16 v[204:207], v[88:91], v[108:111], v[204:207]
    v_mfma_f32_16x16x32_bf16 v[224:227], v[92:95], v[108:111], v[224:227]
    v_mfma_f32_16x16x32_bf16 v[244:247], v[96:99], v[108:111], v[244:247]
    v_mfma_f32_16x16x32_bf16 v[188:191], v[84:87], v[112:115], v[188:191]
    v_mfma_f32_16x16x32_bf16 v[208:211], v[88:91], v[112:115], v[208:211]
    v_mfma_f32_16x16x32_bf16 v[228:231], v[92:95], v[112:115], v[228:231]
    s_waitcnt lgkmcnt(0)
    s_barrier
    v_mfma_f32_16x16x32_bf16 v[248:251], v[96:99], v[112:115], v[248:251]
    v_mfma_f32_16x16x32_bf16 v[176:179], v[120:123], v[136:139], v[176:179]
    ds_read_b128 v[84:87], v6 offset:0
    ds_read_b128 v[88:91], v6 offset:2048
    v_mfma_f32_16x16x32_bf16 v[196:199], v[124:127], v[136:139], v[196:199]
    ds_read_b128 v[92:95], v6 offset:4096
    ds_read_b128 v[96:99], v6 offset:6144
    v_mfma_f32_16x16x32_bf16 v[216:219], v[128:131], v[136:139], v[216:219]
    ds_read_b64_tr_b16 v[100:101], v10 offset:0
    ds_read_b64_tr_b16 v[102:103], v11 offset:0
    v_mfma_f32_16x16x32_bf16 v[236:239], v[132:135], v[136:139], v[236:239]
    ds_read_b64_tr_b16 v[104:105], v10 offset:40
    ds_read_b64_tr_b16 v[106:107], v11 offset:40
    v_mfma_f32_16x16x32_bf16 v[180:183], v[120:123], v[140:143], v[180:183]
    ds_read_b64_tr_b16 v[108:109], v10 offset:10256
    ds_read_b64_tr_b16 v[110:111], v11 offset:10256
    v_mfma_f32_16x16x32_bf16 v[200:203], v[124:127], v[140:143], v[200:203]
    ds_read_b64_tr_b16 v[112:113], v10 offset:10296
    ds_read_b64_tr_b16 v[114:115], v11 offset:10296
    v_mfma_f32_16x16x32_bf16 v[220:223], v[128:131], v[140:143], v[220:223]
    ds_read_b64_tr_b16 v[116:117], v14 offset:0
    ds_read_b64_tr_b16 v[118:119], v15 offset:0
    v_mfma_f32_16x16x32_bf16 v[240:243], v[132:135], v[140:143], v[240:243]
    v_mfma_f32_16x16x32_bf16 v[192:195], v[120:123], v[152:155], v[192:195]
    v_mfma_f32_16x16x32_bf16 v[212:215], v[124:127], v[152:155], v[212:215]
    v_mfma_f32_16x16x32_bf16 v[232:235], v[128:131], v[152:155], v[232:235]
    v_mfma_f32_16x16x32_bf16 v[252:255], v[132:135], v[152:155], v[252:255]
    v_mfma_f32_16x16x32_bf16 v[184:187], v[120:123], v[144:147], v[184:187]
    v_mfma_f32_16x16x32_bf16 v[204:207], v[124:127], v[144:147], v[204:207]
    v_mfma_f32_16x16x32_bf16 v[224:227], v[128:131], v[144:147], v[224:227]
    v_mfma_f32_16x16x32_bf16 v[244:247], v[132:135], v[144:147], v[244:247]
    v_mfma_f32_16x16x32_bf16 v[188:191], v[120:123], v[148:151], v[188:191]
    v_mfma_f32_16x16x32_bf16 v[208:211], v[124:127], v[148:151], v[208:211]
    v_mfma_f32_16x16x32_bf16 v[228:231], v[128:131], v[148:151], v[228:231]
    s_waitcnt lgkmcnt(0)
    v_mfma_f32_16x16x32_bf16 v[248:251], v[132:135], v[148:151], v[248:251]
    v_mfma_f32_16x16x32_bf16 v[176:179], v[84:87], v[100:103], v[176:179]
    ds_read_b128 v[120:123], v7 offset:0
    ds_read_b128 v[124:127], v7 offset:2048
    v_mfma_f32_16x16x32_bf16 v[196:199], v[88:91], v[100:103], v[196:199]
    ds_read_b128 v[128:131], v7 offset:4096
    ds_read_b128 v[132:135], v7 offset:6144
    v_mfma_f32_16x16x32_bf16 v[216:219], v[92:95], v[100:103], v[216:219]
    ds_read_b64_tr_b16 v[136:137], v10 offset:5120
    ds_read_b64_tr_b16 v[138:139], v11 offset:5120
    v_mfma_f32_16x16x32_bf16 v[236:239], v[96:99], v[100:103], v[236:239]
    ds_read_b64_tr_b16 v[140:141], v10 offset:5160
    ds_read_b64_tr_b16 v[142:143], v11 offset:5160
    v_mfma_f32_16x16x32_bf16 v[180:183], v[84:87], v[104:107], v[180:183]
    ds_read_b64_tr_b16 v[144:145], v10 offset:15376
    ds_read_b64_tr_b16 v[146:147], v11 offset:15376
    v_mfma_f32_16x16x32_bf16 v[200:203], v[88:91], v[104:107], v[200:203]
    ds_read_b64_tr_b16 v[148:149], v10 offset:15416
    ds_read_b64_tr_b16 v[150:151], v11 offset:15416
    v_mfma_f32_16x16x32_bf16 v[220:223], v[92:95], v[104:107], v[220:223]
    ds_read_b64_tr_b16 v[152:153], v14 offset:5120
    ds_read_b64_tr_b16 v[154:155], v15 offset:5120
    v_mfma_f32_16x16x32_bf16 v[240:243], v[96:99], v[104:107], v[240:243]
    v_mfma_f32_16x16x32_bf16 v[192:195], v[84:87], v[116:119], v[192:195]
    v_mfma_f32_16x16x32_bf16 v[212:215], v[88:91], v[116:119], v[212:215]
    v_mfma_f32_16x16x32_bf16 v[232:235], v[92:95], v[116:119], v[232:235]
    v_mfma_f32_16x16x32_bf16 v[252:255], v[96:99], v[116:119], v[252:255]
    v_mfma_f32_16x16x32_bf16 v[184:187], v[84:87], v[108:111], v[184:187]
    v_mfma_f32_16x16x32_bf16 v[204:207], v[88:91], v[108:111], v[204:207]
    v_mfma_f32_16x16x32_bf16 v[224:227], v[92:95], v[108:111], v[224:227]
    v_mfma_f32_16x16x32_bf16 v[244:247], v[96:99], v[108:111], v[244:247]
    v_mfma_f32_16x16x32_bf16 v[188:191], v[84:87], v[112:115], v[188:191]
    v_mfma_f32_16x16x32_bf16 v[208:211], v[88:91], v[112:115], v[208:211]
    v_mfma_f32_16x16x32_bf16 v[228:231], v[92:95], v[112:115], v[228:231]
    s_waitcnt lgkmcnt(0)
    s_barrier
    v_mfma_f32_16x16x32_bf16 v[248:251], v[96:99], v[112:115], v[248:251]
    s_cmp_lg_u32 s56, 0
    s_cbranch_scc1 L_one_10
    s_mov_b64 exec, 65535
    buffer_load_dword v4, v21, s[44:47], 0 offen sc1
    s_mov_b64 exec, -1
L_one_10:
    v_mfma_f32_16x16x32_bf16 v[176:179], v[120:123], v[136:139], v[176:179]
    ds_read_b128 v[84:87], v6 offset:36880
    ds_read_b128 v[88:91], v6 offset:38928
    v_mfma_f32_16x16x32_bf16 v[196:199], v[124:127], v[136:139], v[196:199]
    ds_read_b128 v[92:95], v6 offset:40976
    ds_read_b128 v[96:99], v6 offset:43024
    v_mfma_f32_16x16x32_bf16 v[216:219], v[128:131], v[136:139], v[216:219]
    ds_read_b64_tr_b16 v[100:101], v10 offset:36880
    ds_read_b64_tr_b16 v[102:103], v11 offset:36880
    v_mfma_f32_16x16x32_bf16 v[236:239], v[132:135], v[136:139], v[236:239]
    ds_read_b64_tr_b16 v[104:105], v10 offset:36920
    ds_read_b64_tr_b16 v[106:107], v11 offset:36920
    v_mfma_f32_16x16x32_bf16 v[180:183], v[120:123], v[140:143], v[180:183]
    ds_read_b64_tr_b16 v[108:109], v10 offset:47136
    ds_read_b64_tr_b16 v[110:111], v11 offset:47136
    v_mfma_f32_16x16x32_bf16 v[200:203], v[124:127], v[140:143], v[200:203]
    ds_read_b64_tr_b16 v[112:113], v10 offset:47176
    ds_read_b64_tr_b16 v[114:115], v11 offset:47176
    v_mfma_f32_16x16x32_bf16 v[220:223], v[128:131], v[140:143], v[220:223]
    ds_read_b64_tr_b16 v[116:117], v14 offset:36880
    ds_read_b64_tr_b16 v[118:119], v15 offset:36880
    v_mfma_f32_16x16x32_bf16 v[240:243], v[132:135], v[140:143], v[240:243]
    v_mfma_f32_16x16x32_bf16 v[192:195], v[120:123], v[152:155], v[192:195]
    v_mfma_f32_16x16x32_bf16 v[212:215], v[124:127], v[152:155], v[212:215]
    v_mfma_f32_16x16x32_bf16 v[232:235], v[128:131], v[152:155], v[232:235]
    v_mfma_f32_16x16x32_bf16 v[252:255], v[132:135], v[152:155], v[252:255]
    v_mfma_f32_16x16x32_bf16 v[184:187], v[120:123], v[144:147], v[184:187]
    v_mfma_f32_16x16x32_bf16 v[204:207], v[124:127], v[144:147], v[204:207]
    v_mfma_f32_16x16x32_bf16 v[224:227], v[128:131], v[144:147], v[224:227]
    v_mfma_f32_16x16x32_bf16 v[244:247], v[132:135], v[144:147], v[244:247]
    v_mfma_f32_16x16x32_bf16 v[188:191], v[120:123], v[148:151], v[188:191]
    v_mfma_f32_16x16x32_bf16 v[208:211], v[124:127], v[148:151], v[208:211]
    v_mfma_f32_16x16x32_bf16 v[228:231], v[128:131], v[148:151], v[228:231]
    s_waitcnt lgkmcnt(0)
    v_mfma_f32_16x16x32_bf16 v[248:251], v[132:135], v[148:151], v[248:251]
    v_mfma_f32_16x16x32_bf16 v[176:179], v[84:87], v[100:103], v[176:179]
    ds_read_b128 v[120:123], v7 offset:36880
    ds_read_b128 v[124:127], v7 offset:38928
    v_mfma_f32_16x16x32_bf16 v[196:199], v[88:91], v[100:103], v[196:199]
    ds_read_b128 v[128:131], v7 offset:40976
    ds_read_b128 v[132:135], v7 offset:43024
    v_mfma_f32_16x16x32_bf16 v[216:219], v[92:95], v[100:103], v[216:219]
    ds_read_b64_tr_b16 v[136:137], v10 offset:42000
    ds_read_b64_tr_b16 v[138:139], v11 offset:42000
    v_mfma_f32_16x16x32_bf16 v[236:239], v[96:99], v[100:103], v[236:239]
    ds_read_b64_tr_b16 v[140:141], v10 offset:42040
    ds_read_b64_tr_b16 v[142:143], v11 offset:42040
    v_mfma_f32_16x16x32_bf16 v[180:183], v[84:87], v[104:107], v[180:183]
    ds_read_b64_tr_b16 v[144:145], v10 offset:52256
    ds_read_b64_tr_b16 v[146:147], v11 offset:52256
    v_mfma_f32_16x16x32_bf16 v[200:203], v[88:91], v[104:107], v[200:203]
    ds_read_b64_tr_b16 v[148:149], v10 offset:52296
    ds_read_b64_tr_b16 v[150:151], v11 offset:52296
    v_mfma_f32_16x16x32_bf16 v[220:223], v[92:95], v[104:107], v[220:223]
    ds_read_b64_tr_b16 v[152:153], v14 offset:42000
    ds_read_b64_tr_b16 v[154:155], v15 offset:42000
    v_mfma_f32_16x16x32_bf16 v[240:243], v[96:99], v[104:107], v[240:243]
    v_mfma_f32_16x16x32_bf16 v[192:195], v[84:87], v[116:119], v[192:195]
    v_mfma_f32_16x16x32_bf16 v[212:215], v[88:91], v[116:119], v[212:215]
    v_mfma_f32_16x16x32_bf16 v[232:235], v[92:95], v[116:119], v[232:235]
    v_mfma_f32_16x16x32_bf16 v[252:255], v[96:99], v[116:119], v[252:255]
    s_waitcnt lgkmcnt(0)
    v_mfma_f32_16x16x32_bf16 v[176:179], v[120:123], v[136:139], v[176:179]
    v_mfma_f32_16x16x32_bf16 v[196:199], v[124:127], v[136:139], v[196:199]
    v_mfma_f32_16x16x32_bf16 v[216:219], v[128:131], v[136:139], v[216:219]
    v_mfma_f32_16x16x32_bf16 v[236:239], v[132:135], v[136:139], v[236:239]
    v_mfma_f32_16x16x32_bf16 v[180:183], v[120:123], v[140:143], v[180:183]
    v_mfma_f32_16x16x32_bf16 v[200:203], v[124:127], v[140:143], v[200:203]
    v_mfma_f32_16x16x32_bf16 v[220:223], v[128:131], v[140:143], v[220:223]
    v_mfma_f32_16x16x32_bf16 v[240:243], v[132:135], v[140:143], v[240:243]
    v_mfma_f32_16x16x32_bf16 v[192:195], v[120:123], v[152:155], v[192:195]
    v_mfma_f32_16x16x32_bf16 v[212:215], v[124:127], v[152:155], v[212:215]
    v_mfma_f32_16x16x32_bf16 v[232:235], v[128:131], v[152:155], v[232:235]
    v_mfma_f32_16x16x32_bf16 v[252:255], v[132:135], v[152:155], v[252:255]
    v_mfma_f32_16x16x32_bf16 v[184:187], v[84:87], v[108:111], v[184:187]
    v_fma_f32 v156, v176, s10, v5
    v_fma_f32 v157, v177, s10, v5
    v_fma_f32 v158, v178, s10, v5
    v_mfma_f32_16x16x32_bf16 v[204:207], v[88:91], v[108:111], v[204:207]
    v_fma_f32 v159, v179, s10, v5
    v_fma_f32 v160, v196, s10, v5
    v_fma_f32 v161, v197, s10, v5
    v_mfma_f32_16x16x32_bf16 v[224:227], v[92:95], v[108:111], v[224:227]
    v_fma_f32 v162, v198, s10, v5
    v_fma_f32 v163, v199, s10, v5
    v_exp_f32_e64 v156, v156 clamp
    v_mfma_f32_16x16x32_bf16 v[244:247], v[96:99], v[108:111], v[244:247]
    v_max_f32 v176, s11, v176
    v_exp_f32_e64 v157, v157 clamp
    v_max_f32 v177, s11, v177
    v_mfma_f32_16x16x32_bf16 v[188:191], v[84:87], v[112:115], v[188:191]
    v_exp_f32_e64 v158, v158 clamp
    v_max_f32 v178, s11, v178
    v_exp_f32_e64 v159, v159 clamp
    v_mfma_f32_16x16x32_bf16 v[208:211], v[88:91], v[112:115], v[208:211]
    v_max_f32 v179, s11, v179
    v_exp_f32_e64 v160, v160 clamp
    v_max_f32 v196, s11, v196
    v_mfma_f32_16x16x32_bf16 v[228:231], v[92:95], v[112:115], v[228:231]
    v_exp_f32_e64 v161, v161 clamp
    v_max_f32 v197, s11, v197
    v_exp_f32_e64 v162, v162 clamp
    v_mfma_f32_16x16x32_bf16 v[248:251], v[96:99], v[112:115], v[248:251]
    v_max_f32 v198, s11, v198
    v_exp_f32_e64 v163, v163 clamp
    v_max_f32 v199, s11, v199
    s_barrier
    v_mfma_f32_16x16x32_bf16 v[184:187], v[120:123], v[144:147], v[184:187]
    v_add_f32 v176, v176, v156
    v_add_f32 v177, v177, v157
    v_add_f32 v178, v178, v158
    v_mfma_f32_16x16x32_bf16 v[204:207], v[124:127], v[144:147], v[204:207]
    v_add_f32 v179, v179, v159
    v_add_f32 v196, v196, v160
    v_add_f32 v197, v197, v161
    v_mfma_f32_16x16x32_bf16 v[224:227], v[128:131], v[144:147], v[224:227]
    v_add_f32 v198, v198, v162
    v_add_f32 v199, v199, v163
    v_fma_f32 v156, v216, s10, v5
    v_mfma_f32_16x16x32_bf16 v[244:247], v[132:135], v[144:147], v[244:247]
    v_fma_f32 v157, v217, s10, v5
    v_fma_f32 v158, v218, s10, v5
    v_fma_f32 v159, v219, s10, v5
    v_mfma_f32_16x16x32_bf16 v[188:191], v[120:123], v[148:151], v[188:191]
    v_fma_f32 v160, v236, s10, v5
    v_fma_f32 v161, v237, s10, v5
    v_fma_f32 v162, v238, s10, v5
    v_mfma_f32_16x16x32_bf16 v[208:211], v[124:127], v[148:151], v[208:211]
    v_fma_f32 v163, v239, s10, v5
    v_exp_f32_e64 v156, v156 clamp
    v_max_f32 v216, s11, v216
    v_mfma_f32_16x16x32_bf16 v[228:231], v[128:131], v[148:151], v[228:231]
    v_exp_f32_e64 v157, v157 clamp
    v_max_f32 v217, s11, v217
    v_exp_f32_e64 v158, v158 clamp
    v_mfma_f32_16x16x32_bf16 v[248:251], v[132:135], v[148:151], v[248:251]
    v_max_f32 v218, s11, v218
    v_exp_f32_e64 v159, v159 clamp
    v_max_f32 v219, s11, v219
    v_exp_f32_e64 v160, v160 clamp
    v_max_f32 v236, s11, v236
    v_exp_f32_e64 v161, v161 clamp
    v_max_f32 v237, s11, v237
    v_exp_f32_e64 v162, v162 clamp
    v_max_f32 v238, s11, v238
    v_exp_f32_e64 v163, v163 clamp
    v_max_f32 v239, s11, v239
    v_add_f32 v216, v216, v156
    v_add_f32 v217, v217, v157
    v_add_f32 v218, v218, v158
    v_add_f32 v219, v219, v159
    v_add_f32 v236, v236, v160
    v_add_f32 v237, v237, v161
    v_add_f32 v238, v238, v162
    v_add_f32 v239, v239, v163
    v_fma_f32 v156, v180, s10, v5
    v_fma_f32 v157, v181, s10, v5
    v_fma_f32 v158, v182, s10, v5
    v_fma_f32 v159, v183, s10, v5
    v_fma_f32 v160, v200, s10, v5
    v_fma_f32 v161, v201, s10, v5
    v_fma_f32 v162, v202, s10, v5
    v_fma_f32 v163, v203, s10, v5
    v_exp_f32_e64 v156, v156 clamp
    v_max_f32 v180, s11, v180
    v_exp_f32_e64 v157, v157 clamp
    v_max_f32 v181, s11, v181
    v_exp_f32_e64 v158, v158 clamp
    v_max_f32 v182, s11, v182
    v_exp_f32_e64 v159, v159 clamp
    v_max_f32 v183, s11, v183
    v_exp_f32_e64 v160, v160 clamp
    v_max_f32 v200, s11, v200
    v_exp_f32_e64 v161, v161 clamp
    v_max_f32 v201, s11, v201
    v_exp_f32_e64 v162, v162 clamp
    v_max_f32 v202, s11, v202
    v_exp_f32_e64 v163, v163 clamp
    v_max_f32 v203, s11, v203
    v_add_f32 v180, v180, v156
    v_add_f32 v181, v181, v157
    v_add_f32 v182, v182, v158
    v_add_f32 v183, v183, v159
    v_add_f32 v200, v200, v160
    v_add_f32 v201, v201, v161
    v_add_f32 v202, v202, v162
    v_add_f32 v203, v203, v163
    v_fma_f32 v156, v220, s10, v5
    v_fma_f32 v157, v221, s10, v5
    v_fma_f32 v158, v222, s10, v5
    v_fma_f32 v159, v223, s10, v5
    v_fma_f32 v160, v240, s10, v5
    v_fma_f32 v161, v241, s10, v5
    v_fma_f32 v162, v242, s10, v5
    v_fma_f32 v163, v243, s10, v5
    v_exp_f32_e64 v156, v156 clamp
    v_max_f32 v220, s11, v220
    v_exp_f32_e64 v157, v157 clamp
    v_max_f32 v221, s11, v221
    v_exp_f32_e64 v158, v158 clamp
    v_max_f32 v222, s11, v222
    v_exp_f32_e64 v159, v159 clamp
    v_max_f32 v223, s11, v223
    v_exp_f32_e64 v160, v160 clamp
    v_max_f32 v240, s11, v240
    v_exp_f32_e64 v161, v161 clamp
    v_max_f32 v241, s11, v241
    v_exp_f32_e64 v162, v162 clamp
    v_max_f32 v242, s11, v242
    v_exp_f32_e64 v163, v163 clamp
    v_max_f32 v243, s11, v243
    v_add_f32 v220, v220, v156
    v_add_f32 v221, v221, v157
    v_add_f32 v222, v222, v158
    v_add_f32 v223, v223, v159
    v_add_f32 v240, v240, v160
    v_add_f32 v241, v241, v161
    v_add_f32 v242, v242, v162
    v_add_f32 v243, v243, v163
    s_mov_b32 exec_lo, 0x00ff00ff
    s_mov_b32 exec_hi, 0x00ff00ff
    v_fma_f32 v156, v192, s10, v5
    v_fma_f32 v157, v193, s10, v5
    v_fma_f32 v158, v194, s10, v5
    v_fma_f32 v159, v195, s10, v5
    v_fma_f32 v160, v212, s10, v5
    v_fma_f32 v161, v213, s10, v5
    v_fma_f32 v162, v214, s10, v5
    v_fma_f32 v163, v215, s10, v5
    v_exp_f32_e64 v156, v156 clamp
    v_max_f32 v192, s11, v192
    v_exp_f32_e64 v157, v157 clamp
    v_max_f32 v193, s11, v193
    v_exp_f32_e64 v158, v158 clamp
    v_max_f32 v194, s11, v194
    v_exp_f32_e64 v159, v159 clamp
    v_max_f32 v195, s11, v195
    v_exp_f32_e64 v160, v160 clamp
    v_max_f32 v212, s11, v212
    v_exp_f32_e64 v161, v161 clamp
    v_max_f32 v213, s11, v213
    v_exp_f32_e64 v162, v162 clamp
    v_max_f32 v214, s11, v214
    v_exp_f32_e64 v163, v163 clamp
    v_max_f32 v215, s11, v215
    v_add_f32 v192, v192, v156
    v_add_f32 v193, v193, v157
    v_add_f32 v194, v194, v158
    v_add_f32 v195, v195, v159
    v_add_f32 v212, v212, v160
    v_add_f32 v213, v213, v161
    v_add_f32 v214, v214, v162
    v_add_f32 v215, v215, v163
    v_fma_f32 v156, v232, s10, v5
    v_fma_f32 v157, v233, s10, v5
    v_fma_f32 v158, v234, s10, v5
    v_fma_f32 v159, v235, s10, v5
    v_fma_f32 v160, v252, s10, v5
    v_fma_f32 v161, v253, s10, v5
    v_fma_f32 v162, v254, s10, v5
    v_fma_f32 v163, v255, s10, v5
    v_exp_f32_e64 v156, v156 clamp
    v_max_f32 v232, s11, v232
    v_exp_f32_e64 v157, v157 clamp
    v_max_f32 v233, s11, v233
    v_exp_f32_e64 v158, v158 clamp
    v_max_f32 v234, s11, v234
    v_exp_f32_e64 v159, v159 clamp
    v_max_f32 v235, s11, v235
    v_exp_f32_e64 v160, v160 clamp
    v_max_f32 v252, s11, v252
    v_exp_f32_e64 v161, v161 clamp
    v_max_f32 v253, s11, v253
    v_exp_f32_e64 v162, v162 clamp
    v_max_f32 v254, s11, v254
    v_exp_f32_e64 v163, v163 clamp
    v_max_f32 v255, s11, v255
    v_add_f32 v232, v232, v156
    v_add_f32 v233, v233, v157
    v_add_f32 v234, v234, v158
    v_add_f32 v235, v235, v159
    v_add_f32 v252, v252, v160
    v_add_f32 v253, v253, v161
    v_add_f32 v254, v254, v162
    v_add_f32 v255, v255, v163
    s_mov_b64 exec, -1
    v_cvt_pk_bf16_f32 v100, v192, v193
    v_cvt_pk_bf16_f32 v101, v194, v195
    v_cvt_pk_bf16_f32 v102, v212, v213
    v_cvt_pk_bf16_f32 v103, v214, v215
    v_cvt_pk_bf16_f32 v84, v176, v177
    v_cvt_pk_bf16_f32 v85, v178, v179
    v_cvt_pk_bf16_f32 v86, v196, v197
    v_cvt_pk_bf16_f32 v87, v198, v199
    v_cvt_pk_bf16_f32 v88, v180, v181
    v_cvt_pk_bf16_f32 v89, v182, v183
    v_cvt_pk_bf16_f32 v90, v200, v201
    v_cvt_pk_bf16_f32 v91, v202, v203
    v_cvt_pk_bf16_f32 v92, v184, v185
    v_cvt_pk_bf16_f32 v93, v186, v187
    v_cvt_pk_bf16_f32 v94, v204, v205
    v_cvt_pk_bf16_f32 v95, v206, v207
    v_cvt_pk_bf16_f32 v96, v188, v189
    v_cvt_pk_bf16_f32 v97, v190, v191
    v_cvt_pk_bf16_f32 v98, v208, v209
    v_cvt_pk_bf16_f32 v99, v210, v211
    v_mov_b32_dpp v44, v100 quad_perm:[0,1,2,3] row_mask:0xf bank_mask:0x1
    v_mov_b32_dpp v45, v101 quad_perm:[0,1,2,3] row_mask:0xf bank_mask:0x1
    v_mov_b32_dpp v46, v102 quad_perm:[0,1,2,3] row_mask:0xf bank_mask:0x1
    v_mov_b32_dpp v47, v103 quad_perm:[0,1,2,3] row_mask:0xf bank_mask:0x1
    v_mov_b32_dpp v48, v100 quad_perm:[0,1,2,3] row_mask:0xf bank_mask:0x2
    v_mov_b32_dpp v49, v101 quad_perm:[0,1,2,3] row_mask:0xf bank_mask:0x2
    v_mov_b32_dpp v50, v102 quad_perm:[0,1,2,3] row_mask:0xf bank_mask:0x2
    v_mov_b32_dpp v51, v103 quad_perm:[0,1,2,3] row_mask:0xf bank_mask:0x2
    v_mov_b32_dpp v52, v100 row_ror:8 row_mask:0xf bank_mask:0xc
    v_mov_b32_dpp v53, v101 row_ror:8 row_mask:0xf bank_mask:0xc
    v_mov_b32_dpp v54, v102 row_ror:8 row_mask:0xf bank_mask:0xc
    v_mov_b32_dpp v55, v103 row_ror:8 row_mask:0xf bank_mask:0xc
    v_mov_b32_dpp v56, v100 quad_perm:[0,1,2,3] row_mask:0xf bank_mask:0x4
    v_mov_b32_dpp v57, v101 quad_perm:[0,1,2,3] row_mask:0xf bank_mask:0x4
    v_mov_b32_dpp v58, v102 quad_perm:[0,1,2,3] row_mask:0xf bank_mask:0x4
    v_mov_b32_dpp v59, v103 quad_perm:[0,1,2,3] row_mask:0xf bank_mask:0x4
    v_mov_b32_dpp v60, v100 quad_perm:[0,1,2,3] row_mask:0xf bank_mask:0x8
    v_mov_b32_dpp v61, v101 quad_perm:[0,1,2,3] row_mask:0xf bank_mask:0x8
    v_mov_b32_dpp v62, v102 quad_perm:[0,1,2,3] row_mask:0xf bank_mask:0x8
    v_mov_b32_dpp v63, v103 quad_perm:[0,1,2,3] row_mask:0xf bank_mask:0x8
    v_mfma_f32_16x16x32_bf16 v[124:127], v[84:87], v[92:95], 0
    v_mfma_f32_16x16x32_bf16 v[128:131], v[88:91], v[96:99], 0
    v_mfma_f32_16x16x32_bf16 v[132:135], v[84:87], v[56:59], 0
    v_mfma_f32_16x16x32_bf16 v[136:139], v[44:47], v[92:95], 0
    v_mfma_f32_16x16x32_bf16 v[132:135], v[88:91], v[60:63], v[132:135]
    v_mfma_f32_16x16x32_bf16 v[136:139], v[48:51], v[96:99], v[136:139]
    v_mfma_f32_16x16x32_bf16 v[136:139], v[52:55], v[56:59], v[136:139]
    v_mfma_f32_16x16x32_bf16 v[136:139], v[52:55], v[60:63], v[136:139]
    v_cvt_pk_bf16_f32 v120, v232, v233
    v_cvt_pk_bf16_f32 v121, v234, v235
    v_cvt_pk_bf16_f32 v122, v252, v253
    v_cvt_pk_bf16_f32 v123, v254, v255
    v_cvt_pk_bf16_f32 v104, v216, v217
    v_cvt_pk_bf16_f32 v105, v218, v219
    v_cvt_pk_bf16_f32 v106, v236, v237
    v_cvt_pk_bf16_f32 v107, v238, v239
    v_cvt_pk_bf16_f32 v108, v220, v221
    v_cvt_pk_bf16_f32 v109, v222, v223
    v_cvt_pk_bf16_f32 v110, v240, v241
    v_cvt_pk_bf16_f32 v111, v242, v243
    v_cvt_pk_bf16_f32 v112, v224, v225
    v_cvt_pk_bf16_f32 v113, v226, v227
    v_cvt_pk_bf16_f32 v114, v244, v245
    v_cvt_pk_bf16_f32 v115, v246, v247
    v_cvt_pk_bf16_f32 v116, v228, v229
    v_cvt_pk_bf16_f32 v117, v230, v231
    v_cvt_pk_bf16_f32 v118, v248, v249
    v_cvt_pk_bf16_f32 v119, v250, v251
    v_mov_b32_dpp v64, v120 quad_perm:[0,1,2,3] row_mask:0xf bank_mask:0x1
    v_mov_b32_dpp v65, v121 quad_perm:[0,1,2,3] row_mask:0xf bank_mask:0x1
    v_mov_b32_dpp v66, v122 quad_perm:[0,1,2,3] row_mask:0xf bank_mask:0x1
    v_mov_b32_dpp v67, v123 quad_perm:[0,1,2,3] row_mask:0xf bank_mask:0x1
    v_mov_b32_dpp v68, v120 quad_perm:[0,1,2,3] row_mask:0xf bank_mask:0x2
    v_mov_b32_dpp v69, v121 quad_perm:[0,1,2,3] row_mask:0xf bank_mask:0x2
    v_mov_b32_dpp v70, v122 quad_perm:[0,1,2,3] row_mask:0xf bank_mask:0x2
    v_mov_b32_dpp v71, v123 quad_perm:[0,1,2,3] row_mask:0xf bank_mask:0x2
    v_mov_b32_dpp v72, v120 row_ror:8 row_mask:0xf bank_mask:0xc
    v_mov_b32_dpp v73, v121 row_ror:8 row_mask:0xf bank_mask:0xc
    v_mov_b32_dpp v74, v122 row_ror:8 row_mask:0xf bank_mask:0xc
    v_mov_b32_dpp v75, v123 row_ror:8 row_mask:0xf bank_mask:0xc
    v_mov_b32_dpp v76, v120 quad_perm:[0,1,2,3] row_mask:0xf bank_mask:0x4
    v_mov_b32_dpp v77, v121 quad_perm:[0,1,2,3] row_mask:0xf bank_mask:0x4
    v_mov_b32_dpp v78, v122 quad_perm:[0,1,2,3] row_mask:0xf bank_mask:0x4
    v_mov_b32_dpp v79, v123 quad_perm:[0,1,2,3] row_mask:0xf bank_mask:0x4
    v_mov_b32_dpp v80, v120 quad_perm:[0,1,2,3] row_mask:0xf bank_mask:0x8
    v_mov_b32_dpp v81, v121 quad_perm:[0,1,2,3] row_mask:0xf bank_mask:0x8
    v_mov_b32_dpp v82, v122 quad_perm:[0,1,2,3] row_mask:0xf bank_mask:0x8
    v_mov_b32_dpp v83, v123 quad_perm:[0,1,2,3] row_mask:0xf bank_mask:0x8
    v_mfma_f32_16x16x32_bf16 v[124:127], v[104:107], v[112:115], v[124:127]
    v_mfma_f32_16x16x32_bf16 v[128:131], v[108:111], v[116:119], v[128:131]
    v_mfma_f32_16x16x32_bf16 v[132:135], v[104:107], v[76:79], v[132:135]
    v_mfma_f32_16x16x32_bf16 v[136:139], v[64:67], v[112:115], v[136:139]
    v_mfma_f32_16x16x32_bf16 v[132:135], v[108:111], v[80:83], v[132:135]
    v_mfma_f32_16x16x32_bf16 v[136:139], v[68:71], v[116:119], v[136:139]
    v_mfma_f32_16x16x32_bf16 v[136:139], v[72:75], v[76:79], v[136:139]
    v_mfma_f32_16x16x32_bf16 v[136:139], v[72:75], v[80:83], v[136:139]
    s_cmp_eq_u32 s68, 0
    s_cbranch_scc1 L_kv_nosw
    s_nop 2
    v_swap_b32 v124, v132
    v_swap_b32 v125, v133
    v_swap_b32 v126, v134
    v_swap_b32 v127, v135
    v_swap_b32 v128, v136
    v_swap_b32 v129, v137
    v_swap_b32 v130, v138
    v_swap_b32 v131, v139
L_kv_nosw:
    s_nop 2
    ds_write_b128 v172, v[132:135]
    s_nop 1
    ds_write_b128 v172, v[136:139] offset:1024
    s_waitcnt vmcnt(0)
    s_cmp_lg_u32 s56, 0
    s_cbranch_scc1 L_one_11
    s_mov_b32 s63, 0
    s_mov_b64 exec, 65535
L_fl_12:
    v_cmp_ne_u32 vcc, 1, v4
    s_add_u32 s63, s63, 1
    s_cbranch_vccz L_fd_13
    s_cmp_ge_u32 s63, 200000
    s_cbranch_scc1 L_fd_13
    s_sleep 2
    buffer_load_dword v4, v21, s[44:47], 0 offen sc1
    s_waitcnt vmcnt(0)
    s_branch L_fl_12
L_fd_13:
    s_mov_b64 exec, -1
L_one_11:
    v_mov_b32 v3, 1
    s_mov_b64 exec, s[12:13]
    ds_write_b32 v174, v3
    s_mov_b64 exec, -1
    ds_read_b32 v3, v174
    ds_read_b128 v[132:135], v173
    ds_read_b128 v[136:139], v173 offset:1024
    s_waitcnt lgkmcnt(0)
L_rl_14:
    v_cmp_gt_u32 vcc, 1, v3
    s_and_b32 s63, vcc_lo, 0x0f
    s_cbranch_scc0 L_rd_15
    ds_read_b32 v3, v174
    ds_read_b128 v[132:135], v173
    ds_read_b128 v[136:139], v173 offset:1024
    s_waitcnt lgkmcnt(0)
    s_branch L_rl_14
L_rd_15:
    v_add_f32 v124, v124, v132
    v_add_f32 v125, v125, v133
    v_add_f32 v126, v126, v134
    v_add_f32 v127, v127, v135
    v_add_f32 v128, v128, v136
    v_add_f32 v129, v129, v137
    v_add_f32 v130, v130, v138
    v_add_f32 v131, v131, v139
    v_cvt_pk_bf16_f32 v132, v124, v125
    v_cvt_pk_bf16_f32 v133, v126, v127
    v_cvt_pk_bf16_f32 v134, v128, v129
    v_cvt_pk_bf16_f32 v135, v130, v131
    s_bitcmp0_b32 s61, 0
    s_cbranch_scc1 L_kv_even
    v_swap_b32 v132, v134
    v_swap_b32 v133, v135
L_kv_even:
    buffer_store_dwordx4 v[132:135], v20, s[44:47], s8 offen sc1
    s_add_u32 s4, s67, 4096
    s_add_u32 s5, s67, 8192
    s_add_u32 s6, s67, 12288
    s_mov_b32 s7, 0
    s_add_u32 s64, s56, 0
    s_mul_i32 s65, s64, 5120
    s_mul_i32 s64, s64, 40960
    s_lshr_b32 s66, s58, 2
    s_mul_i32 s66, s66, 160
    s_add_u32 s64, s64, s66
    s_add_u32 m0, s65, 32800
    s_nop 0
    buffer_load_dwordx4 v22, s[40:43], s64 offen lds
    s_add_u32 m0, s65, 33824
    s_nop 0
    buffer_load_dwordx4 v23, s[40:43], s64 offen lds
    s_add_u32 m0, s65, 34848
    s_nop 0
    buffer_load_dwordx4 v24, s[40:43], s64 offen lds
    s_add_u32 m0, s65, 35872
    s_nop 0
    buffer_load_dwordx4 v25, s[40:43], s64 offen lds
    s_add_u32 m0, s65, 36896
    s_nop 0
    buffer_load_dwordx4 v26, s[40:43], s64 offen lds
L_rl_16:
    v_cmp_gt_u32 vcc, 1, v3
    s_and_b32 s63, vcc_lo, 0xf0
    s_cbranch_scc0 L_rd_17
    ds_read_b32 v3, v174
    s_sleep 1
    s_waitcnt lgkmcnt(0)
    s_branch L_rl_16
L_rd_17:
    s_add_u32 s64, s56, 8
    s_mul_i32 s65, s64, 5120
    s_mul_i32 s64, s64, 40960
    s_lshr_b32 s66, s58, 2
    s_mul_i32 s66, s66, 160
    s_add_u32 s64, s64, s66
    s_add_u32 m0, s65, 32800
    s_nop 0
    buffer_load_dwordx4 v22, s[40:43], s64 offen lds
    s_add_u32 m0, s65, 33824
    s_nop 0
    buffer_load_dwordx4 v23, s[40:43], s64 offen lds
    s_add_u32 m0, s65, 34848
    s_nop 0
    buffer_load_dwordx4 v24, s[40:43], s64 offen lds
    s_add_u32 m0, s65, 35872
    s_nop 0
    buffer_load_dwordx4 v25, s[40:43], s64 offen lds
    s_add_u32 m0, s65, 36896
    s_nop 0
    buffer_load_dwordx4 v26, s[40:43], s64 offen lds
    s_add_u32 s64, s56, 12
    s_mul_i32 s65, s64, 5120
    s_mul_i32 s64, s64, 40960
    s_lshr_b32 s66, s58, 2
    s_mul_i32 s66, s66, 160
    s_add_u32 s64, s64, s66
    s_add_u32 m0, s65, 32800
    s_nop 0
    buffer_load_dwordx4 v22, s[40:43], s64 offen lds
    s_add_u32 m0, s65, 33824
    s_nop 0
    buffer_load_dwordx4 v23, s[40:43], s64 offen lds
    s_add_u32 m0, s65, 34848
    s_nop 0
    buffer_load_dwordx4 v24, s[40:43], s64 offen lds
    s_add_u32 m0, s65, 35872
    s_nop 0
    buffer_load_dwordx4 v25, s[40:43], s64 offen lds
    s_add_u32 m0, s65, 36896
    s_nop 0
    buffer_load_dwordx4 v26, s[40:43], s64 offen lds
    buffer_load_dwordx4 v[176:179], v20, s[44:47], s67 offen offset:0 sc1
    buffer_load_dwordx4 v[180:183], v20, s[44:47], s67 offen offset:1024 sc1
    buffer_load_dwordx4 v[184:187], v20, s[44:47], s67 offen offset:2048 sc1
    buffer_load_dwordx4 v[188:191], v20, s[44:47], s67 offen offset:3072 sc1
    buffer_load_dwordx4 v[192:195], v20, s[44:47], s4 offen offset:0 sc1
    buffer_load_dwordx4 v[196:199], v20, s[44:47], s4 offen offset:1024 sc1
    buffer_load_dwordx4 v[200:203], v20, s[44:47], s4 offen offset:2048 sc1
    buffer_load_dwordx4 v[204:207], v20, s[44:47], s4 offen offset:3072 sc1
    buffer_load_dwordx4 v[208:211], v20, s[44:47], s5 offen offset:0 sc1
    buffer_load_dwordx4 v[212:215], v20, s[44:47], s5 offen offset:1024 sc1
    buffer_load_dwordx4 v[216:219], v20, s[44:47], s5 offen offset:2048 sc1
    buffer_load_dwordx4 v[220:223], v20, s[44:47], s5 offen offset:3072 sc1
    buffer_load_dwordx4 v[224:227], v20, s[44:47], s6 offen offset:0 sc1
    buffer_load_dwordx4 v[228:231], v20, s[44:47], s6 offen offset:1024 sc1
    buffer_load_dwordx4 v[232:235], v20, s[44:47], s6 offen offset:2048 sc1
    buffer_load_dwordx4 v[236:239], v20, s[44:47], s6 offen offset:3072 sc1
    ds_read_b32 v3, v27
    s_waitcnt lgkmcnt(0)
L_rl_18:
    v_cmp_gt_u32 vcc, 1, v3
    s_and_b32 s63, vcc_lo, 0xf0
    s_cbranch_scc0 L_rd_19
    ds_read_b32 v3, v27
    s_sleep 1
    s_waitcnt lgkmcnt(0)
    s_branch L_rl_18
L_rd_19:
    s_add_u32 s64, s56, 16
    s_mul_i32 s65, s64, 5120
    s_mul_i32 s64, s64, 40960
    s_lshr_b32 s66, s58, 2
    s_mul_i32 s66, s66, 160
    s_add_u32 s64, s64, s66
    s_add_u32 m0, s65, 32800
    s_nop 0
    buffer_load_dwordx4 v22, s[40:43], s64 offen lds
    s_add_u32 m0, s65, 33824
    s_nop 0
    buffer_load_dwordx4 v23, s[40:43], s64 offen lds
    s_add_u32 m0, s65, 34848
    s_nop 0
    buffer_load_dwordx4 v24, s[40:43], s64 offen lds
    s_add_u32 m0, s65, 35872
    s_nop 0
    buffer_load_dwordx4 v25, s[40:43], s64 offen lds
    s_add_u32 m0, s65, 36896
    s_nop 0
    buffer_load_dwordx4 v26, s[40:43], s64 offen lds
    s_waitcnt vmcnt(20)
    v_mfma_f32_16x16x32_bf16 v[124:127], v[40:43], v[176:179], 0
    s_waitcnt vmcnt(19)
    v_mfma_f32_16x16x32_bf16 v[128:131], v[38:41], v[178:181], 0
    s_waitcnt vmcnt(18)
    v_mfma_f32_16x16x32_bf16 v[124:127], v[38:41], v[182:185], v[124:127]
    v_max3_u32 v3, v179, v183, v187
    s_waitcnt vmcnt(17)
    v_mfma_f32_16x16x32_bf16 v[128:131], v[38:41], v[186:189], v[128:131]
    s_waitcnt vmcnt(16)
    v_mfma_f32_16x16x32_bf16 v[124:127], v[38:41], v[190:193], v[124:127]
    v_max3_u32 v3, v3, v191, v195
    s_waitcnt vmcnt(15)
    v_mfma_f32_16x16x32_bf16 v[128:131], v[38:41], v[194:197], v[128:131]
    s_waitcnt vmcnt(14)
    v_mfma_f32_16x16x32_bf16 v[124:127], v[38:41], v[198:201], v[124:127]
    v_max3_u32 v3, v3, v199, v203
    s_waitcnt vmcnt(13)
    v_mfma_f32_16x16x32_bf16 v[128:131], v[38:41], v[202:205], v[128:131]
    s_waitcnt vmcnt(12)
    v_mfma_f32_16x16x32_bf16 v[124:127], v[38:41], v[206:209], v[124:127]
    v_max3_u32 v3, v3, v207, v211
    s_waitcnt vmcnt(11)
    v_mfma_f32_16x16x32_bf16 v[128:131], v[38:41], v[210:213], v[128:131]
    s_waitcnt vmcnt(10)
    v_mfma_f32_16x16x32_bf16 v[124:127], v[38:41], v[214:217], v[124:127]
    v_max3_u32 v3, v3, v215, v219
    s_waitcnt vmcnt(9)
    v_mfma_f32_16x16x32_bf16 v[128:131], v[38:41], v[218:221], v[128:131]
    s_waitcnt vmcnt(8)
    v_mfma_f32_16x16x32_bf16 v[124:127], v[38:41], v[222:225], v[124:127]
    v_max3_u32 v3, v3, v223, v227
    s_waitcnt vmcnt(7)
    v_mfma_f32_16x16x32_bf16 v[128:131], v[38:41], v[226:229], v[128:131]
    s_waitcnt vmcnt(6)
    v_mfma_f32_16x16x32_bf16 v[124:127], v[38:41], v[230:233], v[124:127]
    v_max3_u32 v3, v3, v231, v235
    s_waitcnt vmcnt(5)
    v_mfma_f32_16x16x32_bf16 v[128:131], v[38:41], v[234:237], v[128:131]
    v_mfma_f32_16x16x32_bf16 v[124:127], v[36:39], v[236:239], v[124:127]
    v_max3_u32 v3, v3, v239, v239
    v_cmp_eq_u32 vcc, -1, v3
    s_cbranch_vccz L_kv_got
L_kv_retry:
    s_add_u32 s7, s7, 1
    v_cmp_eq_u32_e64 s[12:13], -1, v179
    v_cmp_eq_u32_e64 s[14:15], -1, v183
    v_cmp_eq_u32_e64 s[16:17], -1, v187
    v_cmp_eq_u32_e64 s[18:19], -1, v191
    v_cmp_eq_u32_e64 s[20:21], -1, v195
    v_cmp_eq_u32_e64 s[22:23], -1, v199
    v_cmp_eq_u32_e64 s[24:25], -1, v203
    v_cmp_eq_u32_e64 s[26:27], -1, v207
    v_cmp_eq_u32_e64 s[28:29], -1, v211
    v_cmp_eq_u32_e64 s[30:31], -1, v215
    s_mov_b64 exec, s[12:13]
    buffer_load_dwordx4 v[176:179], v20, s[44:47], s67 offen offset:0 sc1
    s_mov_b64 exec, s[14:15]
    buffer_load_dwordx4 v[180:183], v20, s[44:47], s67 offen offset:1024 sc1
    s_mov_b64 exec, s[16:17]
    buffer_load_dwordx4 v[184:187], v20, s[44:47], s67 offen offset:2048 sc1
    s_mov_b64 exec, s[18:19]
    buffer_load_dwordx4 v[188:191], v20, s[44:47], s67 offen offset:3072 sc1
    s_mov_b64 exec, s[20:21]
    buffer_load_dwordx4 v[192:195], v20, s[44:47], s4 offen offset:0 sc1
    s_mov_b64 exec, s[22:23]
    buffer_load_dwordx4 v[196:199], v20, s[44:47], s4 offen offset:1024 sc1
    s_mov_b64 exec, s[24:25]
    buffer_load_dwordx4 v[200:203], v20, s[44:47], s4 offen offset:2048 sc1
    s_mov_b64 exec, s[26:27]
    buffer_load_dwordx4 v[204:207], v20, s[44:47], s4 offen offset:3072 sc1
    s_mov_b64 exec, s[28:29]
    buffer_load_dwordx4 v[208:211], v20, s[44:47], s5 offen offset:0 sc1
    s_mov_b64 exec, s[30:31]
    buffer_load_dwordx4 v[212:215], v20, s[44:47], s5 offen offset:1024 sc1
    s_mov_b64 exec, -1
    v_cmp_eq_u32_e64 s[12:13], -1, v219
    v_cmp_eq_u32_e64 s[14:15], -1, v223
    v_cmp_eq_u32_e64 s[16:17], -1, v227
    v_cmp_eq_u32_e64 s[18:19], -1, v231
    v_cmp_eq_u32_e64 s[20:21], -1, v235
    v_cmp_eq_u32_e64 s[22:23], -1, v239
    s_mov_b64 exec, s[12:13]
    buffer_load_dwordx4 v[216:219], v20, s[44:47], s5 offen offset:2048 sc1
    s_mov_b64 exec, s[14:15]
    buffer_load_dwordx4 v[220:223], v20, s[44:47], s5 offen offset:3072 sc1
    s_mov_b64 exec, s[16:17]
    buffer_load_dwordx4 v[224:227], v20, s[44:47], s6 offen offset:0 sc1
    s_mov_b64 exec, s[18:19]
    buffer_load_dwordx4 v[228:231], v20, s[44:47], s6 offen offset:1024 sc1
    s_mov_b64 exec, s[20:21]
    buffer_load_dwordx4 v[232:235], v20, s[44:47], s6 offen offset:2048 sc1
    s_mov_b64 exec, s[22:23]
    buffer_load_dwordx4 v[236:239], v20, s[44:47], s6 offen offset:3072 sc1
    s_mov_b64 exec, -1
    s_waitcnt vmcnt(15)
    v_mfma_f32_16x16x32_bf16 v[124:127], v[40:43], v[176:179], 0
    s_waitcnt vmcnt(14)
    v_mfma_f32_16x16x32_bf16 v[128:131], v[38:41], v[178:181], 0
    s_waitcnt vmcnt(13)
    v_mfma_f32_16x16x32_bf16 v[124:127], v[38:41], v[182:185], v[124:127]
    v_max3_u32 v3, v179, v183, v187
    s_waitcnt vmcnt(12)
    v_mfma_f32_16x16x32_bf16 v[128:131], v[38:41], v[186:189], v[128:131]
    s_waitcnt vmcnt(11)
    v_mfma_f32_16x16x32_bf16 v[124:127], v[38:41], v[190:193], v[124:127]
    v_max3_u32 v3, v3, v191, v195
    s_waitcnt vmcnt(10)
    v_mfma_f32_16x16x32_bf16 v[128:131], v[38:41], v[194:197], v[128:131]
    s_waitcnt vmcnt(9)
    v_mfma_f32_16x16x32_bf16 v[124:127], v[38:41], v[198:201], v[124:127]
    v_max3_u32 v3, v3, v199, v203
    s_waitcnt vmcnt(8)
    v_mfma_f32_16x16x32_bf16 v[128:131], v[38:41], v[202:205], v[128:131]
    s_waitcnt vmcnt(7)
    v_mfma_f32_16x16x32_bf16 v[124:127], v[38:41], v[206:209], v[124:127]
    v_max3_u32 v3, v3, v207, v211
    s_waitcnt vmcnt(6)
    v_mfma_f32_16x16x32_bf16 v[128:131], v[38:41], v[210:213], v[128:131]
    s_waitcnt vmcnt(5)
    v_mfma_f32_16x16x32_bf16 v[124:127], v[38:41], v[214:217], v[124:127]
    v_max3_u32 v3, v3, v215, v219
    s_waitcnt vmcnt(4)
    v_mfma_f32_16x16x32_bf16 v[128:131], v[38:41], v[218:221], v[128:131]
    s_waitcnt vmcnt(3)
    v_mfma_f32_16x16x32_bf16 v[124:127], v[38:41], v[222:225], v[124:127]
    v_max3_u32 v3, v3, v223, v227
    s_waitcnt vmcnt(2)
    v_mfma_f32_16x16x32_bf16 v[128:131], v[38:41], v[226:229], v[128:131]
    s_waitcnt vmcnt(1)
    v_mfma_f32_16x16x32_bf16 v[124:127], v[38:41], v[230:233], v[124:127]
    v_max3_u32 v3, v3, v231, v235
    s_waitcnt vmcnt(0)
    v_mfma_f32_16x16x32_bf16 v[128:131], v[38:41], v[234:237], v[128:131]
    v_mfma_f32_16x16x32_bf16 v[124:127], v[36:39], v[236:239], v[124:127]
    v_max3_u32 v3, v3, v239, v239
    v_cmp_eq_u32 vcc, -1, v3
    s_cmp_ge_u32 s7, 200000
    s_cbranch_scc1 L_kv_got
    s_cbranch_vccnz L_kv_retry
L_kv_got:
    s_nop 3
    v_cvt_pk_bf16_f32 v134, v128, v129
    v_cvt_pk_bf16_f32 v135, v130, v131
    v_cvt_pk_bf16_f32 v132, v124, v125
    v_cvt_pk_bf16_f32 v133, v126, v127
    ds_write_b64 v19, v[134:135]
    ds_write_b64 v18, v[132:133]
    s_lshl_b64 s[12:13], 1, s56
    v_mov_b32 v3, 2
    s_mov_b64 exec, s[12:13]
    ds_write_b32 v27, v3
    s_mov_b64 exec, -1
    ds_read_b32 v3, v27
    s_setprio 0
    s_waitcnt lgkmcnt(0)
L_rl_20:
    v_cmp_gt_u32 vcc, 1, v3
    s_and_b32 s63, vcc_lo, 0xff
    s_cbranch_scc0 L_rd_21
    ds_read_b32 v3, v27
    s_sleep 1
    s_waitcnt lgkmcnt(0)
    s_branch L_rl_20
L_rd_21:
    s_movk_i32 s3, 15
    s_mov_b32 s59, 32800
    s_branch L_outproj2
L_conv:
    s_sub_u32 s63, s58, 16
    s_lshl_b32 s64, s57, 3
    s_lshl_b32 s65, s57, 1
    s_add_u32 s65, s65, 56
    s_cmp_lt_u32 s63, 8
    s_cselect_b32 s61, s64, s65
    s_add_u32 s61, s61, s63
    s_lshl_b32 s68, s61, 3
    s_add_u32 s68, s68, s56
    v_mov_b32 v1, 0
    v_mov_b32 v2, 1
    s_lshl_b32 s63, s68, 8
    v_lshl_add_u32 v4, v0, 2, s63
    v_lshlrev_b32_e64 v5, 1, s68
    s_waitcnt lgkmcnt(0)
    global_load_dword v10, v4, s[12:13]
    global_load_dword v11, v4, s[14:15]
    global_load_ushort v14, v5, s[20:21]
    global_load_dword v12, v4, s[16:17]
    global_load_dword v13, v4, s[18:19]
    global_load_ushort v15, v5, s[22:23]
    v_mul_u32_u24 v16, 1280, v0
    v_mul_u32_u24 v17, 3840, v0
    s_mov_b32 s34, 2621440
    s_mov_b32 s35, 0x20000
    s_mov_b32 s38, 2457600
    s_mov_b32 s39, 0x20000
    s_mov_b32 s46, 268435456
    s_mov_b32 s47, 0x20000
    s_mov_b32 s42, 819200
    s_mov_b32 s43, 0x20000
    s_mov_b32 s50, 256
    s_mov_b32 s51, 0x20000
    s_mov_b32 s54, 2621440
    s_mov_b32 s55, 0x20000
    s_waitcnt lgkmcnt(0)
    s_mov_b64 s[32:33], s[4:5]
    s_mov_b64 s[36:37], s[6:7]
    s_mov_b64 s[44:45], s[30:31]
    s_mov_b64 s[40:41], s[8:9]
    s_mov_b64 s[48:49], s[28:29]
    s_mov_b64 s[52:53], s[26:27]
    s_mul_i32 s67, s56, 10
    s_add_u32 s67, s67, s58
    s_sub_u32 s67, s67, 16
    v_and_b32 v7, 15, v0
    v_ashrrev_i32 v8, 4, v0
    s_mul_i32 s63, s56, 327680
    s_lshl_b32 s64, s61, 4
    s_mul_i32 s65, s56, 8704
    s_add_u32 s63, s63, s64
    s_add_u32 s65, s65, 75808
    s_mul_i32 s69, s56, 1824
    s_mul_i32 s3, s56, 4672
    s_add_u32 s69, s69, 145440
    s_movk_i32 s64, 544
    v_add_u32 v6, s63, v16
    v_lshl_add_u32 v4, v0, 3, s65
    v_lshl_add_u32 v5, v8, 4, s65
    v_lshl_add_u32 v26, v0, 3, s3
    v_mad_u32_u24 v5, v7, s64, v5
    v_lshl_add_u32 v27, v0, 4, s69
    s_mov_b32 s63, 469762048
    v_mov_b32 v28, 0
    v_mov_b32 v29, 0
    v_mov_b32 v30, 0
    v_mov_b32 v31, 0
    s_cmp_eq_u32 s56, 1
    s_cselect_b32 s63, 65011712, s63
    s_cmp_eq_u32 s56, 2
    s_cselect_b32 s63, 1835008, s63
    s_cmp_eq_u32 s56, 3
    s_cselect_b32 s63, 65011712, s63
    s_cmp_eq_u32 s56, 4
    s_cselect_b32 s63, 133169152, s63
    s_cmp_eq_u32 s56, 5
    s_cselect_b32 s63, 267911168, s63
    s_cmp_eq_u32 s56, 6
    s_cselect_b32 s63, 402653184, s63
    s_cselect_b32 s64, 1, 0x3f80
    ds_write_b64 v26, v[28:29]
    ds_write_b128 v27, v[28:31]
    ds_write_b128 v27, v[28:31] offset:800
    v_lshlrev_b32 v234, 3, v8
    s_lshl_b32 s65, s56, 10
    v_sub_u32 v233, v7, v234
    s_cmp_lt_u32 s56, 5
    v_sub_u32 v232, 15, v233
    s_cselect_b32 s66, 0, 117536
    v_min_u32 v232, 31, v232
    s_add_u32 s65, s65, s66
    v_lshrrev_b32_e64 v230, v232, s63
    s_add_u32 s65, s65, 37376
    v_and_b32 v231, 0xaa, v230
    v_and_b32 v230, 0x55, v230
    v_lshl_add_u32 v235, v0, 4, s65
    v_lshl_or_b32 v230, v231, 15, v230
    v_and_b32 v36, 0x10001, v230
    v_mul_u32_u24 v36, s64, v36
    v_lshrrev_b32 v37, 2, v230
    v_and_b32 v37, 0x10001, v37
    v_mul_u32_u24 v37, s64, v37
    v_lshrrev_b32 v38, 4, v230
    v_and_b32 v38, 0x10001, v38
    v_mul_u32_u24 v38, s64, v38
    v_lshrrev_b32 v39, 6, v230
    v_and_b32 v39, 0x10001, v39
    v_mul_u32_u24 v39, s64, v39
    ds_write_b128 v235, v[36:39]
    v_add_u32 v233, 15, v233
    v_and_b32 v232, 1, v233
    s_mov_b32 s63, 33686018
    v_ashrrev_i32 v233, 1, v233
    v_mul_lo_u32 v232, v232, s63
    s_add_u32 s63, s69, 20
    v_lshl_add_u32 v25, v233, 2, s63
    v_add_u32 v26, 16777986, v232
    v_lshlrev_b32 v232, 7, v8
    s_add_u32 s63, s69, 1568
    v_lshl_add_u32 v233, v7, 1, v232
    v_lshl_add_u32 v231, v7, 2, v232
    v_lshl_add_u32 v230, v7, 3, v232
    v_add_u32 v31, s63, v233
    s_add_u32 s63, s69, 928
    s_add_u32 s64, s69, 548
    v_add_u32 v30, s63, v231
    s_mov_b32 exec_hi, 0
    v_lshl_add_u32 v30, v230, 1, s64
    s_mov_b32 exec_hi, -1
    v_and_b32 v232, 0x100, v232
    v_and_b32 v234, 8, v234
    v_lshl_add_u32 v232, v7, 4, v232
    s_add_u32 s63, s69, 32
    v_mov_b32 v32, s69
    v_add3_u32 v29, v232, v234, s63
    s_add_i32 s63, s67, 66
    s_mul_i32 s64, s63, 3641
    s_lshr_b32 s64, s64, 16
    s_mul_i32 s65, s64, 18
    s_sub_u32 s65, s63, s65
    s_cmp_ge_u32 s65, 8
    s_cbranch_scc1 L_pfw_24
    s_lshr_b32 s66, s57, 1
    s_lshl_b32 s66, s66, 3
    s_add_u32 s65, s65, s66
    s_mul_i32 s65, s65, 81920
    s_lshl_b32 s64, s64, 7
    s_add_u32 s64, s64, s65
    buffer_load_dword v19, v16, s[32:35], s64 offen
    s_branch L_pfe_25
L_pfw_24:
    s_mul_i32 s64, s64, 245760
    s_cmp_ge_u32 s65, 13
    s_cselect_b32 s66, 7, 2
    s_add_u32 s65, s65, s66
    s_and_b32 s66, s57, 1
    s_mul_i32 s66, s66, 5
    s_add_u32 s65, s65, s66
    s_lshl_b32 s65, s65, 7
    s_add_u32 s64, s64, s65
    buffer_load_dword v19, v17, s[36:39], s64 offen
L_pfe_25:
L_pe_22:
    s_mov_b32 s4, 5242880
    s_lshl_b32 s60, s61, 7
    s_add_u32 s60, s60, 8429568
    s_waitcnt vmcnt(1)
    s_mov_b32 s10, 1069066811
    s_mov_b32 s11, 0x3e22f983
    s_lshl_b32 s66, s56, 12
    s_cmp_lt_u32 s56, 4
    s_cbranch_scc1 L_cv_ge
    s_add_u32 s63, s58, 0
    s_and_b32 s63, s63, 3
    s_mul_i32 s64, s63, 81920
    s_lshl_b32 s63, s63, 10
    s_add_u32 s63, s63, s66
    s_add_u32 m0, s63, 43040
    s_nop 0
    buffer_load_dwordx4 v6, s[32:35], s64 offen lds
    s_add_u32 s63, s58, 1
    s_and_b32 s63, s63, 3
    s_mul_i32 s64, s63, 81920
    s_lshl_b32 s63, s63, 10
    s_add_u32 s63, s63, s66
    s_add_u32 m0, s63, 43040
    s_nop 0
    buffer_load_dwordx4 v6, s[32:35], s64 offen lds
    s_add_u32 s63, s58, 2
    s_and_b32 s63, s63, 3
    s_mul_i32 s64, s63, 81920
    s_lshl_b32 s63, s63, 10
    s_add_u32 s63, s63, s66
    s_add_u32 m0, s63, 43040
    s_nop 0
    buffer_load_dwordx4 v6, s[32:35], s64 offen lds
    s_add_u32 s63, s58, 3
    s_and_b32 s63, s63, 3
    s_mul_i32 s64, s63, 81920
    s_lshl_b32 s63, s63, 10
    s_add_u32 s63, s63, s66
    s_add_u32 m0, s63, 43040
    s_nop 0
    buffer_load_dwordx4 v6, s[32:35], s64 offen lds
L_cv_ge:
    v_lshlrev_b32 v14, 16, v14
    v_mul_f32 v14, s10, v14
    v_lshlrev_b32 v70, 16, v10
    v_and_b32 v71, 0xffff0000, v10
    v_exp_f32 v14, v14
    v_mul_f32 v70, s10, v70
    v_mul_f32 v71, s10, v71
    v_exp_f32 v70, v70
    v_exp_f32 v71, v71
    v_cvt_pk_bf16_f32 v14, v14, v14
    v_lshlrev_b32 v72, 16, v11
    v_and_b32 v73, 0xffff0000, v11
    v_cvt_pk_bf16_f32 v10, v70, v71
    v_lshlrev_b32 v14, 16, v14
    v_lshlrev_b32 v70, 16, v10
    v_and_b32 v71, 0xffff0000, v10
    v_lshlrev_b32 v15, 16, v15
    v_mul_f32 v70, v70, v14
    v_mul_f32 v71, v71, v14
    v_mul_f32 v72, v72, v14
    v_mul_f32 v73, v73, v14
    v_mul_f32 v70, s10, v70
    v_mul_f32 v72, s11, v72
    v_mul_f32 v71, s10, v71
    v_mul_f32 v73, s11, v73
    v_mul_f32 v230, 0x41000000, v70
    v_mul_f32 v231, 0x41000000, v72
    v_mul_f32 v232, 0x41000000, v71
    v_mul_f32 v233, 0x41000000, v73
    v_exp_f32_e64 v230, -v230
    v_fract_f32 v231, v231
    v_exp_f32_e64 v232, -v232
    v_fract_f32 v233, v233
    v_cos_f32 v74, v231
    v_sin_f32 v75, v231
    v_cos_f32 v76, v233
    v_sin_f32 v77, v233
    v_mul_f32 v74, v74, v230
    v_mul_f32_e64 v75, v75, v230
    v_mul_f32 v76, v76, v232
    v_mul_f32_e64 v77, v77, v232
    v_add_f32 v14, v14, v14
    v_lshlrev_b32 v118, 16, v12
    v_lshlrev_b32 v119, 16, v13
    v_and_b32 v120, 0xffff0000, v12
    v_and_b32 v121, 0xffff0000, v13
    v_mul_f32 v118, v118, v14
    v_mul_f32 v119, v119, v14
    v_mul_f32 v120, v120, v14
    v_mul_f32 v121, v121, v14
    v_pk_mul_f32 v[122:123], v[118:119], v[74:75] op_sel:[0,0] op_sel_hi:[0,1]
    v_pk_mul_f32 v[124:125], v[120:121], v[76:77] op_sel:[0,0] op_sel_hi:[0,1]
    v_pk_fma_f32 v[122:123], v[118:119], v[74:75], v[122:123] op_sel:[1,1,0] op_sel_hi:[1,0,1] neg_lo:[0,1,0]
    v_pk_fma_f32 v[124:125], v[120:121], v[76:77], v[124:125] op_sel:[1,1,0] op_sel_hi:[1,0,1] neg_lo:[0,1,0]
    v_cvt_pk_bf16_f32 v126, v118, v119
    v_cvt_pk_bf16_f32 v127, v120, v121
    ds_write_b64 v4, v[126:127] offset:0
    v_pk_mul_f32 v[118:119], v[122:123], v[74:75] op_sel:[0,0] op_sel_hi:[0,1]
    v_pk_mul_f32 v[120:121], v[124:125], v[76:77] op_sel:[0,0] op_sel_hi:[0,1]
    v_pk_fma_f32 v[118:119], v[122:123], v[74:75], v[118:119] op_sel:[1,1,0] op_sel_hi:[1,0,1] neg_lo:[0,1,0]
    v_pk_fma_f32 v[120:121], v[124:125], v[76:77], v[120:121] op_sel:[1,1,0] op_sel_hi:[1,0,1] neg_lo:[0,1,0]
    v_cvt_pk_bf16_f32 v128, v122, v123
    v_cvt_pk_bf16_f32 v129, v124, v125
    ds_write_b64 v4, v[128:129] offset:544
    v_pk_mul_f32 v[122:123], v[118:119], v[74:75] op_sel:[0,0] op_sel_hi:[0,1]
    v_pk_mul_f32 v[124:125], v[120:121], v[76:77] op_sel:[0,0] op_sel_hi:[0,1]
    v_pk_fma_f32 v[122:123], v[118:119], v[74:75], v[122:123] op_sel:[1,1,0] op_sel_hi:[1,0,1] neg_lo:[0,1,0]
    v_pk_fma_f32 v[124:125], v[120:121], v[76:77], v[124:125] op_sel:[1,1,0] op_sel_hi:[1,0,1] neg_lo:[0,1,0]
    v_cvt_pk_bf16_f32 v130, v118, v119
    v_cvt_pk_bf16_f32 v131, v120, v121
    ds_write_b64 v4, v[130:131] offset:1088
    v_pk_mul_f32 v[118:119], v[122:123], v[74:75] op_sel:[0,0] op_sel_hi:[0,1]
    v_pk_mul_f32 v[120:121], v[124:125], v[76:77] op_sel:[0,0] op_sel_hi:[0,1]
    v_pk_fma_f32 v[118:119], v[122:123], v[74:75], v[118:119] op_sel:[1,1,0] op_sel_hi:[1,0,1] neg_lo:[0,1,0]
    v_pk_fma_f32 v[120:121], v[124:125], v[76:77], v[120:121] op_sel:[1,1,0] op_sel_hi:[1,0,1] neg_lo:[0,1,0]
    v_cvt_pk_bf16_f32 v126, v122, v123
    v_cvt_pk_bf16_f32 v127, v124, v125
    ds_write_b64 v4, v[126:127] offset:1632
    v_pk_mul_f32 v[122:123], v[118:119], v[74:75] op_sel:[0,0] op_sel_hi:[0,1]
    v_pk_mul_f32 v[124:125], v[120:121], v[76:77] op_sel:[0,0] op_sel_hi:[0,1]
    v_pk_fma_f32 v[122:123], v[118:119], v[74:75], v[122:123] op_sel:[1,1,0] op_sel_hi:[1,0,1] neg_lo:[0,1,0]
    v_pk_fma_f32 v[124:125], v[120:121], v[76:77], v[124:125] op_sel:[1,1,0] op_sel_hi:[1,0,1] neg_lo:[0,1,0]
    v_cvt_pk_bf16_f32 v128, v118, v119
    v_cvt_pk_bf16_f32 v129, v120, v121
    ds_write_b64 v4, v[128:129] offset:2176
    v_pk_mul_f32 v[118:119], v[122:123], v[74:75] op_sel:[0,0] op_sel_hi:[0,1]
    v_pk_mul_f32 v[120:121], v[124:125], v[76:77] op_sel:[0,0] op_sel_hi:[0,1]
    v_pk_fma_f32 v[118:119], v[122:123], v[74:75], v[118:119] op_sel:[1,1,0] op_sel_hi:[1,0,1] neg_lo:[0,1,0]
    v_pk_fma_f32 v[120:121], v[124:125], v[76:77], v[120:121] op_sel:[1,1,0] op_sel_hi:[1,0,1] neg_lo:[0,1,0]
    v_cvt_pk_bf16_f32 v130, v122, v123
    v_cvt_pk_bf16_f32 v131, v124, v125
    ds_write_b64 v4, v[130:131] offset:2720
    v_pk_mul_f32 v[122:123], v[118:119], v[74:75] op_sel:[0,0] op_sel_hi:[0,1]
    v_pk_mul_f32 v[124:125], v[120:121], v[76:77] op_sel:[0,0] op_sel_hi:[0,1]
    v_pk_fma_f32 v[122:123], v[118:119], v[74:75], v[122:123] op_sel:[1,1,0] op_sel_hi:[1,0,1] neg_lo:[0,1,0]
    v_pk_fma_f32 v[124:125], v[120:121], v[76:77], v[124:125] op_sel:[1,1,0] op_sel_hi:[1,0,1] neg_lo:[0,1,0]
    v_cvt_pk_bf16_f32 v126, v118, v119
    v_cvt_pk_bf16_f32 v127, v120, v121
    ds_write_b64 v4, v[126:127] offset:3264
    v_pk_mul_f32 v[118:119], v[122:123], v[74:75] op_sel:[0,0] op_sel_hi:[0,1]
    v_pk_mul_f32 v[120:121], v[124:125], v[76:77] op_sel:[0,0] op_sel_hi:[0,1]
    v_pk_fma_f32 v[118:119], v[122:123], v[74:75], v[118:119] op_sel:[1,1,0] op_sel_hi:[1,0,1] neg_lo:[0,1,0]
    v_pk_fma_f32 v[120:121], v[124:125], v[76:77], v[120:121] op_sel:[1,1,0] op_sel_hi:[1,0,1] neg_lo:[0,1,0]
    v_cvt_pk_bf16_f32 v128, v122, v123
    v_cvt_pk_bf16_f32 v129, v124, v125
    ds_write_b64 v4, v[128:129] offset:3808
    v_pk_mul_f32 v[122:123], v[118:119], v[74:75] op_sel:[0,0] op_sel_hi:[0,1]
    v_pk_mul_f32 v[124:125], v[120:121], v[76:77] op_sel:[0,0] op_sel_hi:[0,1]
    v_pk_fma_f32 v[122:123], v[118:119], v[74:75], v[122:123] op_sel:[1,1,0] op_sel_hi:[1,0,1] neg_lo:[0,1,0]
    v_pk_fma_f32 v[124:125], v[120:121], v[76:77], v[124:125] op_sel:[1,1,0] op_sel_hi:[1,0,1] neg_lo:[0,1,0]
    v_cvt_pk_bf16_f32 v130, v118, v119
    v_cvt_pk_bf16_f32 v131, v120, v121
    ds_write_b64 v4, v[130:131] offset:4352
    v_pk_mul_f32 v[118:119], v[122:123], v[74:75] op_sel:[0,0] op_sel_hi:[0,1]
    v_pk_mul_f32 v[120:121], v[124:125], v[76:77] op_sel:[0,0] op_sel_hi:[0,1]
    v_pk_fma_f32 v[118:119], v[122:123], v[74:75], v[118:119] op_sel:[1,1,0] op_sel_hi:[1,0,1] neg_lo:[0,1,0]
    v_pk_fma_f32 v[120:121], v[124:125], v[76:77], v[120:121] op_sel:[1,1,0] op_sel_hi:[1,0,1] neg_lo:[0,1,0]
    v_cvt_pk_bf16_f32 v126, v122, v123
    v_cvt_pk_bf16_f32 v127, v124, v125
    ds_write_b64 v4, v[126:127] offset:4896
    v_pk_mul_f32 v[122:123], v[118:119], v[74:75] op_sel:[0,0] op_sel_hi:[0,1]
    v_pk_mul_f32 v[124:125], v[120:121], v[76:77] op_sel:[0,0] op_sel_hi:[0,1]
    v_pk_fma_f32 v[122:123], v[118:119], v[74:75], v[122:123] op_sel:[1,1,0] op_sel_hi:[1,0,1] neg_lo:[0,1,0]
    v_pk_fma_f32 v[124:125], v[120:121], v[76:77], v[124:125] op_sel:[1,1,0] op_sel_hi:[1,0,1] neg_lo:[0,1,0]
    v_cvt_pk_bf16_f32 v128, v118, v119
    v_cvt_pk_bf16_f32 v129, v120, v121
    ds_write_b64 v4, v[128:129] offset:5440
    v_pk_mul_f32 v[118:119], v[122:123], v[74:75] op_sel:[0,0] op_sel_hi:[0,1]
    v_pk_mul_f32 v[120:121], v[124:125], v[76:77] op_sel:[0,0] op_sel_hi:[0,1]
    v_pk_fma_f32 v[118:119], v[122:123], v[74:75], v[118:119] op_sel:[1,1,0] op_sel_hi:[1,0,1] neg_lo:[0,1,0]
    v_pk_fma_f32 v[120:121], v[124:125], v[76:77], v[120:121] op_sel:[1,1,0] op_sel_hi:[1,0,1] neg_lo:[0,1,0]
    v_cvt_pk_bf16_f32 v130, v122, v123
    v_cvt_pk_bf16_f32 v131, v124, v125
    ds_write_b64 v4, v[130:131] offset:5984
    v_pk_mul_f32 v[122:123], v[118:119], v[74:75] op_sel:[0,0] op_sel_hi:[0,1]
    v_pk_mul_f32 v[124:125], v[120:121], v[76:77] op_sel:[0,0] op_sel_hi:[0,1]
    v_pk_fma_f32 v[122:123], v[118:119], v[74:75], v[122:123] op_sel:[1,1,0] op_sel_hi:[1,0,1] neg_lo:[0,1,0]
    v_pk_fma_f32 v[124:125], v[120:121], v[76:77], v[124:125] op_sel:[1,1,0] op_sel_hi:[1,0,1] neg_lo:[0,1,0]
    v_cvt_pk_bf16_f32 v126, v118, v119
    v_cvt_pk_bf16_f32 v127, v120, v121
    ds_write_b64 v4, v[126:127] offset:6528
    v_pk_mul_f32 v[118:119], v[122:123], v[74:75] op_sel:[0,0] op_sel_hi:[0,1]
    v_pk_mul_f32 v[120:121], v[124:125], v[76:77] op_sel:[0,0] op_sel_hi:[0,1]
    v_pk_fma_f32 v[118:119], v[122:123], v[74:75], v[118:119] op_sel:[1,1,0] op_sel_hi:[1,0,1] neg_lo:[0,1,0]
    v_pk_fma_f32 v[120:121], v[124:125], v[76:77], v[120:121] op_sel:[1,1,0] op_sel_hi:[1,0,1] neg_lo:[0,1,0]
    v_cvt_pk_bf16_f32 v128, v122, v123
    v_cvt_pk_bf16_f32 v129, v124, v125
    ds_write_b64 v4, v[128:129] offset:7072
    v_pk_mul_f32 v[122:123], v[118:119], v[74:75] op_sel:[0,0] op_sel_hi:[0,1]
    v_pk_mul_f32 v[124:125], v[120:121], v[76:77] op_sel:[0,0] op_sel_hi:[0,1]
    v_pk_fma_f32 v[122:123], v[118:119], v[74:75], v[122:123] op_sel:[1,1,0] op_sel_hi:[1,0,1] neg_lo:[0,1,0]
    v_pk_fma_f32 v[124:125], v[120:121], v[76:77], v[124:125] op_sel:[1,1,0] op_sel_hi:[1,0,1] neg_lo:[0,1,0]
    v_cvt_pk_bf16_f32 v130, v118, v119
    v_cvt_pk_bf16_f32 v131, v120, v121
    ds_write_b64 v4, v[130:131] offset:7616
    v_cvt_pk_bf16_f32 v126, v122, v123
    v_cvt_pk_bf16_f32 v127, v124, v125
    ds_write_b64 v4, v[126:127] offset:8160
    ds_read_b128 v[132:135], v5 offset:0
    ds_read_b128 v[136:139], v5 offset:64
    ds_read_b128 v[140:143], v5 offset:128
    ds_read_b128 v[144:147], v5 offset:192
    ds_read_b128 v[148:151], v5 offset:256
    ds_read_b128 v[152:155], v5 offset:320
    ds_read_b128 v[156:159], v5 offset:384
    ds_read_b128 v[160:163], v5 offset:448
    v_mov_b32 v110, v74
    v_sub_f32 v111, 0, v75
    v_mov_b32 v112, v76
    v_sub_f32 v113, 0, v77
    v_mul_f32 v230, 1.0, v70
    v_mul_f32 v231, 1.0, v72
    v_mul_f32 v232, 1.0, v71
    v_mul_f32 v233, 1.0, v73
    v_exp_f32_e64 v230, -v230
    v_fract_f32 v231, v231
    v_exp_f32_e64 v232, -v232
    v_fract_f32 v233, v233
    v_cos_f32 v82, v231
    v_sin_f32 v83, v231
    v_cos_f32 v84, v233
    v_sin_f32 v85, v233
    v_mul_f32 v82, v82, v230
    v_mul_f32_e64 v83, -v83, v230
    v_mul_f32 v84, v84, v232
    v_mul_f32_e64 v85, -v85, v232
    v_mul_f32 v230, 0x43000000, v70
    v_mul_f32 v231, 0x43000000, v72
    v_mul_f32 v232, 0x43000000, v71
    v_mul_f32 v233, 0x43000000, v73
    v_exp_f32_e64 v230, -v230
    v_fract_f32 v231, v231
    v_exp_f32_e64 v232, -v232
    v_fract_f32 v233, v233
    v_cos_f32 v74, v231
    v_sin_f32 v75, v231
    v_cos_f32 v76, v233
    v_sin_f32 v77, v233
    v_mul_f32 v74, v74, v230
    v_mul_f32_e64 v75, -v75, v230
    v_mul_f32 v76, v76, v232
    v_mul_f32_e64 v77, -v77, v232
    v_mov_b32 v78, 1.0
    v_mov_b32 v79, 0
    v_mov_b32 v80, 1.0
    v_mov_b32 v81, 0
    v_cvt_pk_bf16_f32 v128, v78, v79
    v_cvt_pk_bf16_f32 v129, v80, v81
    ds_write_b64 v4, v[128:129] offset:0
    v_cvt_pk_bf16_f32 v130, v82, v83
    v_cvt_pk_bf16_f32 v131, v84, v85
    ds_write_b64 v4, v[130:131] offset:544
    v_pk_mul_f32 v[86:87], v[82:83], v[82:83] op_sel:[0,0] op_sel_hi:[0,1]
    v_pk_mul_f32 v[88:89], v[84:85], v[84:85] op_sel:[0,0] op_sel_hi:[0,1]
    v_pk_fma_f32 v[86:87], v[82:83], v[82:83], v[86:87] op_sel:[1,1,0] op_sel_hi:[1,0,1] neg_lo:[0,1,0]
    v_pk_fma_f32 v[88:89], v[84:85], v[84:85], v[88:89] op_sel:[1,1,0] op_sel_hi:[1,0,1] neg_lo:[0,1,0]
    v_cvt_pk_bf16_f32 v126, v86, v87
    v_cvt_pk_bf16_f32 v127, v88, v89
    ds_write_b64 v4, v[126:127] offset:1088
    v_pk_mul_f32 v[90:91], v[82:83], v[86:87] op_sel:[0,0] op_sel_hi:[0,1]
    v_pk_mul_f32 v[92:93], v[84:85], v[88:89] op_sel:[0,0] op_sel_hi:[0,1]
    v_pk_fma_f32 v[90:91], v[82:83], v[86:87], v[90:91] op_sel:[1,1,0] op_sel_hi:[1,0,1] neg_lo:[0,1,0]
    v_pk_fma_f32 v[92:93], v[84:85], v[88:89], v[92:93] op_sel:[1,1,0] op_sel_hi:[1,0,1] neg_lo:[0,1,0]
    v_cvt_pk_bf16_f32 v128, v90, v91
    v_cvt_pk_bf16_f32 v129, v92, v93
    ds_write_b64 v4, v[128:129] offset:1632
    v_pk_mul_f32 v[94:95], v[86:87], v[86:87] op_sel:[0,0] op_sel_hi:[0,1]
    v_pk_mul_f32 v[96:97], v[88:89], v[88:89] op_sel:[0,0] op_sel_hi:[0,1]
    v_pk_fma_f32 v[94:95], v[86:87], v[86:87], v[94:95] op_sel:[1,1,0] op_sel_hi:[1,0,1] neg_lo:[0,1,0]
    v_pk_fma_f32 v[96:97], v[88:89], v[88:89], v[96:97] op_sel:[1,1,0] op_sel_hi:[1,0,1] neg_lo:[0,1,0]
    v_cvt_pk_bf16_f32 v130, v94, v95
    v_cvt_pk_bf16_f32 v131, v96, v97
    ds_write_b64 v4, v[130:131] offset:2176
    v_pk_mul_f32 v[98:99], v[86:87], v[90:91] op_sel:[0,0] op_sel_hi:[0,1]
    v_pk_mul_f32 v[100:101], v[88:89], v[92:93] op_sel:[0,0] op_sel_hi:[0,1]
    v_pk_fma_f32 v[98:99], v[86:87], v[90:91], v[98:99] op_sel:[1,1,0] op_sel_hi:[1,0,1] neg_lo:[0,1,0]
    v_pk_fma_f32 v[100:101], v[88:89], v[92:93], v[100:101] op_sel:[1,1,0] op_sel_hi:[1,0,1] neg_lo:[0,1,0]
    v_cvt_pk_bf16_f32 v126, v98, v99
    v_cvt_pk_bf16_f32 v127, v100, v101
    ds_write_b64 v4, v[126:127] offset:2720
    v_pk_mul_f32 v[102:103], v[90:91], v[90:91] op_sel:[0,0] op_sel_hi:[0,1]
    v_pk_mul_f32 v[104:105], v[92:93], v[92:93] op_sel:[0,0] op_sel_hi:[0,1]
    v_pk_fma_f32 v[102:103], v[90:91], v[90:91], v[102:103] op_sel:[1,1,0] op_sel_hi:[1,0,1] neg_lo:[0,1,0]
    v_pk_fma_f32 v[104:105], v[92:93], v[92:93], v[104:105] op_sel:[1,1,0] op_sel_hi:[1,0,1] neg_lo:[0,1,0]
    v_cvt_pk_bf16_f32 v128, v102, v103
    v_cvt_pk_bf16_f32 v129, v104, v105
    ds_write_b64 v4, v[128:129] offset:3264
    v_pk_mul_f32 v[106:107], v[90:91], v[94:95] op_sel:[0,0] op_sel_hi:[0,1]
    v_pk_mul_f32 v[108:109], v[92:93], v[96:97] op_sel:[0,0] op_sel_hi:[0,1]
    v_pk_fma_f32 v[106:107], v[90:91], v[94:95], v[106:107] op_sel:[1,1,0] op_sel_hi:[1,0,1] neg_lo:[0,1,0]
    v_pk_fma_f32 v[108:109], v[92:93], v[96:97], v[108:109] op_sel:[1,1,0] op_sel_hi:[1,0,1] neg_lo:[0,1,0]
    v_cvt_pk_bf16_f32 v130, v106, v107
    v_cvt_pk_bf16_f32 v131, v108, v109
    ds_write_b64 v4, v[130:131] offset:3808
    v_cvt_pk_bf16_f32 v126, v74, v75
    v_cvt_pk_bf16_f32 v127, v76, v77
    ds_write_b64 v4, v[126:127] offset:4352
    v_pk_mul_f32 v[118:119], v[82:83], v[74:75] op_sel:[0,0] op_sel_hi:[0,1]
    v_pk_mul_f32 v[120:121], v[84:85], v[76:77] op_sel:[0,0] op_sel_hi:[0,1]
    v_pk_fma_f32 v[118:119], v[82:83], v[74:75], v[118:119] op_sel:[1,1,0] op_sel_hi:[1,0,1] neg_lo:[0,1,0]
    v_pk_fma_f32 v[120:121], v[84:85], v[76:77], v[120:121] op_sel:[1,1,0] op_sel_hi:[1,0,1] neg_lo:[0,1,0]
    v_cvt_pk_bf16_f32 v128, v118, v119
    v_cvt_pk_bf16_f32 v129, v120, v121
    ds_write_b64 v4, v[128:129] offset:4896
    v_pk_mul_f32 v[122:123], v[86:87], v[74:75] op_sel:[0,0] op_sel_hi:[0,1]
    v_pk_mul_f32 v[124:125], v[88:89], v[76:77] op_sel:[0,0] op_sel_hi:[0,1]
    v_pk_fma_f32 v[122:123], v[86:87], v[74:75], v[122:123] op_sel:[1,1,0] op_sel_hi:[1,0,1] neg_lo:[0,1,0]
    v_pk_fma_f32 v[124:125], v[88:89], v[76:77], v[124:125] op_sel:[1,1,0] op_sel_hi:[1,0,1] neg_lo:[0,1,0]
    v_cvt_pk_bf16_f32 v130, v122, v123
    v_cvt_pk_bf16_f32 v131, v124, v125
    ds_write_b64 v4, v[130:131] offset:5440
    v_pk_mul_f32 v[78:79], v[90:91], v[74:75] op_sel:[0,0] op_sel_hi:[0,1]
    v_pk_mul_f32 v[80:81], v[92:93], v[76:77] op_sel:[0,0] op_sel_hi:[0,1]
    v_pk_fma_f32 v[78:79], v[90:91], v[74:75], v[78:79] op_sel:[1,1,0] op_sel_hi:[1,0,1] neg_lo:[0,1,0]
    v_pk_fma_f32 v[80:81], v[92:93], v[76:77], v[80:81] op_sel:[1,1,0] op_sel_hi:[1,0,1] neg_lo:[0,1,0]
    v_cvt_pk_bf16_f32 v126, v78, v79
    v_cvt_pk_bf16_f32 v127, v80, v81
    ds_write_b64 v4, v[126:127] offset:5984
    v_pk_mul_f32 v[82:83], v[94:95], v[74:75] op_sel:[0,0] op_sel_hi:[0,1]
    v_pk_mul_f32 v[84:85], v[96:97], v[76:77] op_sel:[0,0] op_sel_hi:[0,1]
    v_pk_fma_f32 v[82:83], v[94:95], v[74:75], v[82:83] op_sel:[1,1,0] op_sel_hi:[1,0,1] neg_lo:[0,1,0]
    v_pk_fma_f32 v[84:85], v[96:97], v[76:77], v[84:85] op_sel:[1,1,0] op_sel_hi:[1,0,1] neg_lo:[0,1,0]
    v_cvt_pk_bf16_f32 v128, v82, v83
    v_cvt_pk_bf16_f32 v129, v84, v85
    ds_write_b64 v4, v[128:129] offset:6528
    v_pk_mul_f32 v[118:119], v[98:99], v[74:75] op_sel:[0,0] op_sel_hi:[0,1]
    v_pk_mul_f32 v[120:121], v[100:101], v[76:77] op_sel:[0,0] op_sel_hi:[0,1]
    v_pk_fma_f32 v[118:119], v[98:99], v[74:75], v[118:119] op_sel:[1,1,0] op_sel_hi:[1,0,1] neg_lo:[0,1,0]
    v_pk_fma_f32 v[120:121], v[100:101], v[76:77], v[120:121] op_sel:[1,1,0] op_sel_hi:[1,0,1] neg_lo:[0,1,0]
    v_cvt_pk_bf16_f32 v130, v118, v119
    v_cvt_pk_bf16_f32 v131, v120, v121
    ds_write_b64 v4, v[130:131] offset:7072
    v_pk_mul_f32 v[86:87], v[102:103], v[74:75] op_sel:[0,0] op_sel_hi:[0,1]
    v_pk_mul_f32 v[88:89], v[104:105], v[76:77] op_sel:[0,0] op_sel_hi:[0,1]
    v_pk_fma_f32 v[86:87], v[102:103], v[74:75], v[86:87] op_sel:[1,1,0] op_sel_hi:[1,0,1] neg_lo:[0,1,0]
    v_pk_fma_f32 v[88:89], v[104:105], v[76:77], v[88:89] op_sel:[1,1,0] op_sel_hi:[1,0,1] neg_lo:[0,1,0]
    v_cvt_pk_bf16_f32 v126, v86, v87
    v_cvt_pk_bf16_f32 v127, v88, v89
    ds_write_b64 v4, v[126:127] offset:7616
    v_pk_mul_f32 v[90:91], v[106:107], v[74:75] op_sel:[0,0] op_sel_hi:[0,1]
    v_pk_mul_f32 v[92:93], v[108:109], v[76:77] op_sel:[0,0] op_sel_hi:[0,1]
    v_pk_fma_f32 v[90:91], v[106:107], v[74:75], v[90:91] op_sel:[1,1,0] op_sel_hi:[1,0,1] neg_lo:[0,1,0]
    v_pk_fma_f32 v[92:93], v[108:109], v[76:77], v[92:93] op_sel:[1,1,0] op_sel_hi:[1,0,1] neg_lo:[0,1,0]
    v_cvt_pk_bf16_f32 v128, v90, v91
    v_cvt_pk_bf16_f32 v129, v92, v93
    ds_write_b64 v4, v[128:129] offset:8160
    ds_read_b128 v[164:167], v5 offset:0
    ds_read_b128 v[168:171], v5 offset:64
    ds_read_b128 v[172:175], v5 offset:128
    ds_read_b128 v[176:179], v5 offset:192
    ds_read_b128 v[180:183], v5 offset:256
    ds_read_b128 v[184:187], v5 offset:320
    ds_read_b128 v[188:191], v5 offset:384
    ds_read_b128 v[192:195], v5 offset:448
    v_pk_mul_f32 v[78:79], v[110:111], v[74:75] op_sel:[0,0] op_sel_hi:[0,1]
    v_pk_mul_f32 v[80:81], v[112:113], v[76:77] op_sel:[0,0] op_sel_hi:[0,1]
    v_pk_fma_f32 v[78:79], v[110:111], v[74:75], v[78:79] op_sel:[1,1,0] op_sel_hi:[1,0,1] neg_lo:[0,1,0]
    v_pk_fma_f32 v[80:81], v[112:113], v[76:77], v[80:81] op_sel:[1,1,0] op_sel_hi:[1,0,1] neg_lo:[0,1,0]
    v_pk_mul_f32 v[94:95], v[122:123], v[74:75] op_sel:[0,0] op_sel_hi:[0,1]
    v_pk_mul_f32 v[96:97], v[124:125], v[76:77] op_sel:[0,0] op_sel_hi:[0,1]
    v_pk_fma_f32 v[94:95], v[122:123], v[74:75], v[94:95] op_sel:[1,1,0] op_sel_hi:[1,0,1] neg_lo:[0,1,0]
    v_pk_fma_f32 v[96:97], v[124:125], v[76:77], v[96:97] op_sel:[1,1,0] op_sel_hi:[1,0,1] neg_lo:[0,1,0]
    s_waitcnt lgkmcnt(0)
    v_mfma_f32_16x16x32_bf16 v[196:199], v[164:167], v[132:135], 0
    v_mfma_f32_16x16x32_bf16 v[196:199], v[168:171], v[136:139], v[196:199]
    v_mfma_f32_16x16x32_bf16 v[196:199], v[172:175], v[140:143], v[196:199]
    v_mfma_f32_16x16x32_bf16 v[196:199], v[176:179], v[144:147], v[196:199]
    v_mfma_f32_16x16x32_bf16 v[196:199], v[180:183], v[148:151], v[196:199]
    v_mfma_f32_16x16x32_bf16 v[196:199], v[184:187], v[152:155], v[196:199]
    v_mfma_f32_16x16x32_bf16 v[196:199], v[188:191], v[156:159], v[196:199]
    v_mfma_f32_16x16x32_bf16 v[196:199], v[192:195], v[160:163], v[196:199]
    v_pk_mul_f32 v[98:99], v[82:83], v[74:75] op_sel:[0,0] op_sel_hi:[0,1]
    v_pk_mul_f32 v[100:101], v[84:85], v[76:77] op_sel:[0,0] op_sel_hi:[0,1]
    v_pk_fma_f32 v[98:99], v[82:83], v[74:75], v[98:99] op_sel:[1,1,0] op_sel_hi:[1,0,1] neg_lo:[0,1,0]
    v_pk_fma_f32 v[100:101], v[84:85], v[76:77], v[100:101] op_sel:[1,1,0] op_sel_hi:[1,0,1] neg_lo:[0,1,0]
    v_cvt_pk_bf16_f32 v130, v94, v95
    v_cvt_pk_bf16_f32 v131, v96, v97
    ds_write_b64 v4, v[130:131] offset:0
    v_pk_mul_f32 v[118:119], v[86:87], v[74:75] op_sel:[0,0] op_sel_hi:[0,1]
    v_pk_mul_f32 v[120:121], v[88:89], v[76:77] op_sel:[0,0] op_sel_hi:[0,1]
    v_pk_fma_f32 v[118:119], v[86:87], v[74:75], v[118:119] op_sel:[1,1,0] op_sel_hi:[1,0,1] neg_lo:[0,1,0]
    v_pk_fma_f32 v[120:121], v[88:89], v[76:77], v[120:121] op_sel:[1,1,0] op_sel_hi:[1,0,1] neg_lo:[0,1,0]
    v_cvt_pk_bf16_f32 v126, v98, v99
    v_cvt_pk_bf16_f32 v127, v100, v101
    ds_write_b64 v4, v[126:127] offset:544
    v_pk_mul_f32 v[102:103], v[78:79], v[74:75] op_sel:[0,0] op_sel_hi:[0,1]
    v_pk_mul_f32 v[104:105], v[80:81], v[76:77] op_sel:[0,0] op_sel_hi:[0,1]
    v_pk_fma_f32 v[102:103], v[78:79], v[74:75], v[102:103] op_sel:[1,1,0] op_sel_hi:[1,0,1] neg_lo:[0,1,0]
    v_pk_fma_f32 v[104:105], v[80:81], v[76:77], v[104:105] op_sel:[1,1,0] op_sel_hi:[1,0,1] neg_lo:[0,1,0]
    v_cvt_pk_bf16_f32 v128, v118, v119
    v_cvt_pk_bf16_f32 v129, v120, v121
    ds_write_b64 v4, v[128:129] offset:1088
    v_pk_mul_f32 v[106:107], v[94:95], v[74:75] op_sel:[0,0] op_sel_hi:[0,1]
    v_pk_mul_f32 v[108:109], v[96:97], v[76:77] op_sel:[0,0] op_sel_hi:[0,1]
    v_pk_fma_f32 v[106:107], v[94:95], v[74:75], v[106:107] op_sel:[1,1,0] op_sel_hi:[1,0,1] neg_lo:[0,1,0]
    v_pk_fma_f32 v[108:109], v[96:97], v[76:77], v[108:109] op_sel:[1,1,0] op_sel_hi:[1,0,1] neg_lo:[0,1,0]
    v_cvt_pk_bf16_f32 v130, v102, v103
    v_cvt_pk_bf16_f32 v131, v104, v105
    ds_write_b64 v4, v[130:131] offset:1632
    v_pk_mul_f32 v[90:91], v[98:99], v[74:75] op_sel:[0,0] op_sel_hi:[0,1]
    v_pk_mul_f32 v[92:93], v[100:101], v[76:77] op_sel:[0,0] op_sel_hi:[0,1]
    v_pk_fma_f32 v[90:91], v[98:99], v[74:75], v[90:91] op_sel:[1,1,0] op_sel_hi:[1,0,1] neg_lo:[0,1,0]
    v_pk_fma_f32 v[92:93], v[100:101], v[76:77], v[92:93] op_sel:[1,1,0] op_sel_hi:[1,0,1] neg_lo:[0,1,0]
    v_cvt_pk_bf16_f32 v126, v106, v107
    v_cvt_pk_bf16_f32 v127, v108, v109
    ds_write_b64 v4, v[126:127] offset:2176
    v_pk_mul_f32 v[110:111], v[118:119], v[74:75] op_sel:[0,0] op_sel_hi:[0,1]
    v_pk_mul_f32 v[112:113], v[120:121], v[76:77] op_sel:[0,0] op_sel_hi:[0,1]
    v_pk_fma_f32 v[110:111], v[118:119], v[74:75], v[110:111] op_sel:[1,1,0] op_sel_hi:[1,0,1] neg_lo:[0,1,0]
    v_pk_fma_f32 v[112:113], v[120:121], v[76:77], v[112:113] op_sel:[1,1,0] op_sel_hi:[1,0,1] neg_lo:[0,1,0]
    v_cvt_pk_bf16_f32 v128, v90, v91
    v_cvt_pk_bf16_f32 v129, v92, v93
    ds_write_b64 v4, v[128:129] offset:2720
    v_pk_mul_f32 v[122:123], v[102:103], v[74:75] op_sel:[0,0] op_sel_hi:[0,1]
    v_pk_mul_f32 v[124:125], v[104:105], v[76:77] op_sel:[0,0] op_sel_hi:[0,1]
    v_pk_fma_f32 v[122:123], v[102:103], v[74:75], v[122:123] op_sel:[1,1,0] op_sel_hi:[1,0,1] neg_lo:[0,1,0]
    v_pk_fma_f32 v[124:125], v[104:105], v[76:77], v[124:125] op_sel:[1,1,0] op_sel_hi:[1,0,1] neg_lo:[0,1,0]
    v_cvt_pk_bf16_f32 v130, v110, v111
    v_cvt_pk_bf16_f32 v131, v112, v113
    ds_write_b64 v4, v[130:131] offset:3264
    v_pk_mul_f32 v[82:83], v[90:91], v[74:75] op_sel:[0,0] op_sel_hi:[0,1]
    v_pk_mul_f32 v[84:85], v[92:93], v[76:77] op_sel:[0,0] op_sel_hi:[0,1]
    v_pk_fma_f32 v[82:83], v[90:91], v[74:75], v[82:83] op_sel:[1,1,0] op_sel_hi:[1,0,1] neg_lo:[0,1,0]
    v_pk_fma_f32 v[84:85], v[92:93], v[76:77], v[84:85] op_sel:[1,1,0] op_sel_hi:[1,0,1] neg_lo:[0,1,0]
    v_cvt_pk_bf16_f32 v126, v122, v123
    v_cvt_pk_bf16_f32 v127, v124, v125
    ds_write_b64 v4, v[126:127] offset:3808
    v_pk_mul_f32 v[86:87], v[122:123], v[74:75] op_sel:[0,0] op_sel_hi:[0,1]
    v_pk_mul_f32 v[88:89], v[124:125], v[76:77] op_sel:[0,0] op_sel_hi:[0,1]
    v_pk_fma_f32 v[86:87], v[122:123], v[74:75], v[86:87] op_sel:[1,1,0] op_sel_hi:[1,0,1] neg_lo:[0,1,0]
    v_pk_fma_f32 v[88:89], v[124:125], v[76:77], v[88:89] op_sel:[1,1,0] op_sel_hi:[1,0,1] neg_lo:[0,1,0]
    v_cvt_pk_bf16_f32 v128, v82, v83
    v_cvt_pk_bf16_f32 v129, v84, v85
    ds_write_b64 v4, v[128:129] offset:4352
    v_pk_mul_f32 v[78:79], v[82:83], v[74:75] op_sel:[0,0] op_sel_hi:[0,1]
    v_pk_mul_f32 v[80:81], v[84:85], v[76:77] op_sel:[0,0] op_sel_hi:[0,1]
    v_pk_fma_f32 v[78:79], v[82:83], v[74:75], v[78:79] op_sel:[1,1,0] op_sel_hi:[1,0,1] neg_lo:[0,1,0]
    v_pk_fma_f32 v[80:81], v[84:85], v[76:77], v[80:81] op_sel:[1,1,0] op_sel_hi:[1,0,1] neg_lo:[0,1,0]
    v_cvt_pk_bf16_f32 v130, v86, v87
    v_cvt_pk_bf16_f32 v131, v88, v89
    ds_write_b64 v4, v[130:131] offset:4896
    v_pk_mul_f32 v[94:95], v[86:87], v[74:75] op_sel:[0,0] op_sel_hi:[0,1]
    v_pk_mul_f32 v[96:97], v[88:89], v[76:77] op_sel:[0,0] op_sel_hi:[0,1]
    v_pk_fma_f32 v[94:95], v[86:87], v[74:75], v[94:95] op_sel:[1,1,0] op_sel_hi:[1,0,1] neg_lo:[0,1,0]
    v_pk_fma_f32 v[96:97], v[88:89], v[76:77], v[96:97] op_sel:[1,1,0] op_sel_hi:[1,0,1] neg_lo:[0,1,0]
    v_cvt_pk_bf16_f32 v126, v78, v79
    v_cvt_pk_bf16_f32 v127, v80, v81
    ds_write_b64 v4, v[126:127] offset:5440
    v_pk_mul_f32 v[98:99], v[78:79], v[74:75] op_sel:[0,0] op_sel_hi:[0,1]
    v_pk_mul_f32 v[100:101], v[80:81], v[76:77] op_sel:[0,0] op_sel_hi:[0,1]
    v_pk_fma_f32 v[98:99], v[78:79], v[74:75], v[98:99] op_sel:[1,1,0] op_sel_hi:[1,0,1] neg_lo:[0,1,0]
    v_pk_fma_f32 v[100:101], v[80:81], v[76:77], v[100:101] op_sel:[1,1,0] op_sel_hi:[1,0,1] neg_lo:[0,1,0]
    v_cvt_pk_bf16_f32 v128, v94, v95
    v_cvt_pk_bf16_f32 v129, v96, v97
    ds_write_b64 v4, v[128:129] offset:5984
    v_pk_mul_f32 v[118:119], v[94:95], v[74:75] op_sel:[0,0] op_sel_hi:[0,1]
    v_pk_mul_f32 v[120:121], v[96:97], v[76:77] op_sel:[0,0] op_sel_hi:[0,1]
    v_pk_fma_f32 v[118:119], v[94:95], v[74:75], v[118:119] op_sel:[1,1,0] op_sel_hi:[1,0,1] neg_lo:[0,1,0]
    v_pk_fma_f32 v[120:121], v[96:97], v[76:77], v[120:121] op_sel:[1,1,0] op_sel_hi:[1,0,1] neg_lo:[0,1,0]
    v_cvt_pk_bf16_f32 v130, v98, v99
    v_cvt_pk_bf16_f32 v131, v100, v101
    ds_write_b64 v4, v[130:131] offset:6528
    v_pk_mul_f32 v[102:103], v[98:99], v[74:75] op_sel:[0,0] op_sel_hi:[0,1]
    v_pk_mul_f32 v[104:105], v[100:101], v[76:77] op_sel:[0,0] op_sel_hi:[0,1]
    v_pk_fma_f32 v[102:103], v[98:99], v[74:75], v[102:103] op_sel:[1,1,0] op_sel_hi:[1,0,1] neg_lo:[0,1,0]
    v_pk_fma_f32 v[104:105], v[100:101], v[76:77], v[104:105] op_sel:[1,1,0] op_sel_hi:[1,0,1] neg_lo:[0,1,0]
    v_cvt_pk_bf16_f32 v126, v118, v119
    v_cvt_pk_bf16_f32 v127, v120, v121
    ds_write_b64 v4, v[126:127] offset:7072
    v_pk_mul_f32 v[90:91], v[118:119], v[74:75] op_sel:[0,0] op_sel_hi:[0,1]
    v_pk_mul_f32 v[92:93], v[120:121], v[76:77] op_sel:[0,0] op_sel_hi:[0,1]
    v_pk_fma_f32 v[90:91], v[118:119], v[74:75], v[90:91] op_sel:[1,1,0] op_sel_hi:[1,0,1] neg_lo:[0,1,0]
    v_pk_fma_f32 v[92:93], v[120:121], v[76:77], v[92:93] op_sel:[1,1,0] op_sel_hi:[1,0,1] neg_lo:[0,1,0]
    v_cvt_pk_bf16_f32 v128, v102, v103
    v_cvt_pk_bf16_f32 v129, v104, v105
    ds_write_b64 v4, v[128:129] offset:7616
    v_pk_mul_f32 v[122:123], v[90:91], v[74:75] op_sel:[0,0] op_sel_hi:[0,1]
    v_pk_mul_f32 v[124:125], v[92:93], v[76:77] op_sel:[0,0] op_sel_hi:[0,1]
    v_pk_fma_f32 v[122:123], v[90:91], v[74:75], v[122:123] op_sel:[1,1,0] op_sel_hi:[1,0,1] neg_lo:[0,1,0]
    v_pk_fma_f32 v[124:125], v[92:93], v[76:77], v[124:125] op_sel:[1,1,0] op_sel_hi:[1,0,1] neg_lo:[0,1,0]
    v_cvt_pk_bf16_f32 v130, v90, v91
    v_cvt_pk_bf16_f32 v131, v92, v93
    ds_write_b64 v4, v[130:131] offset:8160
    ds_read_b128 v[164:167], v5 offset:0
    ds_read_b128 v[168:171], v5 offset:64
    ds_read_b128 v[172:175], v5 offset:128
    ds_read_b128 v[176:179], v5 offset:192
    ds_read_b128 v[180:183], v5 offset:256
    ds_read_b128 v[184:187], v5 offset:320
    ds_read_b128 v[188:191], v5 offset:384
    ds_read_b128 v[192:195], v5 offset:448
    s_mov_b64 exec, 1
    v_add_f32 v196, v196, v15
    s_mov_b64 exec, -1
    v_cvt_pk_bf16_f32 v196, v196, v197
    v_cvt_pk_bf16_f32 v197, v198, v199
    ds_write_b64 v29, v[196:197]
    s_waitcnt lgkmcnt(0)
    v_mfma_f32_16x16x32_bf16 v[200:203], v[164:167], v[132:135], 0
    v_mfma_f32_16x16x32_bf16 v[200:203], v[168:171], v[136:139], v[200:203]
    v_mfma_f32_16x16x32_bf16 v[200:203], v[172:175], v[140:143], v[200:203]
    v_mfma_f32_16x16x32_bf16 v[200:203], v[176:179], v[144:147], v[200:203]
    v_mfma_f32_16x16x32_bf16 v[200:203], v[180:183], v[148:151], v[200:203]
    v_mfma_f32_16x16x32_bf16 v[200:203], v[184:187], v[152:155], v[200:203]
    v_mfma_f32_16x16x32_bf16 v[200:203], v[188:191], v[156:159], v[200:203]
    v_mfma_f32_16x16x32_bf16 v[200:203], v[192:195], v[160:163], v[200:203]
    v_pk_mul_f32 v[82:83], v[122:123], v[74:75] op_sel:[0,0] op_sel_hi:[0,1]
    v_pk_mul_f32 v[84:85], v[124:125], v[76:77] op_sel:[0,0] op_sel_hi:[0,1]
    v_pk_fma_f32 v[82:83], v[122:123], v[74:75], v[82:83] op_sel:[1,1,0] op_sel_hi:[1,0,1] neg_lo:[0,1,0]
    v_pk_fma_f32 v[84:85], v[124:125], v[76:77], v[84:85] op_sel:[1,1,0] op_sel_hi:[1,0,1] neg_lo:[0,1,0]
    v_cvt_pk_bf16_f32 v126, v122, v123
    v_cvt_pk_bf16_f32 v127, v124, v125
    ds_write_b64 v4, v[126:127] offset:0
    v_pk_mul_f32 v[86:87], v[82:83], v[74:75] op_sel:[0,0] op_sel_hi:[0,1]
    v_pk_mul_f32 v[88:89], v[84:85], v[76:77] op_sel:[0,0] op_sel_hi:[0,1]
    v_pk_fma_f32 v[86:87], v[82:83], v[74:75], v[86:87] op_sel:[1,1,0] op_sel_hi:[1,0,1] neg_lo:[0,1,0]
    v_pk_fma_f32 v[88:89], v[84:85], v[76:77], v[88:89] op_sel:[1,1,0] op_sel_hi:[1,0,1] neg_lo:[0,1,0]
    v_cvt_pk_bf16_f32 v128, v82, v83
    v_cvt_pk_bf16_f32 v129, v84, v85
    ds_write_b64 v4, v[128:129] offset:544
    v_pk_mul_f32 v[78:79], v[86:87], v[74:75] op_sel:[0,0] op_sel_hi:[0,1]
    v_pk_mul_f32 v[80:81], v[88:89], v[76:77] op_sel:[0,0] op_sel_hi:[0,1]
    v_pk_fma_f32 v[78:79], v[86:87], v[74:75], v[78:79] op_sel:[1,1,0] op_sel_hi:[1,0,1] neg_lo:[0,1,0]
    v_pk_fma_f32 v[80:81], v[88:89], v[76:77], v[80:81] op_sel:[1,1,0] op_sel_hi:[1,0,1] neg_lo:[0,1,0]
    v_cvt_pk_bf16_f32 v130, v86, v87
    v_cvt_pk_bf16_f32 v131, v88, v89
    ds_write_b64 v4, v[130:131] offset:1088
    v_pk_mul_f32 v[94:95], v[78:79], v[74:75] op_sel:[0,0] op_sel_hi:[0,1]
    v_pk_mul_f32 v[96:97], v[80:81], v[76:77] op_sel:[0,0] op_sel_hi:[0,1]
    v_pk_fma_f32 v[94:95], v[78:79], v[74:75], v[94:95] op_sel:[1,1,0] op_sel_hi:[1,0,1] neg_lo:[0,1,0]
    v_pk_fma_f32 v[96:97], v[80:81], v[76:77], v[96:97] op_sel:[1,1,0] op_sel_hi:[1,0,1] neg_lo:[0,1,0]
    v_cvt_pk_bf16_f32 v126, v78, v79
    v_cvt_pk_bf16_f32 v127, v80, v81
    ds_write_b64 v4, v[126:127] offset:1632
    v_pk_mul_f32 v[98:99], v[94:95], v[74:75] op_sel:[0,0] op_sel_hi:[0,1]
    v_pk_mul_f32 v[100:101], v[96:97], v[76:77] op_sel:[0,0] op_sel_hi:[0,1]
    v_pk_fma_f32 v[98:99], v[94:95], v[74:75], v[98:99] op_sel:[1,1,0] op_sel_hi:[1,0,1] neg_lo:[0,1,0]
    v_pk_fma_f32 v[100:101], v[96:97], v[76:77], v[100:101] op_sel:[1,1,0] op_sel_hi:[1,0,1] neg_lo:[0,1,0]
    v_cvt_pk_bf16_f32 v128, v94, v95
    v_cvt_pk_bf16_f32 v129, v96, v97
    ds_write_b64 v4, v[128:129] offset:2176
    v_pk_mul_f32 v[118:119], v[98:99], v[74:75] op_sel:[0,0] op_sel_hi:[0,1]
    v_pk_mul_f32 v[120:121], v[100:101], v[76:77] op_sel:[0,0] op_sel_hi:[0,1]
    v_pk_fma_f32 v[118:119], v[98:99], v[74:75], v[118:119] op_sel:[1,1,0] op_sel_hi:[1,0,1] neg_lo:[0,1,0]
    v_pk_fma_f32 v[120:121], v[100:101], v[76:77], v[120:121] op_sel:[1,1,0] op_sel_hi:[1,0,1] neg_lo:[0,1,0]
    v_cvt_pk_bf16_f32 v130, v98, v99
    v_cvt_pk_bf16_f32 v131, v100, v101
    ds_write_b64 v4, v[130:131] offset:2720
    v_pk_mul_f32 v[90:91], v[118:119], v[74:75] op_sel:[0,0] op_sel_hi:[0,1]
    v_pk_mul_f32 v[92:93], v[120:121], v[76:77] op_sel:[0,0] op_sel_hi:[0,1]
    v_pk_fma_f32 v[90:91], v[118:119], v[74:75], v[90:91] op_sel:[1,1,0] op_sel_hi:[1,0,1] neg_lo:[0,1,0]
    v_pk_fma_f32 v[92:93], v[120:121], v[76:77], v[92:93] op_sel:[1,1,0] op_sel_hi:[1,0,1] neg_lo:[0,1,0]
    v_cvt_pk_bf16_f32 v126, v118, v119
    v_cvt_pk_bf16_f32 v127, v120, v121
    ds_write_b64 v4, v[126:127] offset:3264
    v_pk_mul_f32 v[122:123], v[74:75], v[74:75] op_sel:[0,0] op_sel_hi:[0,1]
    v_pk_mul_f32 v[124:125], v[76:77], v[76:77] op_sel:[0,0] op_sel_hi:[0,1]
    v_pk_fma_f32 v[122:123], v[74:75], v[74:75], v[122:123] op_sel:[1,1,0] op_sel_hi:[1,0,1] neg_lo:[0,1,0]
    v_pk_fma_f32 v[124:125], v[76:77], v[76:77], v[124:125] op_sel:[1,1,0] op_sel_hi:[1,0,1] neg_lo:[0,1,0]
    v_cvt_pk_bf16_f32 v128, v90, v91
    v_cvt_pk_bf16_f32 v129, v92, v93
    ds_write_b64 v4, v[128:129] offset:3808
    v_cvt_pk_bf16_f32 v130, v122, v123
    v_cvt_pk_bf16_f32 v131, v124, v125
    ds_write_b64 v4, v[130:131] offset:4352
    s_cmp_ge_u32 s56, 4
    s_cbranch_scc1 L_cv_gl
    s_add_u32 s63, s58, 0
    s_and_b32 s63, s63, 3
    s_mul_i32 s64, s63, 81920
    s_lshl_b32 s63, s63, 10
    s_add_u32 s63, s63, s66
    s_add_u32 m0, s63, 43040
    s_nop 0
    buffer_load_dwordx4 v6, s[32:35], s64 offen lds
    s_add_u32 s63, s58, 1
    s_and_b32 s63, s63, 3
    s_mul_i32 s64, s63, 81920
    s_lshl_b32 s63, s63, 10
    s_add_u32 s63, s63, s66
    s_add_u32 m0, s63, 43040
    s_nop 0
    buffer_load_dwordx4 v6, s[32:35], s64 offen lds
    s_add_u32 s63, s58, 2
    s_and_b32 s63, s63, 3
    s_mul_i32 s64, s63, 81920
    s_lshl_b32 s63, s63, 10
    s_add_u32 s63, s63, s66
    s_add_u32 m0, s63, 43040
    s_nop 0
    buffer_load_dwordx4 v6, s[32:35], s64 offen lds
    s_add_u32 s63, s58, 3
    s_and_b32 s63, s63, 3
    s_mul_i32 s64, s63, 81920
    s_lshl_b32 s63, s63, 10
    s_add_u32 s63, s63, s66
    s_add_u32 m0, s63, 43040
    s_nop 0
    buffer_load_dwordx4 v6, s[32:35], s64 offen lds
L_cv_gl:
    v_lshlrev_b32 v35, 7, v0
    s_cmp_lg_u32 s56, 0
    s_cbranch_scc1 L_one_26
    s_mov_b64 exec, 3
    buffer_load_dword v3, v35, s[48:51], 0 offen sc1
    s_mov_b64 exec, -1
L_one_26:
    ds_read_b128 v[164:167], v5 offset:0
    ds_read_b128 v[168:171], v5 offset:64
    ds_read_b128 v[172:175], v5 offset:128
    ds_read_b128 v[176:179], v5 offset:192
    ds_read_b128 v[180:183], v5 offset:256
    ds_read_b128 v[184:187], v5 offset:320
    ds_read_b128 v[188:191], v5 offset:384
    ds_read_b128 v[192:195], v5 offset:448
    v_cvt_pk_bf16_f32 v196, v200, v201
    v_cvt_pk_bf16_f32 v197, v201, v201
    v_cvt_pk_bf16_f32 v198, v202, v203
    v_cvt_pk_bf16_f32 v199, v203, v203
    v_and_b32 v200, 0xffff, v199
    s_mov_b32 exec_hi, 0
    ds_write2_b32 v30, v196, v197 offset1:1
    ds_write2_b32 v30, v198, v199 offset0:2 offset1:3
    s_mov_b32 exec_lo, 0x80000000
    ds_write_b32 v30, v200 offset:16
    s_mov_b32 exec_lo, 0
    s_mov_b32 exec_hi, -1
    ds_write2_b32 v30, v196, v198 offset1:16
    s_mov_b32 exec_lo, -1
    s_waitcnt lgkmcnt(0)
    v_mfma_f32_16x16x32_bf16 v[204:207], v[164:167], v[132:135], 0
    v_mfma_f32_16x16x32_bf16 v[204:207], v[168:171], v[136:139], v[204:207]
    v_mfma_f32_16x16x32_bf16 v[204:207], v[172:175], v[140:143], v[204:207]
    v_mfma_f32_16x16x32_bf16 v[204:207], v[176:179], v[144:147], v[204:207]
    v_mfma_f32_16x16x32_bf16 v[204:207], v[180:183], v[148:151], v[204:207]
    v_mfma_f32_16x16x32_bf16 v[204:207], v[184:187], v[152:155], v[204:207]
    v_mfma_f32_16x16x32_bf16 v[204:207], v[188:191], v[156:159], v[204:207]
    v_mfma_f32_16x16x32_bf16 v[204:207], v[192:195], v[160:163], v[204:207]
    v_lshlrev_b32 v255, 4, v8
    v_and_b32 v254, 2, v7
    v_lshlrev_b32 v254, 2, v254
    v_add_u32 v254, v255, v254
    v_ashrrev_i32 v255, 2, v7
    v_add_u32 v255, v254, v255
    v_lshlrev_b32 v255, 4, v255
    v_and_b32 v254, 1, v7
    v_lshlrev_b32 v254, 3, v254
    v_add_u32 v254, v255, v254
    v_mov_b32 v255, s56
    v_lshlrev_b32 v255, 12, v255
    v_add_u32 v255, v254, v255
    v_add_u32 v74, 43040, v255
    v_and_b32 v255, 7, v7
    v_mul_u32_u24 v255, 4672, v255
    v_mov_b32 v254, s56
    v_lshlrev_b32 v254, 8, v254
    v_add_u32 v254, 256, v254
    v_lshlrev_b32 v253, 4, v8
    v_add_u32 v253, v254, v253
    v_ashrrev_i32 v254, 3, v7
    v_lshlrev_b32 v254, 3, v254
    v_add_u32 v254, v253, v254
    v_lshlrev_b32 v254, 1, v254
    v_add_u32 v75, v255, v254
    v_cvt_pk_bf16_f32 v200, v204, v204
    v_cvt_pk_bf16_f32 v204, v204, v205
    v_cvt_pk_bf16_f32 v205, v206, v207
    s_mov_b32 exec_hi, 0
    ds_write_b16 v31, v204 offset:0
    ds_write_b16_d16_hi v31, v204 offset:32
    ds_write_b16 v31, v205 offset:64
    ds_write_b16_d16_hi v31, v205 offset:96
    s_mov_b32 exec_lo, 0
    s_mov_b32 exec_hi, 1
    ds_write_b32 v32, v200 offset:544
    s_mov_b64 exec, -1
    v_add_u32 v33, 1024, v25
    ds_read_u16 v34, v32 offset:1438
    ds_read2_b32 v[96:97], v33 offset1:1
    ds_read2_b32 v[98:99], v33 offset0:2 offset1:3
    ds_read_b32 v100, v25 offset:1040
    ds_read2_b32 v[102:103], v25 offset0:0 offset1:1
    ds_read2_b32 v[104:105], v25 offset0:2 offset1:3
    ds_read_b32 v106, v25 offset:16
    s_waitcnt vmcnt(0)
    s_cmp_lg_u32 s56, 0
    s_cbranch_scc1 L_one_27
    s_mov_b32 s63, 0
    s_mov_b64 exec, 3
L_fl_28:
    v_cmp_ne_u32 vcc, 1, v3
    s_add_u32 s63, s63, 1
    s_cbranch_vccz L_fd_29
    s_cmp_ge_u32 s63, 200000
    s_cbranch_scc1 L_fd_29
    s_sleep 4
    buffer_load_dword v3, v35, s[48:51], 0 offen sc1
    s_waitcnt vmcnt(0)
    s_branch L_fl_28
L_fd_29:
    s_mov_b64 exec, -1
L_one_27:
    s_cmp_ge_u32 s67, 40
    s_cbranch_scc1 L_pn_31
    s_add_i32 s63, s67, 60
    s_mul_i32 s64, s63, 6554
    s_lshr_b32 s64, s64, 16
    s_mul_i32 s64, s64, -819072
    s_mul_i32 s65, s63, 81920
    s_add_u32 s64, s64, s65
    buffer_load_dword v35, v16, s[40:43], s64 offen
    s_branch L_pe_30
L_pn_31:
    s_mov_b64 exec, 1
    buffer_load_dword v35, v16, s[32:35], 0 offen
    s_mov_b64 exec, -1
L_pe_30:
    v_lshlrev_b32 v254, 2, v7
    v_add_u32 v4, 163776, v254
    ds_write_b32 v4, v1
    ds_read_b64_tr_b16 v[80:81], v74 offset:0
    ds_read_b64_tr_b16 v[82:83], v74 offset:64
    ds_read_b64_tr_b16 v[84:85], v74 offset:1024
    ds_read_b64_tr_b16 v[86:87], v74 offset:1088
    ds_read_b64_tr_b16 v[88:89], v74 offset:2048
    ds_read_b64_tr_b16 v[90:91], v74 offset:2112
    ds_read_b64_tr_b16 v[92:93], v74 offset:3072
    ds_read_b64_tr_b16 v[94:95], v74 offset:3136
    s_waitcnt lgkmcnt(8)
    v_perm_b32 v252, v100, v99, v26
    v_perm_b32 v253, v99, v98, v26
    v_perm_b32 v254, v98, v97, v26
    v_perm_b32 v255, v97, v96, v26
    v_perm_b32 v108, v106, v105, v26
    v_perm_b32 v109, v105, v104, v26
    v_perm_b32 v110, v104, v103, v26
    v_perm_b32 v111, v103, v102, v26
    s_add_u32 s63, s3, 32
    v_lshl_add_u32 v9, v8, 4, s63
    v_lshlrev_b32 v20, 4, v0
    v_lshl_add_u32 v9, v7, 5, v9
    v_add_u32 v21, 160032, v20
    ds_read2_b32 v[96:97], v25 offset0:128 offset1:129
    ds_read2_b32 v[98:99], v25 offset0:130 offset1:131
    ds_read_b32 v100, v25 offset:528
    s_waitcnt lgkmcnt(9)
    ds_write_b128 v75, v[80:83] offset:0
    s_waitcnt lgkmcnt(8)
    ds_write_b128 v75, v[84:87] offset:128
    s_waitcnt lgkmcnt(7)
    ds_write_b128 v75, v[88:91] offset:256
    s_waitcnt lgkmcnt(6)
    ds_write_b128 v75, v[92:95] offset:384
    s_waitcnt lgkmcnt(0)
    v_perm_b32 v112, v100, v99, v26
    v_perm_b32 v113, v99, v98, v26
    v_perm_b32 v114, v98, v97, v26
    v_perm_b32 v115, v97, v96, v26
    s_setprio 1
    s_cmp_lt_u32 s56, 4
    s_cbranch_scc1 L_cv_p1
    s_setprio 2
L_cv_p1:
    s_barrier
    ds_read_b128 v[124:127], v9 offset:448
    ds_read_b128 v[128:131], v9 offset:960
    ds_read_b128 v[132:135], v9 offset:1472
    ds_read_b128 v[136:139], v9 offset:1984
    ds_read_b128 v[140:143], v9 offset:2496
    ds_read_b128 v[144:147], v9 offset:3008
    ds_read_b128 v[148:151], v9 offset:3520
    ds_read_b128 v[152:155], v9 offset:4032
    ds_read_b128 v[156:159], v9 offset:432
    ds_read_b128 v[160:163], v9 offset:944
    ds_read_b128 v[164:167], v9 offset:1456
    ds_read_b128 v[168:171], v9 offset:1968
    ds_read_b128 v[172:175], v9 offset:2480
    ds_read_b128 v[176:179], v9 offset:2992
    s_waitcnt lgkmcnt(13)
    v_mfma_f32_16x16x32_bf16 v[64:67], v[108:111], v[124:127], 0
    ds_read_b128 v[36:39], v20 offset:37376
    s_waitcnt lgkmcnt(13)
    v_mfma_f32_16x16x32_bf16 v[68:71], v[108:111], v[128:131], 0
    ds_read_b128 v[40:43], v20 offset:38400
    s_waitcnt lgkmcnt(13)
    v_mfma_f32_16x16x32_bf16 v[72:75], v[108:111], v[132:135], 0
    ds_read_b128 v[44:47], v20 offset:39424
    s_waitcnt lgkmcnt(13)
    v_mfma_f32_16x16x32_bf16 v[76:79], v[108:111], v[136:139], 0
    ds_read_b128 v[48:51], v20 offset:40448
    s_waitcnt lgkmcnt(13)
    v_mfma_f32_16x16x32_bf16 v[80:83], v[108:111], v[140:143], 0
    ds_read_b128 v[52:55], v20 offset:41472
    s_waitcnt lgkmcnt(13)
    v_mfma_f32_16x16x32_bf16 v[84:87], v[108:111], v[144:147], 0
    ds_read_b128 v[56:59], v21 offset:0
    s_waitcnt lgkmcnt(13)
    v_mfma_f32_16x16x32_bf16 v[88:91], v[108:111], v[148:151], 0
    ds_read_b128 v[60:63], v21 offset:1024
    s_waitcnt lgkmcnt(13)
    v_mfma_f32_16x16x32_bf16 v[92:95], v[108:111], v[152:155], 0
    s_waitcnt lgkmcnt(0)
    v_mul_u32_u24 v60, v34, v60
    v_mul_u32_u24 v61, v34, v61
    v_mul_u32_u24 v62, v34, v62
    v_mul_u32_u24 v63, v34, v63
    v_mfma_f32_16x16x32_bf16 v[96:99], v[124:127], v[36:39], 0
    v_mfma_f32_16x16x32_bf16 v[100:103], v[124:127], v[40:43], 0
    v_mfma_f32_16x16x32_bf16 v[12:15], v[124:127], v[44:47], 0
    v_mfma_f32_16x16x32_bf16 v[16:19], v[156:159], v[48:51], 0
    v_mfma_f32_16x16x32_bf16 v[116:119], v[124:127], v[52:55], 0
    v_mfma_f32_16x16x32_bf16 v[120:123], v[156:159], v[56:59], 0
    v_mfma_f32_16x16x32_bf16 v[68:71], v[112:115], v[124:127], v[68:71]
    s_nop 2
    v_cvt_pk_bf16_f32 v188, v96, v100
    v_cvt_pk_bf16_f32 v190, v97, v101
    v_cvt_pk_bf16_f32 v192, v98, v102
    v_cvt_pk_bf16_f32 v194, v99, v103
    v_mfma_f32_16x16x32_bf16 v[72:75], v[112:115], v[128:131], v[72:75]
    v_cvt_pk_bf16_f32 v189, v12, v16
    v_cvt_pk_bf16_f32 v191, v13, v17
    v_cvt_pk_bf16_f32 v193, v14, v18
    v_cvt_pk_bf16_f32 v195, v15, v19
    v_mfma_f32_16x16x32_bf16 v[76:79], v[112:115], v[132:135], v[76:79]
    v_cvt_pk_bf16_f32 v236, v116, v120
    v_cvt_pk_bf16_f32 v237, v117, v121
    v_cvt_pk_bf16_f32 v238, v118, v122
    v_cvt_pk_bf16_f32 v239, v119, v123
    ds_read_b128 v[156:159], v9 offset:384
    v_mfma_f32_16x16x32_bf16 v[96:99], v[128:131], v[36:39], 0
    v_mfma_f32_16x16x32_bf16 v[100:103], v[128:131], v[40:43], 0
    v_mfma_f32_16x16x32_bf16 v[12:15], v[128:131], v[44:47], 0
    v_mfma_f32_16x16x32_bf16 v[16:19], v[160:163], v[48:51], 0
    v_mfma_f32_16x16x32_bf16 v[116:119], v[128:131], v[52:55], 0
    v_mfma_f32_16x16x32_bf16 v[120:123], v[160:163], v[56:59], 0
    v_mfma_f32_16x16x32_bf16 v[80:83], v[112:115], v[136:139], v[80:83]
    s_nop 2
    v_cvt_pk_bf16_f32 v196, v96, v100
    v_cvt_pk_bf16_f32 v198, v97, v101
    v_cvt_pk_bf16_f32 v200, v98, v102
    v_cvt_pk_bf16_f32 v202, v99, v103
    v_mfma_f32_16x16x32_bf16 v[84:87], v[112:115], v[140:143], v[84:87]
    v_cvt_pk_bf16_f32 v197, v12, v16
    v_cvt_pk_bf16_f32 v199, v13, v17
    v_cvt_pk_bf16_f32 v201, v14, v18
    v_cvt_pk_bf16_f32 v203, v15, v19
    v_mfma_f32_16x16x32_bf16 v[88:91], v[112:115], v[144:147], v[88:91]
    v_cvt_pk_bf16_f32 v240, v116, v120
    v_cvt_pk_bf16_f32 v241, v117, v121
    v_cvt_pk_bf16_f32 v242, v118, v122
    v_cvt_pk_bf16_f32 v243, v119, v123
    ds_read_b128 v[160:163], v9 offset:896
    v_mfma_f32_16x16x32_bf16 v[96:99], v[132:135], v[36:39], 0
    v_mfma_f32_16x16x32_bf16 v[100:103], v[132:135], v[40:43], 0
    v_mfma_f32_16x16x32_bf16 v[12:15], v[132:135], v[44:47], 0
    v_mfma_f32_16x16x32_bf16 v[16:19], v[164:167], v[48:51], 0
    v_mfma_f32_16x16x32_bf16 v[116:119], v[132:135], v[52:55], 0
    v_mfma_f32_16x16x32_bf16 v[120:123], v[164:167], v[56:59], 0
    v_mfma_f32_16x16x32_bf16 v[92:95], v[112:115], v[148:151], v[92:95]
    s_nop 2
    v_cvt_pk_bf16_f32 v204, v96, v100
    v_cvt_pk_bf16_f32 v206, v97, v101
    v_cvt_pk_bf16_f32 v208, v98, v102
    v_cvt_pk_bf16_f32 v210, v99, v103
    v_mfma_f32_16x16x32_bf16 v[72:75], v[252:255], v[124:127], v[72:75]
    v_cvt_pk_bf16_f32 v205, v12, v16
    v_cvt_pk_bf16_f32 v207, v13, v17
    v_cvt_pk_bf16_f32 v209, v14, v18
    v_cvt_pk_bf16_f32 v211, v15, v19
    v_mfma_f32_16x16x32_bf16 v[76:79], v[252:255], v[128:131], v[76:79]
    v_cvt_pk_bf16_f32 v244, v116, v120
    v_cvt_pk_bf16_f32 v245, v117, v121
    v_cvt_pk_bf16_f32 v246, v118, v122
    v_cvt_pk_bf16_f32 v247, v119, v123
    ds_read_b128 v[164:167], v9 offset:1408
    v_mfma_f32_16x16x32_bf16 v[96:99], v[136:139], v[36:39], 0
    v_mfma_f32_16x16x32_bf16 v[100:103], v[136:139], v[40:43], 0
    v_mfma_f32_16x16x32_bf16 v[12:15], v[136:139], v[44:47], 0
    v_mfma_f32_16x16x32_bf16 v[16:19], v[168:171], v[48:51], 0
    v_mfma_f32_16x16x32_bf16 v[116:119], v[136:139], v[52:55], 0
    v_mfma_f32_16x16x32_bf16 v[120:123], v[168:171], v[56:59], 0
    v_mfma_f32_16x16x32_bf16 v[80:83], v[252:255], v[132:135], v[80:83]
    s_nop 2
    v_cvt_pk_bf16_f32 v212, v96, v100
    v_cvt_pk_bf16_f32 v214, v97, v101
    v_cvt_pk_bf16_f32 v216, v98, v102
    v_cvt_pk_bf16_f32 v218, v99, v103
    v_mfma_f32_16x16x32_bf16 v[84:87], v[252:255], v[136:139], v[84:87]
    v_cvt_pk_bf16_f32 v213, v12, v16
    v_cvt_pk_bf16_f32 v215, v13, v17
    v_cvt_pk_bf16_f32 v217, v14, v18
    v_cvt_pk_bf16_f32 v219, v15, v19
    v_mfma_f32_16x16x32_bf16 v[88:91], v[252:255], v[140:143], v[88:91]
    v_cvt_pk_bf16_f32 v248, v116, v120
    v_cvt_pk_bf16_f32 v249, v117, v121
    v_cvt_pk_bf16_f32 v250, v118, v122
    v_cvt_pk_bf16_f32 v251, v119, v123
    ds_read_b128 v[168:171], v9 offset:1920
    v_mfma_f32_16x16x32_bf16 v[96:99], v[140:143], v[36:39], 0
    v_mfma_f32_16x16x32_bf16 v[100:103], v[140:143], v[40:43], 0
    v_mfma_f32_16x16x32_bf16 v[12:15], v[140:143], v[44:47], 0
    v_mfma_f32_16x16x32_bf16 v[16:19], v[172:175], v[48:51], 0
    v_mfma_f32_16x16x32_bf16 v[92:95], v[252:255], v[144:147], v[92:95]
    s_nop 4
    v_cvt_pk_bf16_f32 v220, v96, v100
    v_cvt_pk_bf16_f32 v222, v97, v101
    v_cvt_pk_bf16_f32 v224, v98, v102
    v_mfma_f32_16x16x32_bf16 v[80:83], v[60:63], v[124:127], v[80:83]
    v_cvt_pk_bf16_f32 v226, v99, v103
    v_cvt_pk_bf16_f32 v221, v12, v16
    v_cvt_pk_bf16_f32 v223, v13, v17
    v_mfma_f32_16x16x32_bf16 v[84:87], v[60:63], v[128:131], v[84:87]
    v_cvt_pk_bf16_f32 v225, v14, v18
    v_cvt_pk_bf16_f32 v227, v15, v19
    ds_read_b128 v[172:175], v9 offset:2432
    v_mfma_f32_16x16x32_bf16 v[96:99], v[144:147], v[36:39], 0
    v_mfma_f32_16x16x32_bf16 v[100:103], v[144:147], v[40:43], 0
    v_mfma_f32_16x16x32_bf16 v[12:15], v[144:147], v[44:47], 0
    v_mfma_f32_16x16x32_bf16 v[16:19], v[176:179], v[48:51], 0
    v_mfma_f32_16x16x32_bf16 v[88:91], v[60:63], v[132:135], v[88:91]
    s_nop 4
    v_cvt_pk_bf16_f32 v228, v96, v100
    v_cvt_pk_bf16_f32 v230, v97, v101
    v_cvt_pk_bf16_f32 v232, v98, v102
    v_mfma_f32_16x16x32_bf16 v[92:95], v[60:63], v[136:139], v[92:95]
    v_cvt_pk_bf16_f32 v234, v99, v103
    v_cvt_pk_bf16_f32 v229, v12, v16
    v_cvt_pk_bf16_f32 v231, v13, v17
    v_cvt_pk_bf16_f32 v233, v14, v18
    v_cvt_pk_bf16_f32 v235, v15, v19
    ds_read_b128 v[176:179], v9 offset:2944
    ds_read_b128 v[180:183], v9 offset:3456
    ds_read_b128 v[184:187], v9 offset:3968
    ds_read2_b32 v[96:97], v25 offset0:16 offset1:17
    ds_read2_b32 v[98:99], v25 offset0:18 offset1:19
    ds_read_b32 v100, v25 offset:80
    ds_read2_b32 v[102:103], v25 offset0:144 offset1:145
    ds_read2_b32 v[104:105], v25 offset0:146 offset1:147
    ds_read_b32 v106, v25 offset:592
    s_lshl_b32 s63, s61, 3
    v_lshlrev_b32 v16, 2, v8
    s_add_u32 s63, s63, s56
    v_sub_u32 v16, v7, v16
    s_lshl_b32 s63, s63, 12
    s_add_u32 s64, s69, 1160
    s_add_u32 s65, s69, 1556
    v_add_u32 v6, s63, v20
    v_lshl_add_u32 v27, v16, 3, s64
    v_lshl_add_u32 v28, v16, 2, s65
    s_movk_i32 s64, 1120
    v_mul_u32_u24 v23, 6554, v0
    v_lshlrev_b32 v24, 4, v0
    v_lshrrev_b32 v20, 16, v23
    v_add_u32 v23, 419456, v23
    v_mad_u32_u24 v20, v20, s64, v24
    v_add_u32 v24, 1024, v24
    v_lshrrev_b32 v21, 16, v23
    v_add_u32 v23, 419456, v23
    v_mad_u32_u24 v21, v21, s64, v24
    v_add_u32 v24, 1024, v24
    v_lshrrev_b32 v22, 16, v23
    v_add_u32 v23, 419456, v23
    v_mad_u32_u24 v22, v22, s64, v24
    v_add_u32 v24, 1024, v24
    v_ashrrev_i32 v19, 16, v23
    v_mul_u32_u24 v19, 1120, v19
    v_add_u32 v23, v19, v24
    v_add_u32 v19, 256, v0
    v_mul_u32_u24 v19, 6554, v19
    v_ashrrev_i32 v19, 16, v19
    v_mul_u32_u24 v19, 1120, v19
    v_add_u32 v19, v19, v24
    v_add_u32 v24, 1024, v19
    v_mov_b32 v12, -1
    v_mov_b32 v13, -1
    v_mov_b32 v14, -1
    v_mov_b32 v15, -1
    ds_read_b64 v[44:45], v27 offset:24
    ds_read_b64 v[46:47], v27 offset:16
    buffer_store_dwordx4 v[12:15], v6, s[44:47], s4 offen offset:0 sc1
    buffer_store_dwordx4 v[12:15], v6, s[44:47], s4 offen offset:1024 sc1
    buffer_store_dwordx4 v[12:15], v6, s[44:47], s4 offen offset:2048 sc1
    buffer_store_dwordx4 v[12:15], v6, s[44:47], s4 offen offset:3072 sc1
    s_waitcnt lgkmcnt(0)
    v_perm_b32 v116, v100, v99, v26
    v_perm_b32 v117, v99, v98, v26
    v_perm_b32 v118, v98, v97, v26
    v_perm_b32 v119, v97, v96, v26
    v_perm_b32 v120, v106, v105, v26
    v_perm_b32 v121, v105, v104, v26
    v_perm_b32 v122, v104, v103, v26
    v_perm_b32 v123, v103, v102, v26
    v_mfma_f32_16x16x32_bf16 v[64:67], v[116:119], v[156:159], v[64:67]
    ds_read2_b32 v[96:97], v25 offset0:32 offset1:33
    ds_read2_b32 v[98:99], v25 offset0:34 offset1:35
    v_mfma_f32_16x16x32_bf16 v[68:71], v[116:119], v[160:163], v[68:71]
    ds_read_b32 v100, v25 offset:144
    ds_read2_b32 v[102:103], v25 offset0:160 offset1:161
    v_mfma_f32_16x16x32_bf16 v[72:75], v[116:119], v[164:167], v[72:75]
    ds_read2_b32 v[104:105], v25 offset0:162 offset1:163
    ds_read_b32 v106, v25 offset:656
    v_mfma_f32_16x16x32_bf16 v[76:79], v[116:119], v[168:171], v[76:79]
    ds_read_b64 v[36:37], v27 offset:8
    ds_read_b64 v[38:39], v27 offset:0
    v_mfma_f32_16x16x32_bf16 v[80:83], v[116:119], v[172:175], v[80:83]
    ds_read_b128 v[124:127], v9 offset:320
    ds_read_b128 v[128:131], v9 offset:832
    v_mfma_f32_16x16x32_bf16 v[84:87], v[116:119], v[176:179], v[84:87]
    ds_read_b128 v[132:135], v9 offset:1344
    ds_read_b128 v[136:139], v9 offset:1856
    v_mfma_f32_16x16x32_bf16 v[88:91], v[116:119], v[180:183], v[88:91]
    ds_read_b128 v[140:143], v9 offset:2368
    ds_read_b128 v[144:147], v9 offset:2880
    v_mfma_f32_16x16x32_bf16 v[92:95], v[116:119], v[184:187], v[92:95]
    ds_read_b128 v[148:151], v9 offset:3392
    ds_read_b128 v[152:155], v9 offset:3904
    v_mfma_f32_16x16x32_bf16 v[68:71], v[120:123], v[156:159], v[68:71]
    s_cmp_ge_u32 s56, 4
    s_cbranch_scc1 L_cv_a1
    v_mfma_f32_16x16x32_bf16 v[72:75], v[120:123], v[160:163], v[72:75]
    s_add_u32 s64, s56, 0
    s_mul_i32 s65, s64, 5120
    s_mul_i32 s64, s64, 40960
    s_lshr_b32 s66, s58, 2
    s_mul_i32 s66, s66, 160
    s_add_u32 s64, s64, s66
    s_add_u32 m0, s65, 43040
    s_nop 0
    buffer_load_dwordx4 v20, s[40:43], s64 offen lds
    v_mfma_f32_16x16x32_bf16 v[76:79], v[120:123], v[164:167], v[76:79]
    s_add_u32 m0, s65, 44064
    s_nop 0
    buffer_load_dwordx4 v21, s[40:43], s64 offen lds
    v_mfma_f32_16x16x32_bf16 v[80:83], v[120:123], v[168:171], v[80:83]
    s_add_u32 m0, s65, 45088
    s_nop 0
    buffer_load_dwordx4 v22, s[40:43], s64 offen lds
    v_mfma_f32_16x16x32_bf16 v[84:87], v[120:123], v[172:175], v[84:87]
    s_add_u32 m0, s65, 46112
    s_nop 0
    buffer_load_dwordx4 v23, s[40:43], s64 offen lds
    v_mfma_f32_16x16x32_bf16 v[88:91], v[120:123], v[176:179], v[88:91]
    s_add_u32 m0, s65, 47136
    s_nop 0
    buffer_load_dwordx4 v24, s[40:43], s64 offen lds
    v_mfma_f32_16x16x32_bf16 v[92:95], v[120:123], v[180:183], v[92:95]
    s_branch L_cv_b1
L_cv_a1:
    v_mfma_f32_16x16x32_bf16 v[72:75], v[120:123], v[160:163], v[72:75]
    v_mfma_f32_16x16x32_bf16 v[76:79], v[120:123], v[164:167], v[76:79]
    v_mfma_f32_16x16x32_bf16 v[80:83], v[120:123], v[168:171], v[80:83]
    v_mfma_f32_16x16x32_bf16 v[84:87], v[120:123], v[172:175], v[84:87]
    v_mfma_f32_16x16x32_bf16 v[88:91], v[120:123], v[176:179], v[88:91]
    v_mfma_f32_16x16x32_bf16 v[92:95], v[120:123], v[180:183], v[92:95]
L_cv_b1:
    s_waitcnt lgkmcnt(0)
    v_mfma_f32_16x16x32_bf16 v[72:75], v[188:191], v[44:47], v[72:75]
    v_perm_b32 v108, v100, v99, v26
    v_perm_b32 v109, v99, v98, v26
    v_mfma_f32_16x16x32_bf16 v[76:79], v[196:199], v[44:47], v[76:79]
    v_perm_b32 v110, v98, v97, v26
    v_perm_b32 v111, v97, v96, v26
    v_mfma_f32_16x16x32_bf16 v[80:83], v[204:207], v[44:47], v[80:83]
    v_perm_b32 v112, v106, v105, v26
    v_perm_b32 v113, v105, v104, v26
    v_mfma_f32_16x16x32_bf16 v[84:87], v[212:215], v[44:47], v[84:87]
    v_perm_b32 v114, v104, v103, v26
    v_perm_b32 v115, v103, v102, v26
    v_mfma_f32_16x16x32_bf16 v[88:91], v[220:223], v[44:47], v[88:91]
    v_mfma_f32_16x16x32_bf16 v[92:95], v[228:231], v[44:47], v[92:95]
    s_cmp_lt_u32 s56, 4
    s_cbranch_scc1 L_cv_p2
    s_setprio 0
L_cv_p2:
    v_mfma_f32_16x16x32_bf16 v[64:67], v[108:111], v[124:127], v[64:67]
    ds_read2_b32 v[96:97], v25 offset0:48 offset1:49
    ds_read2_b32 v[98:99], v25 offset0:50 offset1:51
    v_mfma_f32_16x16x32_bf16 v[68:71], v[108:111], v[128:131], v[68:71]
    ds_read_b32 v100, v25 offset:208
    ds_read2_b32 v[102:103], v25 offset0:176 offset1:177
    v_mfma_f32_16x16x32_bf16 v[72:75], v[108:111], v[132:135], v[72:75]
    ds_read2_b32 v[104:105], v25 offset0:178 offset1:179
    ds_read_b32 v106, v25 offset:720
    v_mfma_f32_16x16x32_bf16 v[76:79], v[108:111], v[136:139], v[76:79]
    ds_read_b64 v[44:45], v27 offset:152
    ds_read_b64 v[46:47], v27 offset:144
    v_mfma_f32_16x16x32_bf16 v[80:83], v[108:111], v[140:143], v[80:83]
    ds_read2_b32 v[48:49], v28 offset0:51 offset1:50
    ds_read2_b32 v[50:51], v28 offset0:49 offset1:48
    v_mfma_f32_16x16x32_bf16 v[84:87], v[108:111], v[144:147], v[84:87]
    ds_read_b128 v[156:159], v9 offset:256
    ds_read_b128 v[160:163], v9 offset:768
    v_mfma_f32_16x16x32_bf16 v[88:91], v[108:111], v[148:151], v[88:91]
    ds_read_b128 v[164:167], v9 offset:1280
    ds_read_b128 v[168:171], v9 offset:1792
    v_mfma_f32_16x16x32_bf16 v[92:95], v[108:111], v[152:155], v[92:95]
    ds_read_b128 v[172:175], v9 offset:2304
    ds_read_b128 v[176:179], v9 offset:2816
    v_mfma_f32_16x16x32_bf16 v[68:71], v[112:115], v[124:127], v[68:71]
    ds_read_b128 v[180:183], v9 offset:3328
    ds_read_b128 v[184:187], v9 offset:3840
    s_cmp_ge_u32 s56, 4
    s_cbranch_scc1 L_cv_a2
    v_mfma_f32_16x16x32_bf16 v[72:75], v[112:115], v[128:131], v[72:75]
    s_add_u32 s64, s56, 4
    s_mul_i32 s65, s64, 5120
    s_mul_i32 s64, s64, 40960
    s_lshr_b32 s66, s58, 2
    s_mul_i32 s66, s66, 160
    s_add_u32 s64, s64, s66
    s_add_u32 m0, s65, 43040
    s_nop 0
    buffer_load_dwordx4 v20, s[40:43], s64 offen lds
    v_mfma_f32_16x16x32_bf16 v[76:79], v[112:115], v[132:135], v[76:79]
    s_add_u32 m0, s65, 44064
    s_nop 0
    buffer_load_dwordx4 v21, s[40:43], s64 offen lds
    v_mfma_f32_16x16x32_bf16 v[80:83], v[112:115], v[136:139], v[80:83]
    s_add_u32 m0, s65, 45088
    s_nop 0
    buffer_load_dwordx4 v22, s[40:43], s64 offen lds
    v_mfma_f32_16x16x32_bf16 v[84:87], v[112:115], v[140:143], v[84:87]
    s_add_u32 m0, s65, 46112
    s_nop 0
    buffer_load_dwordx4 v23, s[40:43], s64 offen lds
    v_mfma_f32_16x16x32_bf16 v[88:91], v[112:115], v[144:147], v[88:91]
    s_add_u32 m0, s65, 47136
    s_nop 0
    buffer_load_dwordx4 v24, s[40:43], s64 offen lds
    v_mfma_f32_16x16x32_bf16 v[92:95], v[112:115], v[148:151], v[92:95]
    s_branch L_cv_b2
L_cv_a2:
    v_mfma_f32_16x16x32_bf16 v[72:75], v[112:115], v[128:131], v[72:75]
    v_mfma_f32_16x16x32_bf16 v[76:79], v[112:115], v[132:135], v[76:79]
    v_mfma_f32_16x16x32_bf16 v[80:83], v[112:115], v[136:139], v[80:83]
    v_mfma_f32_16x16x32_bf16 v[84:87], v[112:115], v[140:143], v[84:87]
    v_mfma_f32_16x16x32_bf16 v[88:91], v[112:115], v[144:147], v[88:91]
    v_mfma_f32_16x16x32_bf16 v[92:95], v[112:115], v[148:151], v[92:95]
    s_waitcnt vmcnt(0)
L_cv_b2:
    s_waitcnt lgkmcnt(0)
    v_mfma_f32_16x16x32_bf16 v[72:75], v[192:195], v[36:39], v[72:75]
    v_perm_b32 v116, v100, v99, v26
    v_perm_b32 v117, v99, v98, v26
    v_mfma_f32_16x16x32_bf16 v[76:79], v[200:203], v[36:39], v[76:79]
    v_perm_b32 v118, v98, v97, v26
    v_perm_b32 v119, v97, v96, v26
    v_mfma_f32_16x16x32_bf16 v[80:83], v[208:211], v[36:39], v[80:83]
    v_perm_b32 v120, v106, v105, v26
    v_perm_b32 v121, v105, v104, v26
    v_mfma_f32_16x16x32_bf16 v[84:87], v[216:219], v[36:39], v[84:87]
    v_perm_b32 v122, v104, v103, v26
    v_perm_b32 v123, v103, v102, v26
    v_mfma_f32_16x16x32_bf16 v[88:91], v[224:227], v[36:39], v[88:91]
    v_mfma_f32_16x16x32_bf16 v[92:95], v[232:235], v[36:39], v[92:95]
    s_waitcnt vmcnt(10)
    s_mov_b64 exec, 1
    ds_add_rtn_u32 v5, v4, v2
    s_mov_b64 exec, -1
    v_mfma_f32_16x16x32_bf16 v[64:67], v[116:119], v[156:159], v[64:67]
    ds_read2_b32 v[96:97], v25 offset0:64 offset1:65
    ds_read2_b32 v[98:99], v25 offset0:66 offset1:67
    v_mfma_f32_16x16x32_bf16 v[68:71], v[116:119], v[160:163], v[68:71]
    ds_read_b32 v100, v25 offset:272
    ds_read2_b32 v[102:103], v25 offset0:192 offset1:193
    v_mfma_f32_16x16x32_bf16 v[72:75], v[116:119], v[164:167], v[72:75]
    ds_read2_b32 v[104:105], v25 offset0:194 offset1:195
    ds_read_b32 v106, v25 offset:784
    v_mfma_f32_16x16x32_bf16 v[76:79], v[116:119], v[168:171], v[76:79]
    ds_read_b64 v[36:37], v27 offset:136
    ds_read_b64 v[38:39], v27 offset:128
    v_mfma_f32_16x16x32_bf16 v[80:83], v[116:119], v[172:175], v[80:83]
    ds_read_b128 v[124:127], v9 offset:192
    ds_read_b128 v[128:131], v9 offset:704
    v_mfma_f32_16x16x32_bf16 v[84:87], v[116:119], v[176:179], v[84:87]
    ds_read_b128 v[132:135], v9 offset:1216
    ds_read_b128 v[136:139], v9 offset:1728
    v_mfma_f32_16x16x32_bf16 v[88:91], v[116:119], v[180:183], v[88:91]
    ds_read_b128 v[140:143], v9 offset:2240
    ds_read_b128 v[144:147], v9 offset:2752
    v_mfma_f32_16x16x32_bf16 v[92:95], v[116:119], v[184:187], v[92:95]
    ds_read_b128 v[148:151], v9 offset:3264
    ds_read_b128 v[152:155], v9 offset:3776
    v_mfma_f32_16x16x32_bf16 v[68:71], v[120:123], v[156:159], v[68:71]
    s_cmp_ge_u32 s56, 4
    s_cbranch_scc1 L_cv_a3
    v_mfma_f32_16x16x32_bf16 v[72:75], v[120:123], v[160:163], v[72:75]
    s_add_u32 s64, s56, 8
    s_mul_i32 s65, s64, 5120
    s_mul_i32 s64, s64, 40960
    s_lshr_b32 s66, s58, 2
    s_mul_i32 s66, s66, 160
    s_add_u32 s64, s64, s66
    s_add_u32 m0, s65, 43040
    s_nop 0
    buffer_load_dwordx4 v20, s[40:43], s64 offen lds
    v_mfma_f32_16x16x32_bf16 v[76:79], v[120:123], v[164:167], v[76:79]
    s_add_u32 m0, s65, 44064
    s_nop 0
    buffer_load_dwordx4 v21, s[40:43], s64 offen lds
    v_mfma_f32_16x16x32_bf16 v[80:83], v[120:123], v[168:171], v[80:83]
    s_add_u32 m0, s65, 45088
    s_nop 0
    buffer_load_dwordx4 v22, s[40:43], s64 offen lds
    v_mfma_f32_16x16x32_bf16 v[84:87], v[120:123], v[172:175], v[84:87]
    s_add_u32 m0, s65, 46112
    s_nop 0
    buffer_load_dwordx4 v23, s[40:43], s64 offen lds
    v_mfma_f32_16x16x32_bf16 v[88:91], v[120:123], v[176:179], v[88:91]
    s_add_u32 m0, s65, 47136
    s_nop 0
    buffer_load_dwordx4 v24, s[40:43], s64 offen lds
    v_mfma_f32_16x16x32_bf16 v[92:95], v[120:123], v[180:183], v[92:95]
    s_branch L_cv_b3
L_cv_a3:
    v_mfma_f32_16x16x32_bf16 v[72:75], v[120:123], v[160:163], v[72:75]
    v_mfma_f32_16x16x32_bf16 v[76:79], v[120:123], v[164:167], v[76:79]
    v_mfma_f32_16x16x32_bf16 v[80:83], v[120:123], v[168:171], v[80:83]
    v_mfma_f32_16x16x32_bf16 v[84:87], v[120:123], v[172:175], v[84:87]
    v_mfma_f32_16x16x32_bf16 v[88:91], v[120:123], v[176:179], v[88:91]
    v_mfma_f32_16x16x32_bf16 v[92:95], v[120:123], v[180:183], v[92:95]
L_cv_b3:
    s_waitcnt lgkmcnt(0)
    v_mfma_f32_16x16x32_bf16 v[76:79], v[188:191], v[44:47], v[76:79]
    v_perm_b32 v108, v100, v99, v26
    v_perm_b32 v109, v99, v98, v26
    v_mfma_f32_16x16x32_bf16 v[80:83], v[196:199], v[44:47], v[80:83]
    v_perm_b32 v110, v98, v97, v26
    v_perm_b32 v111, v97, v96, v26
    v_mfma_f32_16x16x32_bf16 v[84:87], v[204:207], v[44:47], v[84:87]
    v_perm_b32 v112, v106, v105, v26
    v_perm_b32 v113, v105, v104, v26
    v_mfma_f32_16x16x32_bf16 v[88:91], v[212:215], v[44:47], v[88:91]
    v_perm_b32 v114, v104, v103, v26
    v_perm_b32 v115, v103, v102, v26
    v_mfma_f32_16x16x32_bf16 v[92:95], v[220:223], v[44:47], v[92:95]
    v_mfma_f32_16x16x32_bf16 v[92:95], v[236:239], v[48:51], v[92:95]
    v_readfirstlane_b32 s7, v5
    s_cmp_lg_u32 s7, 7
    s_cbranch_scc1 L_one_32
    s_mov_b64 exec, 1
    buffer_store_dword v2, v1, s[44:47], s60 offen sc1
    s_mov_b64 exec, -1
L_one_32:
    v_mfma_f32_16x16x32_bf16 v[64:67], v[108:111], v[124:127], v[64:67]
    ds_read2_b32 v[96:97], v25 offset0:80 offset1:81
    ds_read2_b32 v[98:99], v25 offset0:82 offset1:83
    v_mfma_f32_16x16x32_bf16 v[68:71], v[108:111], v[128:131], v[68:71]
    ds_read_b32 v100, v25 offset:336
    ds_read2_b32 v[102:103], v25 offset0:208 offset1:209
    v_mfma_f32_16x16x32_bf16 v[72:75], v[108:111], v[132:135], v[72:75]
    ds_read2_b32 v[104:105], v25 offset0:210 offset1:211
    ds_read_b32 v106, v25 offset:848
    v_mfma_f32_16x16x32_bf16 v[76:79], v[108:111], v[136:139], v[76:79]
    ds_read_b64 v[44:45], v27 offset:280
    ds_read_b64 v[46:47], v27 offset:272
    v_mfma_f32_16x16x32_bf16 v[80:83], v[108:111], v[140:143], v[80:83]
    ds_read2_b32 v[48:49], v28 offset0:35 offset1:34
    ds_read2_b32 v[50:51], v28 offset0:33 offset1:32
    v_mfma_f32_16x16x32_bf16 v[84:87], v[108:111], v[144:147], v[84:87]
    ds_read_b128 v[156:159], v9 offset:128
    ds_read_b128 v[160:163], v9 offset:640
    v_mfma_f32_16x16x32_bf16 v[88:91], v[108:111], v[148:151], v[88:91]
    ds_read_b128 v[164:167], v9 offset:1152
    ds_read_b128 v[168:171], v9 offset:1664
    v_mfma_f32_16x16x32_bf16 v[92:95], v[108:111], v[152:155], v[92:95]
    ds_read_b128 v[172:175], v9 offset:2176
    ds_read_b128 v[176:179], v9 offset:2688
    v_mfma_f32_16x16x32_bf16 v[68:71], v[112:115], v[124:127], v[68:71]
    ds_read_b128 v[180:183], v9 offset:3200
    ds_read_b128 v[184:187], v9 offset:3712
    s_cmp_ge_u32 s56, 4
    s_cbranch_scc1 L_cv_a4
    v_mfma_f32_16x16x32_bf16 v[72:75], v[112:115], v[128:131], v[72:75]
    s_add_u32 s64, s56, 12
    s_mul_i32 s65, s64, 5120
    s_mul_i32 s64, s64, 40960
    s_lshr_b32 s66, s58, 2
    s_mul_i32 s66, s66, 160
    s_add_u32 s64, s64, s66
    s_add_u32 m0, s65, 43040
    s_nop 0
    buffer_load_dwordx4 v20, s[40:43], s64 offen lds
    v_mfma_f32_16x16x32_bf16 v[76:79], v[112:115], v[132:135], v[76:79]
    s_add_u32 m0, s65, 44064
    s_nop 0
    buffer_load_dwordx4 v21, s[40:43], s64 offen lds
    v_mfma_f32_16x16x32_bf16 v[80:83], v[112:115], v[136:139], v[80:83]
    s_add_u32 m0, s65, 45088
    s_nop 0
    buffer_load_dwordx4 v22, s[40:43], s64 offen lds
    v_mfma_f32_16x16x32_bf16 v[84:87], v[112:115], v[140:143], v[84:87]
    s_add_u32 m0, s65, 46112
    s_nop 0
    buffer_load_dwordx4 v23, s[40:43], s64 offen lds
    v_mfma_f32_16x16x32_bf16 v[88:91], v[112:115], v[144:147], v[88:91]
    s_add_u32 m0, s65, 47136
    s_nop 0
    buffer_load_dwordx4 v24, s[40:43], s64 offen lds
    v_mfma_f32_16x16x32_bf16 v[92:95], v[112:115], v[148:151], v[92:95]
    s_branch L_cv_b4
L_cv_a4:
    v_mfma_f32_16x16x32_bf16 v[72:75], v[112:115], v[128:131], v[72:75]
    v_mfma_f32_16x16x32_bf16 v[76:79], v[112:115], v[132:135], v[76:79]
    v_mfma_f32_16x16x32_bf16 v[80:83], v[112:115], v[136:139], v[80:83]
    v_mfma_f32_16x16x32_bf16 v[84:87], v[112:115], v[140:143], v[84:87]
    v_mfma_f32_16x16x32_bf16 v[88:91], v[112:115], v[144:147], v[88:91]
    v_mfma_f32_16x16x32_bf16 v[92:95], v[112:115], v[148:151], v[92:95]
L_cv_b4:
    s_waitcnt lgkmcnt(0)
    v_mfma_f32_16x16x32_bf16 v[76:79], v[192:195], v[36:39], v[76:79]
    v_perm_b32 v116, v100, v99, v26
    v_perm_b32 v117, v99, v98, v26
    v_mfma_f32_16x16x32_bf16 v[80:83], v[200:203], v[36:39], v[80:83]
    v_perm_b32 v118, v98, v97, v26
    v_perm_b32 v119, v97, v96, v26
    v_mfma_f32_16x16x32_bf16 v[84:87], v[208:211], v[36:39], v[84:87]
    v_perm_b32 v120, v106, v105, v26
    v_perm_b32 v121, v105, v104, v26
    v_mfma_f32_16x16x32_bf16 v[88:91], v[216:219], v[36:39], v[88:91]
    v_perm_b32 v122, v104, v103, v26
    v_perm_b32 v123, v103, v102, v26
    v_mfma_f32_16x16x32_bf16 v[92:95], v[224:227], v[36:39], v[92:95]
    v_mfma_f32_16x16x32_bf16 v[64:67], v[116:119], v[156:159], v[64:67]
    ds_read2_b32 v[96:97], v25 offset0:96 offset1:97
    ds_read2_b32 v[98:99], v25 offset0:98 offset1:99
    v_mfma_f32_16x16x32_bf16 v[68:71], v[116:119], v[160:163], v[68:71]
    ds_read_b32 v100, v25 offset:400
    ds_read2_b32 v[102:103], v25 offset0:224 offset1:225
    v_mfma_f32_16x16x32_bf16 v[72:75], v[116:119], v[164:167], v[72:75]
    ds_read2_b32 v[104:105], v25 offset0:226 offset1:227
    ds_read_b32 v106, v25 offset:912
    v_mfma_f32_16x16x32_bf16 v[76:79], v[116:119], v[168:171], v[76:79]
    ds_read_b64 v[36:37], v27 offset:264
    ds_read_b64 v[38:39], v27 offset:256
    v_mfma_f32_16x16x32_bf16 v[80:83], v[116:119], v[172:175], v[80:83]
    ds_read_b128 v[124:127], v9 offset:64
    ds_read_b128 v[128:131], v9 offset:576
    v_mfma_f32_16x16x32_bf16 v[84:87], v[116:119], v[176:179], v[84:87]
    ds_read_b128 v[132:135], v9 offset:1088
    ds_read_b128 v[136:139], v9 offset:1600
    v_mfma_f32_16x16x32_bf16 v[88:91], v[116:119], v[180:183], v[88:91]
    ds_read_b128 v[140:143], v9 offset:2112
    ds_read_b128 v[144:147], v9 offset:2624
    v_mfma_f32_16x16x32_bf16 v[92:95], v[116:119], v[184:187], v[92:95]
    ds_read_b128 v[148:151], v9 offset:3136
    ds_read_b128 v[152:155], v9 offset:3648
    v_mfma_f32_16x16x32_bf16 v[68:71], v[120:123], v[156:159], v[68:71]
    s_cmp_ge_u32 s56, 4
    s_cbranch_scc1 L_cv_a5
    v_mfma_f32_16x16x32_bf16 v[72:75], v[120:123], v[160:163], v[72:75]
    s_add_u32 s64, s56, 16
    s_mul_i32 s65, s64, 5120
    s_mul_i32 s64, s64, 40960
    s_lshr_b32 s66, s58, 2
    s_mul_i32 s66, s66, 160
    s_add_u32 s64, s64, s66
    s_add_u32 m0, s65, 43040
    s_nop 0
    buffer_load_dwordx4 v20, s[40:43], s64 offen lds
    v_mfma_f32_16x16x32_bf16 v[76:79], v[120:123], v[164:167], v[76:79]
    s_add_u32 m0, s65, 44064
    s_nop 0
    buffer_load_dwordx4 v21, s[40:43], s64 offen lds
    v_mfma_f32_16x16x32_bf16 v[80:83], v[120:123], v[168:171], v[80:83]
    s_add_u32 m0, s65, 45088
    s_nop 0
    buffer_load_dwordx4 v22, s[40:43], s64 offen lds
    v_mfma_f32_16x16x32_bf16 v[84:87], v[120:123], v[172:175], v[84:87]
    s_add_u32 m0, s65, 46112
    s_nop 0
    buffer_load_dwordx4 v23, s[40:43], s64 offen lds
    v_mfma_f32_16x16x32_bf16 v[88:91], v[120:123], v[176:179], v[88:91]
    s_add_u32 m0, s65, 47136
    s_nop 0
    buffer_load_dwordx4 v24, s[40:43], s64 offen lds
    v_mfma_f32_16x16x32_bf16 v[92:95], v[120:123], v[180:183], v[92:95]
    s_branch L_cv_b5
L_cv_a5:
    v_mfma_f32_16x16x32_bf16 v[72:75], v[120:123], v[160:163], v[72:75]
    v_mfma_f32_16x16x32_bf16 v[76:79], v[120:123], v[164:167], v[76:79]
    v_mfma_f32_16x16x32_bf16 v[80:83], v[120:123], v[168:171], v[80:83]
    v_mfma_f32_16x16x32_bf16 v[84:87], v[120:123], v[172:175], v[84:87]
    v_mfma_f32_16x16x32_bf16 v[88:91], v[120:123], v[176:179], v[88:91]
    v_mfma_f32_16x16x32_bf16 v[92:95], v[120:123], v[180:183], v[92:95]
L_cv_b5:
    s_waitcnt lgkmcnt(0)
    v_mfma_f32_16x16x32_bf16 v[80:83], v[188:191], v[44:47], v[80:83]
    v_perm_b32 v108, v100, v99, v26
    v_perm_b32 v109, v99, v98, v26
    v_mfma_f32_16x16x32_bf16 v[84:87], v[196:199], v[44:47], v[84:87]
    v_perm_b32 v110, v98, v97, v26
    v_perm_b32 v111, v97, v96, v26
    v_mfma_f32_16x16x32_bf16 v[88:91], v[204:207], v[44:47], v[88:91]
    v_perm_b32 v112, v106, v105, v26
    v_perm_b32 v113, v105, v104, v26
    v_mfma_f32_16x16x32_bf16 v[92:95], v[212:215], v[44:47], v[92:95]
    v_perm_b32 v114, v104, v103, v26
    v_perm_b32 v115, v103, v102, v26
    v_mfma_f32_16x16x32_bf16 v[88:91], v[236:239], v[48:51], v[88:91]
    v_mfma_f32_16x16x32_bf16 v[92:95], v[240:243], v[48:51], v[92:95]
    v_mfma_f32_16x16x32_bf16 v[64:67], v[108:111], v[124:127], v[64:67]
    ds_read2_b32 v[96:97], v25 offset0:112 offset1:113
    ds_read2_b32 v[98:99], v25 offset0:114 offset1:115
    v_mfma_f32_16x16x32_bf16 v[68:71], v[108:111], v[128:131], v[68:71]
    ds_read_b32 v100, v25 offset:464
    ds_read2_b32 v[102:103], v25 offset0:240 offset1:241
    v_mfma_f32_16x16x32_bf16 v[72:75], v[108:111], v[132:135], v[72:75]
    ds_read2_b32 v[104:105], v25 offset0:242 offset1:243
    ds_read_b32 v106, v25 offset:976
    v_mfma_f32_16x16x32_bf16 v[76:79], v[108:111], v[136:139], v[76:79]
    ds_read2_b32 v[44:45], v28 offset0:3 offset1:2
    ds_read2_b32 v[46:47], v28 offset0:1 offset1:0
    v_mfma_f32_16x16x32_bf16 v[80:83], v[108:111], v[140:143], v[80:83]
    ds_read2_b32 v[48:49], v28 offset0:19 offset1:18
    ds_read2_b32 v[50:51], v28 offset0:17 offset1:16
    v_mfma_f32_16x16x32_bf16 v[84:87], v[108:111], v[144:147], v[84:87]
    ds_read_b128 v[156:159], v9 offset:0
    ds_read_b128 v[160:163], v9 offset:512
    v_mfma_f32_16x16x32_bf16 v[88:91], v[108:111], v[148:151], v[88:91]
    ds_read_b128 v[164:167], v9 offset:1024
    ds_read_b128 v[168:171], v9 offset:1536
    v_mfma_f32_16x16x32_bf16 v[92:95], v[108:111], v[152:155], v[92:95]
    ds_read_b128 v[172:175], v9 offset:2048
    ds_read_b128 v[176:179], v9 offset:2560
    v_mfma_f32_16x16x32_bf16 v[68:71], v[112:115], v[124:127], v[68:71]
    ds_read_b128 v[180:183], v9 offset:3072
    ds_read_b128 v[184:187], v9 offset:3584
    v_mfma_f32_16x16x32_bf16 v[72:75], v[112:115], v[128:131], v[72:75]
    v_mfma_f32_16x16x32_bf16 v[76:79], v[112:115], v[132:135], v[76:79]
    v_mfma_f32_16x16x32_bf16 v[80:83], v[112:115], v[136:139], v[80:83]
    v_mfma_f32_16x16x32_bf16 v[84:87], v[112:115], v[140:143], v[84:87]
    v_mfma_f32_16x16x32_bf16 v[88:91], v[112:115], v[144:147], v[88:91]
    v_mfma_f32_16x16x32_bf16 v[92:95], v[112:115], v[148:151], v[92:95]
    s_waitcnt lgkmcnt(0)
    v_mfma_f32_16x16x32_bf16 v[80:83], v[192:195], v[36:39], v[80:83]
    v_perm_b32 v116, v100, v99, v26
    v_perm_b32 v117, v99, v98, v26
    v_mfma_f32_16x16x32_bf16 v[84:87], v[200:203], v[36:39], v[84:87]
    v_perm_b32 v118, v98, v97, v26
    v_perm_b32 v119, v97, v96, v26
    v_mfma_f32_16x16x32_bf16 v[88:91], v[208:211], v[36:39], v[88:91]
    v_perm_b32 v120, v106, v105, v26
    v_perm_b32 v121, v105, v104, v26
    v_mfma_f32_16x16x32_bf16 v[92:95], v[216:219], v[36:39], v[92:95]
    v_perm_b32 v122, v104, v103, v26
    v_perm_b32 v123, v103, v102, v26
    v_mfma_f32_16x16x32_bf16 v[84:87], v[116:119], v[176:179], v[84:87]
    v_lshlrev_b32 v19, 5, v7
    v_lshlrev_b32 v18, 3, v8
    v_add_u32 v18, v19, v18
    v_add_u32 v18, s3, v18
    v_mfma_f32_16x16x32_bf16 v[88:91], v[116:119], v[180:183], v[88:91]
    v_add_u32 v4, 512, v18
    v_and_b32 v18, 7, v0
    v_lshlrev_b32 v18, 2, v18
    v_add_u32 v3, 163808, v18
    v_mfma_f32_16x16x32_bf16 v[92:95], v[116:119], v[184:187], v[92:95]
    v_ashrrev_i32 v18, 2, v7
    v_mul_u32_u24 v18, 4672, v18
    v_mov_b32 v19, s56
    v_lshlrev_b32 v19, 8, v19
    v_mfma_f32_16x16x32_bf16 v[84:87], v[120:123], v[172:175], v[84:87]
    v_add_u32 v19, 256, v19
    v_lshlrev_b32 v17, 4, v8
    v_add_u32 v17, v19, v17
    v_and_b32 v19, 3, v7
    v_mfma_f32_16x16x32_bf16 v[88:91], v[120:123], v[176:179], v[88:91]
    v_lshlrev_b32 v19, 2, v19
    v_add_u32 v19, v17, v19
    v_lshlrev_b32 v19, 1, v19
    v_add_u32 v19, v18, v19
    v_mfma_f32_16x16x32_bf16 v[92:95], v[120:123], v[180:183], v[92:95]
    v_subrev_u32 v5, 2048, v19
    v_mfma_f32_16x16x32_bf16 v[84:87], v[240:243], v[44:47], v[84:87]
    v_mfma_f32_16x16x32_bf16 v[88:91], v[244:247], v[44:47], v[88:91]
    v_mfma_f32_16x16x32_bf16 v[92:95], v[248:251], v[44:47], v[92:95]
    s_waitcnt vmcnt(0)
    s_cmp_lg_u32 s56, 0
    s_cbranch_scc1 L_one_33
    s_and_b32 s64, s58, 2
    s_lshl_b32 s65, s57, 2
    s_add_u32 s64, s64, s65
    s_lshl_b32 s64, s64, 9
    s_add_u32 s64, s64, 8413184
    s_lshr_b32 s65, s58, 2
    s_mul_i32 s65, s65, 1280
    s_add_u32 s65, s65, 8428544
    v_mov_b32 v19, s64
    v_mov_b32 v18, s65
    v_cmp_gt_i32 vcc, 8, v0
    s_nop 1
    v_cndmask_b32 v18, v18, v19, vcc
    v_lshlrev_b32 v19, 7, v0
    v_add_u32 v6, v18, v19
    s_mov_b64 exec, 262143
    buffer_load_dword v15, v6, s[44:47], 0 offen sc1
    s_mov_b64 exec, -1
L_one_33:
    v_mfma_f32_16x16x32_bf16 v[64:67], v[116:119], v[156:159], v[64:67]
    v_mfma_f32_16x16x32_bf16 v[68:71], v[116:119], v[160:163], v[68:71]
    v_mfma_f32_16x16x32_bf16 v[68:71], v[120:123], v[156:159], v[68:71]
    s_nop 5
    v_cvt_pk_bf16_f32 v64, v64, v65
    v_cvt_pk_bf16_f32 v65, v66, v67
    ds_write_b64 v4, v[64:65] offset:0
    v_mfma_f32_16x16x32_bf16 v[72:75], v[116:119], v[164:167], v[72:75]
    v_mfma_f32_16x16x32_bf16 v[72:75], v[120:123], v[160:163], v[72:75]
    v_cvt_pk_bf16_f32 v68, v68, v69
    v_cvt_pk_bf16_f32 v69, v70, v71
    ds_write_b64 v4, v[68:69] offset:512
    v_mfma_f32_16x16x32_bf16 v[76:79], v[116:119], v[168:171], v[76:79]
    v_mfma_f32_16x16x32_bf16 v[76:79], v[120:123], v[164:167], v[76:79]
    s_nop 2
    v_cvt_pk_bf16_f32 v72, v72, v73
    v_cvt_pk_bf16_f32 v73, v74, v75
    ds_write_b64 v4, v[72:73] offset:1024
    v_mfma_f32_16x16x32_bf16 v[80:83], v[116:119], v[172:175], v[80:83]
    v_mfma_f32_16x16x32_bf16 v[80:83], v[120:123], v[168:171], v[80:83]
    v_cvt_pk_bf16_f32 v76, v76, v77
    v_cvt_pk_bf16_f32 v77, v78, v79
    ds_write_b64 v4, v[76:77] offset:1536
    v_mfma_f32_16x16x32_bf16 v[80:83], v[236:239], v[44:47], v[80:83]
    v_mfma_f32_16x16x32_bf16 v[84:87], v[236:239], v[48:51], v[84:87]
    v_mfma_f32_16x16x32_bf16 v[88:91], v[240:243], v[48:51], v[88:91]
    s_nop 5
    v_cvt_pk_bf16_f32 v80, v80, v81
    v_cvt_pk_bf16_f32 v81, v82, v83
    ds_write_b64 v4, v[80:81] offset:2048
    v_mfma_f32_16x16x32_bf16 v[92:95], v[244:247], v[48:51], v[92:95]
    v_cvt_pk_bf16_f32 v84, v84, v85
    v_cvt_pk_bf16_f32 v85, v86, v87
    ds_write_b64 v4, v[84:85] offset:2560
    v_cvt_pk_bf16_f32 v88, v88, v89
    v_cvt_pk_bf16_f32 v89, v90, v91
    ds_write_b64 v4, v[88:89] offset:3072
    s_nop 1
    v_cvt_pk_bf16_f32 v92, v92, v93
    v_cvt_pk_bf16_f32 v93, v94, v95
    ds_write_b64 v4, v[92:93] offset:3584
    s_lshl_b64 s[12:13], 1, s56
    s_cmp_ge_u32 s56, 4
    s_cselect_b32 s14, 0xff, 15
    v_mov_b32 v14, 4
    s_mov_b64 exec, s[12:13]
    ds_write_b32 v3, v14
    s_mov_b64 exec, -1
    ds_read_b32 v14, v3
    s_waitcnt lgkmcnt(0)
L_rl_34:
    v_cmp_gt_u32 vcc, 4, v14
    s_and_b32 s63, vcc_lo, s14
    s_cbranch_scc0 L_rd_35
    ds_read_b32 v14, v3
    s_sleep 1
    s_waitcnt lgkmcnt(0)
    s_branch L_rl_34
L_rd_35:
    s_mov_b32 s59, 43040
    s_mov_b32 s3, 15
    s_cmp_lt_u32 s56, 4
    s_cbranch_scc1 L_outproj3
    s_setprio 0
    s_sub_u32 s5, s4, 16384
    ds_read_b64_tr_b16 v[108:109], v5 offset:0
    ds_read_b64_tr_b16 v[110:111], v5 offset:18688
    ds_read_b64_tr_b16 v[112:113], v5 offset:128
    ds_read_b64_tr_b16 v[114:115], v5 offset:18816
    ds_read_b64_tr_b16 v[116:117], v5 offset:256
    ds_read_b64_tr_b16 v[118:119], v5 offset:18944
    ds_read_b64_tr_b16 v[120:121], v5 offset:384
    ds_read_b64_tr_b16 v[122:123], v5 offset:19072
    s_waitcnt lgkmcnt(6)
    buffer_store_dwordx4 v[108:111], v6, s[44:47], s5 offen offset:0 sc1
    ds_read_b64_tr_b16 v[124:125], v5 offset:2048
    ds_read_b64_tr_b16 v[126:127], v5 offset:20736
    s_waitcnt lgkmcnt(6)
    buffer_store_dwordx4 v[112:115], v6, s[44:47], s5 offen offset:1024 sc1
    ds_read_b64_tr_b16 v[128:129], v5 offset:2176
    ds_read_b64_tr_b16 v[130:131], v5 offset:20864
    s_waitcnt lgkmcnt(6)
    buffer_store_dwordx4 v[116:119], v6, s[44:47], s5 offen offset:2048 sc1
    ds_read_b64_tr_b16 v[132:133], v5 offset:2304
    ds_read_b64_tr_b16 v[134:135], v5 offset:20992
    s_waitcnt lgkmcnt(6)
    buffer_store_dwordx4 v[120:123], v6, s[44:47], s5 offen offset:3072 sc1
    ds_read_b64_tr_b16 v[136:137], v5 offset:2432
    ds_read_b64_tr_b16 v[138:139], v5 offset:21120
    s_waitcnt lgkmcnt(6)
    buffer_store_dwordx4 v[124:127], v6, s[44:47], s4 offen offset:0 sc1
    s_waitcnt lgkmcnt(4)
    buffer_store_dwordx4 v[128:131], v6, s[44:47], s4 offen offset:1024 sc1
    s_waitcnt lgkmcnt(2)
    buffer_store_dwordx4 v[132:135], v6, s[44:47], s4 offen offset:2048 sc1
    s_waitcnt lgkmcnt(0)
    buffer_store_dwordx4 v[136:139], v6, s[44:47], s4 offen offset:3072 sc1
    s_branch L_end
L_spare:
    s_sub_u32 s68, s58, 26
    s_lshl_b32 s64, s57, 2
    s_lshl_b32 s65, s57, 1
    s_add_u32 s65, s65, 28
    s_cmp_lt_u32 s68, 4
    s_cselect_b32 s61, s64, s65
    s_add_u32 s61, s61, s68
    s_mul_i32 s69, s56, 6
    s_add_u32 s69, s69, s68
    v_mov_b32 v1, 0
    v_mov_b32 v2, 1
    v_mul_u32_u24 v5, 1280, v0
    v_mul_u32_u24 v6, 3840, v0
    v_lshlrev_b32 v15, 2, v0
    s_mov_b32 s34, 2621440
    s_mov_b32 s35, 0x20000
    s_mov_b32 s38, 2457600
    s_mov_b32 s39, 0x20000
    s_waitcnt lgkmcnt(0)
    s_mov_b64 s[32:33], s[4:5]
    s_mov_b64 s[36:37], s[6:7]
    s_add_i32 s63, s69, 18
    s_mul_i32 s64, s63, 3641
    s_lshr_b32 s64, s64, 16
    s_mul_i32 s65, s64, 18
    s_sub_u32 s65, s63, s65
    s_cmp_ge_u32 s65, 8
    s_cbranch_scc1 L_pfw_38
    s_lshr_b32 s66, s57, 1
    s_lshl_b32 s66, s66, 3
    s_add_u32 s65, s65, s66
    s_mul_i32 s65, s65, 81920
    s_lshl_b32 s64, s64, 7
    s_add_u32 s64, s64, s65
    buffer_load_dword v4, v5, s[32:35], s64 offen
    s_branch L_pfe_39
L_pfw_38:
    s_mul_i32 s64, s64, 245760
    s_cmp_ge_u32 s65, 13
    s_cselect_b32 s66, 7, 2
    s_add_u32 s65, s65, s66
    s_and_b32 s66, s57, 1
    s_mul_i32 s66, s66, 5
    s_add_u32 s65, s65, s66
    s_lshl_b32 s65, s65, 7
    s_add_u32 s64, s64, s65
    buffer_load_dword v4, v6, s[36:39], s64 offen
L_pfe_39:
L_pe_36:
    s_mov_b32 s46, 268435456
    s_mov_b32 s47, 0x20000
    s_mov_b32 s42, 819200
    s_mov_b32 s43, 0x20000
    s_mov_b32 s50, 256
    s_mov_b32 s51, 0x20000
    s_mov_b32 s54, 2621440
    s_mov_b32 s55, 0x20000
    s_waitcnt lgkmcnt(0)
    s_mov_b64 s[44:45], s[30:31]
    s_mov_b64 s[40:41], s[8:9]
    s_mov_b64 s[48:49], s[28:29]
    s_mov_b64 s[52:53], s[26:27]
    s_barrier
    s_cmp_lt_u32 s2, 254
    s_cbranch_scc1 L_sp_noclr
    s_and_b32 s64, s2, 1
    v_lshlrev_b32 v255, 4, v0
    v_mov_b32 v254, s64
    v_lshlrev_b32 v254, 3, v254
    v_add_u32 v254, s56, v254
    v_lshlrev_b32 v254, 12, v254
    v_add_u32 v254, v255, v254
    v_add_u32 v104, 8388608, v254
    v_mov_b32 v100, -1
    v_mov_b32 v101, -1
    v_mov_b32 v102, -1
    v_mov_b32 v103, -1
    buffer_store_dwordx4 v[100:103], v104, s[44:47], 0 offen offset:0 sc1
    buffer_store_dwordx4 v[100:103], v104, s[44:47], 0 offen offset:1024 sc1
    buffer_store_dwordx4 v[100:103], v104, s[44:47], 0 offen offset:2048 sc1
    buffer_store_dwordx4 v[100:103], v104, s[44:47], 0 offen offset:3072 sc1
    s_lshl_b32 s64, s64, 7
    s_waitcnt vmcnt(0)
    s_barrier
    s_cmp_lg_u32 s56, 0
    s_cbranch_scc1 L_one_40
    s_mov_b64 exec, 1
    buffer_store_dword v2, v1, s[48:51], s64 offen sc1
    s_mov_b64 exec, -1
L_one_40:
L_sp_noclr:
    s_cmp_ge_u32 s69, 34
    s_cbranch_scc1 L_pn_43
    s_add_i32 s63, s69, 146
    s_mul_i32 s64, s63, 3641
    s_lshr_b32 s64, s64, 16
    s_mul_i32 s65, s64, 18
    s_sub_u32 s65, s63, s65
    s_cmp_ge_u32 s65, 8
    s_cbranch_scc1 L_pfw_44
    s_lshr_b32 s66, s57, 1
    s_lshl_b32 s66, s66, 3
    s_add_u32 s65, s65, s66
    s_mul_i32 s65, s65, 81920
    s_lshl_b32 s64, s64, 7
    s_add_u32 s64, s64, s65
    buffer_load_dword v4, v5, s[32:35], s64 offen
    s_branch L_pfe_45
L_pfw_44:
    s_mul_i32 s64, s64, 245760
    s_cmp_ge_u32 s65, 13
    s_cselect_b32 s66, 7, 2
    s_add_u32 s65, s65, s66
    s_and_b32 s66, s57, 1
    s_mul_i32 s66, s66, 5
    s_add_u32 s65, s65, s66
    s_lshl_b32 s65, s65, 7
    s_add_u32 s64, s64, s65
    buffer_load_dword v4, v6, s[36:39], s64 offen
L_pfe_45:
    s_branch L_pe_42
L_pn_43:
    s_add_i32 s63, s69, -34
    s_mul_i32 s64, s63, 13108
    s_lshr_b32 s64, s64, 16
    s_mul_i32 s65, s64, 5
    s_sub_u32 s65, s63, s65
    s_mul_i32 s64, s64, 245760
    s_and_b32 s66, s57, 1
    s_mul_i32 s66, s66, 5
    s_add_u32 s65, s65, s66
    s_lshl_b32 s65, s65, 7
    s_add_u32 s64, s64, s65
    buffer_load_dword v4, v6, s[36:39], s64 offen
L_pe_42:
    s_barrier
L_sp_41:
    s_cmp_ge_u32 s69, 36
    s_cbranch_scc1 L_pn_49
    s_add_i32 s63, s69, 14
    s_mul_i32 s64, s63, 13108
    s_lshr_b32 s64, s64, 16
    s_mul_i32 s65, s64, 5
    s_sub_u32 s65, s63, s65
    s_mul_i32 s64, s64, 245760
    s_and_b32 s66, s57, 1
    s_mul_i32 s66, s66, 5
    s_add_u32 s65, s65, s66
    s_lshl_b32 s65, s65, 7
    s_add_u32 s64, s64, s65
    buffer_load_dword v4, v6, s[36:39], s64 offen
    s_branch L_pe_48
L_pn_49:
    s_add_i32 s63, s69, -36
    s_mul_i32 s64, s63, 6554
    s_lshr_b32 s64, s64, 16
    s_mul_i32 s64, s64, -819072
    s_mul_i32 s65, s63, 81920
    s_add_u32 s64, s64, s65
    buffer_load_dword v4, v5, s[40:43], s64 offen
L_pe_48:
    s_barrier
L_sp_47:
    s_add_i32 s63, s69, 12
    s_mul_i32 s64, s63, 6554
    s_lshr_b32 s64, s64, 16
    s_mul_i32 s64, s64, -819072
    s_mul_i32 s65, s63, 81920
    s_add_u32 s64, s64, s65
    buffer_load_dword v4, v5, s[40:43], s64 offen
L_pe_52:
    s_barrier
L_sp_51:
    s_cmp_ge_u32 s68, 4
    s_cbranch_scc1 L_sp_54
    v_and_b32 v254, 7, v0
    v_lshlrev_b32 v14, 4, v254
    v_mov_b32 v254, s61
    v_lshlrev_b32 v254, 6, v254
    v_mov_b32 v255, s56
    v_lshlrev_b32 v255, 3, v255
    v_add_u32 v255, v254, v255
    v_ashrrev_i32 v254, 3, v0
    v_add_u32 v15, v255, v254
    v_mul_u32_u24 v254, 1280, v15
    v_add_u32 v13, v254, v14
    v_lshlrev_b32 v15, 2, v15
    buffer_load_dwordx4 v[20:23], v13, s[32:35], 0 offen offset:0
    global_load_dwordx4 v[60:63], v14, s[24:25] offset:0
    buffer_load_dwordx4 v[24:27], v13, s[32:35], 0 offen offset:128
    global_load_dwordx4 v[64:67], v14, s[24:25] offset:128
    buffer_load_dwordx4 v[28:31], v13, s[32:35], 0 offen offset:256
    global_load_dwordx4 v[68:71], v14, s[24:25] offset:256
    buffer_load_dwordx4 v[32:35], v13, s[32:35], 0 offen offset:384
    global_load_dwordx4 v[72:75], v14, s[24:25] offset:384
    buffer_load_dwordx4 v[36:39], v13, s[32:35], 0 offen offset:512
    global_load_dwordx4 v[76:79], v14, s[24:25] offset:512
    buffer_load_dwordx4 v[40:43], v13, s[32:35], 0 offen offset:640
    global_load_dwordx4 v[80:83], v14, s[24:25] offset:640
    buffer_load_dwordx4 v[44:47], v13, s[32:35], 0 offen offset:768
    global_load_dwordx4 v[84:87], v14, s[24:25] offset:768
    buffer_load_dwordx4 v[48:51], v13, s[32:35], 0 offen offset:896
    global_load_dwordx4 v[88:91], v14, s[24:25] offset:896
    buffer_load_dwordx4 v[52:55], v13, s[32:35], 0 offen offset:1024
    global_load_dwordx4 v[92:95], v14, s[24:25] offset:1024
    buffer_load_dwordx4 v[56:59], v13, s[32:35], 0 offen offset:1152
    global_load_dwordx4 v[96:99], v14, s[24:25] offset:1152
    v_mov_b32 v16, 0
    v_mov_b32 v17, 0
    s_waitcnt vmcnt(18)
    v_dot2c_f32_bf16 v16, v20, v60
    v_dot2c_f32_bf16 v17, v21, v61
    v_dot2c_f32_bf16 v16, v22, v62
    v_dot2c_f32_bf16 v17, v23, v63
    s_waitcnt vmcnt(16)
    v_dot2c_f32_bf16 v16, v24, v64
    v_dot2c_f32_bf16 v17, v25, v65
    v_dot2c_f32_bf16 v16, v26, v66
    v_dot2c_f32_bf16 v17, v27, v67
    s_waitcnt vmcnt(14)
    v_dot2c_f32_bf16 v16, v28, v68
    v_dot2c_f32_bf16 v17, v29, v69
    v_dot2c_f32_bf16 v16, v30, v70
    v_dot2c_f32_bf16 v17, v31, v71
    s_waitcnt vmcnt(12)
    v_dot2c_f32_bf16 v16, v32, v72
    v_dot2c_f32_bf16 v17, v33, v73
    v_dot2c_f32_bf16 v16, v34, v74
    v_dot2c_f32_bf16 v17, v35, v75
    s_waitcnt vmcnt(10)
    v_dot2c_f32_bf16 v16, v36, v76
    v_dot2c_f32_bf16 v17, v37, v77
    v_dot2c_f32_bf16 v16, v38, v78
    v_dot2c_f32_bf16 v17, v39, v79
    s_waitcnt vmcnt(8)
    v_dot2c_f32_bf16 v16, v40, v80
    v_dot2c_f32_bf16 v17, v41, v81
    v_dot2c_f32_bf16 v16, v42, v82
    v_dot2c_f32_bf16 v17, v43, v83
    s_waitcnt vmcnt(6)
    v_dot2c_f32_bf16 v16, v44, v84
    v_dot2c_f32_bf16 v17, v45, v85
    v_dot2c_f32_bf16 v16, v46, v86
    v_dot2c_f32_bf16 v17, v47, v87
    s_waitcnt vmcnt(4)
    v_dot2c_f32_bf16 v16, v48, v88
    v_dot2c_f32_bf16 v17, v49, v89
    v_dot2c_f32_bf16 v16, v50, v90
    v_dot2c_f32_bf16 v17, v51, v91
    s_waitcnt vmcnt(2)
    v_dot2c_f32_bf16 v16, v52, v92
    v_dot2c_f32_bf16 v17, v53, v93
    v_dot2c_f32_bf16 v16, v54, v94
    v_dot2c_f32_bf16 v17, v55, v95
    s_waitcnt vmcnt(0)
    v_dot2c_f32_bf16 v16, v56, v96
    v_dot2c_f32_bf16 v17, v57, v97
    v_dot2c_f32_bf16 v16, v58, v98
    v_dot2c_f32_bf16 v17, v59, v99
    s_nop 3
    v_add_f32 v16, v16, v17
    s_nop 1
    v_add_f32_dpp v16, v16, v16 quad_perm:[1,0,3,2] row_mask:0xf bank_mask:0xf
    s_nop 1
    v_add_f32_dpp v16, v16, v16 quad_perm:[2,3,0,1] row_mask:0xf bank_mask:0xf
    s_nop 1
    v_add_f32_dpp v16, v16, v16 row_half_mirror row_mask:0xf bank_mask:0xf
    v_mul_f32 v16, 1069066811, v16
    v_exp_f32_e64 v16, -v16
    s_nop 0
    v_add_f32 v16, 1.0, v16
    v_rcp_f32 v16, v16
L_sp_54:
    s_movk_i32 s64, 1120
    v_mul_u32_u24 v11, 6554, v0
    v_lshlrev_b32 v12, 4, v0
    v_lshrrev_b32 v8, 16, v11
    v_add_u32 v11, 419456, v11
    v_mad_u32_u24 v8, v8, s64, v12
    v_add_u32 v12, 1024, v12
    v_lshrrev_b32 v9, 16, v11
    v_add_u32 v11, 419456, v11
    v_mad_u32_u24 v9, v9, s64, v12
    v_add_u32 v12, 1024, v12
    v_lshrrev_b32 v10, 16, v11
    v_add_u32 v11, 419456, v11
    v_mad_u32_u24 v10, v10, s64, v12
    v_add_u32 v12, 1024, v12
    v_ashrrev_i32 v254, 16, v11
    v_mul_u32_u24 v254, 1120, v254
    v_add_u32 v11, v254, v12
    v_add_u32 v254, 256, v0
    v_mul_u32_u24 v254, 6554, v254
    v_ashrrev_i32 v254, 16, v254
    v_mul_u32_u24 v254, 1120, v254
    v_add_u32 v254, v254, v12
    v_add_u32 v12, 1024, v254
    v_lshlrev_b32 v7, 7, v0
    s_cmp_lg_u32 s56, 0
    s_cbranch_scc1 L_one_56
    s_mov_b64 exec, 3
    buffer_load_dword v3, v7, s[48:51], 0 offen sc1
    s_mov_b64 exec, -1
L_one_56:
    s_add_u32 s64, s56, 0
    s_mul_i32 s65, s64, 5120
    s_mul_i32 s64, s64, 40960
    s_lshr_b32 s66, s58, 2
    s_mul_i32 s66, s66, 160
    s_add_u32 s64, s64, s66
    s_add_u32 m0, s65, 43040
    s_nop 0
    buffer_load_dwordx4 v8, s[40:43], s64 offen lds
    s_add_u32 m0, s65, 44064
    s_nop 0
    buffer_load_dwordx4 v9, s[40:43], s64 offen lds
    s_add_u32 m0, s65, 45088
    s_nop 0
    buffer_load_dwordx4 v10, s[40:43], s64 offen lds
    s_add_u32 m0, s65, 46112
    s_nop 0
    buffer_load_dwordx4 v11, s[40:43], s64 offen lds
    s_add_u32 m0, s65, 47136
    s_nop 0
    buffer_load_dwordx4 v12, s[40:43], s64 offen lds
    s_add_u32 s64, s56, 8
    s_mul_i32 s65, s64, 5120
    s_mul_i32 s64, s64, 40960
    s_lshr_b32 s66, s58, 2
    s_mul_i32 s66, s66, 160
    s_add_u32 s64, s64, s66
    s_add_u32 m0, s65, 43040
    s_nop 0
    buffer_load_dwordx4 v8, s[40:43], s64 offen lds
    s_add_u32 m0, s65, 44064
    s_nop 0
    buffer_load_dwordx4 v9, s[40:43], s64 offen lds
    s_add_u32 m0, s65, 45088
    s_nop 0
    buffer_load_dwordx4 v10, s[40:43], s64 offen lds
    s_add_u32 m0, s65, 46112
    s_nop 0
    buffer_load_dwordx4 v11, s[40:43], s64 offen lds
    s_add_u32 m0, s65, 47136
    s_nop 0
    buffer_load_dwordx4 v12, s[40:43], s64 offen lds
    s_cmp_ge_u32 s56, 4
    s_cbranch_scc1 L_sp_55
    s_add_u32 s64, s56, 16
    s_mul_i32 s65, s64, 5120
    s_mul_i32 s64, s64, 40960
    s_lshr_b32 s66, s58, 2
    s_mul_i32 s66, s66, 160
    s_add_u32 s64, s64, s66
    s_add_u32 m0, s65, 43040
    s_nop 0
    buffer_load_dwordx4 v8, s[40:43], s64 offen lds
    s_add_u32 m0, s65, 44064
    s_nop 0
    buffer_load_dwordx4 v9, s[40:43], s64 offen lds
    s_add_u32 m0, s65, 45088
    s_nop 0
    buffer_load_dwordx4 v10, s[40:43], s64 offen lds
    s_add_u32 m0, s65, 46112
    s_nop 0
    buffer_load_dwordx4 v11, s[40:43], s64 offen lds
    s_add_u32 m0, s65, 47136
    s_nop 0
    buffer_load_dwordx4 v12, s[40:43], s64 offen lds
L_sp_55:
    v_and_b32 v254, 7, v0
    v_lshlrev_b32 v254, 2, v254
    v_add_u32 v14, 163808, v254
    ds_write_b32 v14, v1
    s_waitcnt vmcnt(0) lgkmcnt(0)
    s_cmp_lg_u32 s56, 0
    s_cbranch_scc1 L_one_57
    s_mov_b32 s63, 0
    s_mov_b64 exec, 3
L_fl_58:
    v_cmp_ne_u32 vcc, 1, v3
    s_add_u32 s63, s63, 1
    s_cbranch_vccz L_fd_59
    s_cmp_ge_u32 s63, 200000
    s_cbranch_scc1 L_fd_59
    s_sleep 4
    buffer_load_dword v3, v7, s[48:51], 0 offen sc1
    s_waitcnt vmcnt(0)
    s_branch L_fl_58
L_fd_59:
    s_mov_b64 exec, -1
L_one_57:
    s_barrier
    s_cmp_ge_u32 s68, 4
    s_cbranch_scc1 L_sp_nog
    s_mov_b32 s64, 8388608
    s_mov_b32 exec_lo, 0x01010101
    s_mov_b32 exec_hi, 0x01010101
    buffer_store_dword v16, v15, s[44:47], s64 offen sc1
    s_mov_b64 exec, -1
L_sp_nog:
    s_cmp_ge_u32 s56, 4
    s_cbranch_scc1 L_end
    s_mov_b32 s59, 43040
L_outproj:
    s_mov_b32 s3, 15
L_outproj2:
    s_cmp_lg_u32 s56, 0
    s_cbranch_scc1 L_one_60
    s_and_b32 s64, s58, 2
    s_lshl_b32 s65, s57, 2
    s_add_u32 s64, s64, s65
    s_lshl_b32 s64, s64, 9
    s_add_u32 s64, s64, 8413184
    s_lshr_b32 s65, s58, 2
    s_mul_i32 s65, s65, 1280
    s_add_u32 s65, s65, 8428544
    v_mov_b32 v43, s64
    v_mov_b32 v42, s65
    v_cmp_gt_i32 vcc, 8, v0
    s_nop 1
    v_cndmask_b32 v42, v42, v43, vcc
    v_lshlrev_b32 v43, 7, v0
    v_add_u32 v6, v42, v43
    s_mov_b64 exec, 262143
    buffer_load_dword v15, v6, s[44:47], 0 offen sc1
    s_mov_b64 exec, -1
L_one_60:
L_outproj3:
    s_and_b32 s67, s58, 3
    s_lshl_b32 s65, s57, 2
    s_add_u32 s67, s67, s65
    s_lshl_b32 s67, s67, 2
    s_add_u32 s67, s67, s56
    v_lshlrev_b32 v7, 4, v0
    v_lshlrev_b32 v8, 3, v0
    s_mul_i32 s4, s67, 20480
    s_add_u32 s4, s4, 2097152
    s_add_u32 s5, s4, 4096
    s_add_u32 s6, s4, 8192
    s_add_u32 s7, s4, 12288
    s_add_u32 s8, s4, 16384
    v_and_b32 v26, 15, v0
    v_ashrrev_i32 v27, 4, v0
    v_lshlrev_b32 v43, 2, v27
    v_ashrrev_i32 v42, 2, v26
    v_add_u32 v42, v43, v42
    v_mul_u32_u24 v42, 160, v42
    v_and_b32 v43, 3, v26
    v_lshlrev_b32 v43, 3, v43
    v_add_u32 v43, v42, v43
    v_add_u32 v2, s59, v43
    v_mul_u32_u24 v43, 2560, v27
    v_add_u32 v43, v2, v43
    v_add_u32 v4, 2560, v43
    v_add_u32 v3, 51200, v2
    v_add_u32 v5, 51200, v4
    ds_read_b64_tr_b16 v[128:129], v2 offset:0
    s_lshr_b32 s68, s58, 2
    ds_read_b64_tr_b16 v[130:131], v2 offset:3200
    s_mul_i32 s69, s68, 10
    ds_read_b64_tr_b16 v[132:133], v2 offset:32
    s_mov_b32 s9, 131072
    ds_read_b64_tr_b16 v[134:135], v2 offset:3232
    v_and_b32 v43, 7, v0
    ds_read_b64_tr_b16 v[136:137], v2 offset:64
    v_lshlrev_b32 v43, 2, v43
    ds_read_b64_tr_b16 v[138:139], v2 offset:3264
    v_add_u32 v16, 163808, v43
    ds_read_b64_tr_b16 v[140:141], v2 offset:96
    v_mov_b32 v43, s67
    ds_read_b64_tr_b16 v[142:143], v2 offset:3296
    v_lshlrev_b32 v43, 4, v43
    ds_read_b64_tr_b16 v[144:145], v2 offset:128
    v_add_u32 v1, v43, v26
    ds_read_b64_tr_b16 v[146:147], v2 offset:3328
    v_and_b32 v43, 1, v27
    ds_read_b64_tr_b16 v[148:149], v2 offset:6400
    v_lshlrev_b32 v43, 1, v43
    ds_read_b64_tr_b16 v[150:151], v2 offset:9600
    v_ashrrev_i32 v42, 1, v27
    ds_read_b64_tr_b16 v[152:153], v2 offset:6432
    v_add_u32 v14, v43, v42
    ds_read_b64_tr_b16 v[154:155], v2 offset:9632
    v_add_u32 v42, s69, v14
    ds_read_b64_tr_b16 v[156:157], v2 offset:6464
    v_lshlrev_b32 v42, 15, v42
    ds_read_b64_tr_b16 v[158:159], v2 offset:9664
    v_lshlrev_b32 v43, 4, v1
    ds_read_b64_tr_b16 v[160:161], v2 offset:6496
    v_add_u32 v43, v42, v43
    ds_read_b64_tr_b16 v[162:163], v2 offset:9696
    v_add_u32 v9, 5242880, v43
    ds_read_b64_tr_b16 v[164:165], v2 offset:6528
    v_mov_b32 v43, s69
    ds_read_b64_tr_b16 v[166:167], v2 offset:9728
    v_add_u32 v43, 8, v43
    ds_read_b64_tr_b16 v[168:169], v2 offset:12800
    v_ashrrev_i32 v42, 1, v27
    ds_read_b64_tr_b16 v[170:171], v2 offset:16000
    v_add_u32 v42, v43, v42
    ds_read_b64_tr_b16 v[172:173], v2 offset:12832
    v_lshlrev_b32 v42, 15, v42
    ds_read_b64_tr_b16 v[174:175], v2 offset:16032
    v_lshlrev_b32 v43, 4, v1
    ds_read_b64_tr_b16 v[176:177], v2 offset:12864
    v_add_u32 v43, v42, v43
    ds_read_b64_tr_b16 v[178:179], v2 offset:16064
    v_and_b32 v42, 1, v27
    ds_read_b64_tr_b16 v[180:181], v2 offset:12896
    v_lshlrev_b32 v42, 3, v42
    ds_read_b64_tr_b16 v[182:183], v2 offset:16096
    v_add_u32 v42, v43, v42
    ds_read_b64_tr_b16 v[184:185], v2 offset:12928
    v_add_u32 v10, 5242880, v42
    ds_read_b64_tr_b16 v[186:187], v2 offset:16128
    v_lshlrev_b32 v42, 2, v1
    ds_read_b64_tr_b16 v[188:189], v2 offset:19200
    v_add_u32 v11, 8388608, v42
    ds_read_b64_tr_b16 v[190:191], v2 offset:22400
    v_mul_u32_u24 v42, 1280, v1
    ds_read_b64_tr_b16 v[192:193], v2 offset:19232
    v_mov_b32 v43, s68
    ds_read_b64_tr_b16 v[194:195], v2 offset:22432
    v_mul_u32_u24 v43, 160, v43
    ds_read_b64_tr_b16 v[196:197], v2 offset:19264
    v_add_u32 v13, v42, v43
    ds_read_b64_tr_b16 v[198:199], v2 offset:22464
    v_lshlrev_b32 v43, 4, v14
    ds_read_b64_tr_b16 v[200:201], v2 offset:19296
    v_add_u32 v12, v13, v43
    ds_read_b64_tr_b16 v[202:203], v2 offset:22496
    v_lshlrev_b32 v43, 3, v27
    ds_read_b64_tr_b16 v[204:205], v2 offset:19328
    v_add_u32 v43, v13, v43
    ds_read_b64_tr_b16 v[206:207], v2 offset:22528
    v_add_u32 v13, 128, v43
    ds_read_b64_tr_b16 v[208:209], v4 offset:0
    ds_read_b64_tr_b16 v[210:211], v4 offset:12800
    ds_read_b64_tr_b16 v[212:213], v4 offset:32
    ds_read_b64_tr_b16 v[214:215], v4 offset:12832
    ds_read_b64_tr_b16 v[216:217], v4 offset:64
    ds_read_b64_tr_b16 v[218:219], v4 offset:12864
    ds_read_b64_tr_b16 v[220:221], v4 offset:96
    ds_read_b64_tr_b16 v[222:223], v4 offset:12896
    ds_read_b64_tr_b16 v[224:225], v4 offset:128
    ds_read_b64_tr_b16 v[226:227], v4 offset:12928
    ds_read_b64_tr_b16 v[228:229], v2 offset:25600
    ds_read_b64_tr_b16 v[230:231], v2 offset:28800
    ds_read_b64_tr_b16 v[232:233], v2 offset:25632
    ds_read_b64_tr_b16 v[234:235], v2 offset:28832
    ds_read_b64_tr_b16 v[236:237], v2 offset:25664
    ds_read_b64_tr_b16 v[238:239], v2 offset:28864
    ds_read_b64_tr_b16 v[240:241], v2 offset:25696
    ds_read_b64_tr_b16 v[242:243], v2 offset:28896
    ds_read_b64_tr_b16 v[244:245], v2 offset:25728
    ds_read_b64_tr_b16 v[246:247], v2 offset:28928
    s_lshl_b64 s[12:13], 1, s56
    s_waitcnt vmcnt(0)
    s_cmp_lg_u32 s56, 0
    s_cbranch_scc1 L_one_61
    s_mov_b32 s63, 0
    s_mov_b64 exec, 262143
L_fl_62:
    v_cmp_ne_u32 vcc, 1, v15
    s_add_u32 s63, s63, 1
    s_cbranch_vccz L_fd_63
    s_cmp_ge_u32 s63, 200000
    s_cbranch_scc1 L_fd_63
    s_sleep 2
    buffer_load_dword v15, v6, s[44:47], 0 offen sc1
    s_waitcnt vmcnt(0)
    s_branch L_fl_62
L_fd_63:
    s_mov_b64 exec, -1
L_one_61:
    v_mov_b32 v17, 5
    s_mov_b64 exec, s[12:13]
    ds_write_b32 v16, v17
    s_mov_b64 exec, -1
    ds_read_b32 v17, v16
    s_waitcnt lgkmcnt(0)
L_rl_64:
    v_cmp_gt_u32 vcc, 5, v17
    s_and_b32 s63, vcc_lo, s3
    s_cbranch_scc0 L_rd_65
    ds_read_b32 v17, v16
    s_sleep 1
    s_waitcnt lgkmcnt(0)
    s_branch L_rl_64
L_rd_65:
    s_setprio 2
    buffer_load_dwordx4 v[48:51], v7, s[44:47], s4 offen offset:0 sc1
    buffer_load_dwordx4 v[52:55], v7, s[44:47], s4 offen offset:1024 sc1
    buffer_load_dwordx4 v[56:59], v7, s[44:47], s4 offen offset:2048 sc1
    buffer_load_dwordx4 v[60:63], v7, s[44:47], s4 offen offset:3072 sc1
    buffer_load_dwordx2 v[112:113], v8, s[44:47], s8 offen offset:0 sc1
    buffer_load_dwordx2 v[114:115], v8, s[44:47], s8 offen offset:512 sc1
    buffer_load_dwordx4 v[64:67], v7, s[44:47], s5 offen offset:0 sc1
    buffer_load_dwordx4 v[68:71], v7, s[44:47], s5 offen offset:1024 sc1
    buffer_load_dwordx4 v[72:75], v7, s[44:47], s5 offen offset:2048 sc1
    buffer_load_dwordx4 v[76:79], v7, s[44:47], s5 offen offset:3072 sc1
    buffer_load_dwordx2 v[116:117], v8, s[44:47], s8 offen offset:1024 sc1
    buffer_load_dwordx2 v[118:119], v8, s[44:47], s8 offen offset:1536 sc1
L_op_open:
    s_mov_b32 s63, 0
L_op_chk0:
    s_waitcnt vmcnt(6)
    v_max3_u32 v14, v51, v55, v59
    v_max3_u32 v14, v14, v63, v113
    v_max3_u32 v14, v14, v115, v115
    v_cmp_eq_u32 vcc, -1, v14
    s_cbranch_vccnz L_op_slow0
L_op_ok0:
    s_waitcnt lgkmcnt(0)
    v_mfma_f32_16x16x32_bf16 v[28:31], v[128:131], v[48:51], 0
    buffer_load_dwordx4 v[80:83], v7, s[44:47], s6 offen offset:0 sc1
    v_mfma_f32_16x16x32_bf16 v[32:35], v[132:135], v[48:51], 0
    buffer_load_dwordx4 v[84:87], v7, s[44:47], s6 offen offset:1024 sc1
    v_mfma_f32_16x16x32_bf16 v[36:39], v[136:139], v[48:51], 0
    buffer_load_dwordx4 v[88:91], v7, s[44:47], s6 offen offset:2048 sc1
    v_mfma_f32_16x16x32_bf16 v[40:43], v[140:143], v[48:51], 0
    buffer_load_dwordx4 v[92:95], v7, s[44:47], s6 offen offset:3072 sc1
    v_mfma_f32_16x16x32_bf16 v[44:47], v[144:147], v[48:51], 0
    buffer_load_dwordx2 v[120:121], v8, s[44:47], s8 offen offset:2048 sc1
    s_waitcnt lgkmcnt(10)
    v_mfma_f32_16x16x32_bf16 v[28:31], v[148:151], v[52:55], v[28:31]
    buffer_load_dwordx2 v[122:123], v8, s[44:47], s8 offen offset:2560 sc1
    ds_read_b64_tr_b16 v[128:129], v2 offset:32000
    ds_read_b64_tr_b16 v[130:131], v2 offset:35200
    v_mfma_f32_16x16x32_bf16 v[32:35], v[152:155], v[52:55], v[32:35]
    ds_read_b64_tr_b16 v[132:133], v2 offset:32032
    ds_read_b64_tr_b16 v[134:135], v2 offset:35232
    v_mfma_f32_16x16x32_bf16 v[36:39], v[156:159], v[52:55], v[36:39]
    ds_read_b64_tr_b16 v[136:137], v2 offset:32064
    ds_read_b64_tr_b16 v[138:139], v2 offset:35264
    v_mfma_f32_16x16x32_bf16 v[40:43], v[160:163], v[52:55], v[40:43]
    ds_read_b64_tr_b16 v[140:141], v2 offset:32096
    ds_read_b64_tr_b16 v[142:143], v2 offset:35296
    v_mfma_f32_16x16x32_bf16 v[44:47], v[164:167], v[52:55], v[44:47]
    ds_read_b64_tr_b16 v[144:145], v2 offset:32128
    ds_read_b64_tr_b16 v[146:147], v2 offset:35328
    s_waitcnt lgkmcnt(10)
    v_mfma_f32_16x16x32_bf16 v[28:31], v[168:171], v[56:59], v[28:31]
    ds_read_b64_tr_b16 v[148:149], v2 offset:38400
    ds_read_b64_tr_b16 v[150:151], v2 offset:41600
    v_mfma_f32_16x16x32_bf16 v[32:35], v[172:175], v[56:59], v[32:35]
    ds_read_b64_tr_b16 v[152:153], v2 offset:38432
    ds_read_b64_tr_b16 v[154:155], v2 offset:41632
    v_mfma_f32_16x16x32_bf16 v[36:39], v[176:179], v[56:59], v[36:39]
    ds_read_b64_tr_b16 v[156:157], v2 offset:38464
    ds_read_b64_tr_b16 v[158:159], v2 offset:41664
    v_mfma_f32_16x16x32_bf16 v[40:43], v[180:183], v[56:59], v[40:43]
    ds_read_b64_tr_b16 v[160:161], v2 offset:38496
    ds_read_b64_tr_b16 v[162:163], v2 offset:41696
    v_mfma_f32_16x16x32_bf16 v[44:47], v[184:187], v[56:59], v[44:47]
    ds_read_b64_tr_b16 v[164:165], v2 offset:38528
    ds_read_b64_tr_b16 v[166:167], v2 offset:41728
    s_waitcnt lgkmcnt(10)
    v_mfma_f32_16x16x32_bf16 v[28:31], v[188:191], v[60:63], v[28:31]
    ds_read_b64_tr_b16 v[168:169], v2 offset:44800
    ds_read_b64_tr_b16 v[170:171], v2 offset:48000
    v_mfma_f32_16x16x32_bf16 v[32:35], v[192:195], v[60:63], v[32:35]
    ds_read_b64_tr_b16 v[172:173], v2 offset:44832
    ds_read_b64_tr_b16 v[174:175], v2 offset:48032
    v_mfma_f32_16x16x32_bf16 v[36:39], v[196:199], v[60:63], v[36:39]
    ds_read_b64_tr_b16 v[176:177], v2 offset:44864
    ds_read_b64_tr_b16 v[178:179], v2 offset:48064
    v_mfma_f32_16x16x32_bf16 v[40:43], v[200:203], v[60:63], v[40:43]
    ds_read_b64_tr_b16 v[180:181], v2 offset:44896
    ds_read_b64_tr_b16 v[182:183], v2 offset:48096
    v_mfma_f32_16x16x32_bf16 v[44:47], v[204:207], v[60:63], v[44:47]
    ds_read_b64_tr_b16 v[184:185], v2 offset:44928
    ds_read_b64_tr_b16 v[186:187], v2 offset:48128
    s_waitcnt lgkmcnt(10)
    v_mfma_f32_16x16x32_bf16 v[28:31], v[208:211], v[112:115], v[28:31]
    ds_read_b64_tr_b16 v[188:189], v4 offset:25600
    ds_read_b64_tr_b16 v[190:191], v4 offset:38400
    v_mfma_f32_16x16x32_bf16 v[32:35], v[212:215], v[112:115], v[32:35]
    ds_read_b64_tr_b16 v[192:193], v4 offset:25632
    ds_read_b64_tr_b16 v[194:195], v4 offset:38432
    v_mfma_f32_16x16x32_bf16 v[36:39], v[216:219], v[112:115], v[36:39]
    ds_read_b64_tr_b16 v[196:197], v4 offset:25664
    ds_read_b64_tr_b16 v[198:199], v4 offset:38464
    v_mfma_f32_16x16x32_bf16 v[40:43], v[220:223], v[112:115], v[40:43]
    ds_read_b64_tr_b16 v[200:201], v4 offset:25696
    ds_read_b64_tr_b16 v[202:203], v4 offset:38496
    v_mfma_f32_16x16x32_bf16 v[44:47], v[224:227], v[112:115], v[44:47]
    ds_read_b64_tr_b16 v[204:205], v4 offset:25728
    ds_read_b64_tr_b16 v[206:207], v4 offset:38528
L_op_chk1:
    s_waitcnt vmcnt(6)
    v_max3_u32 v14, v67, v71, v75
    v_max3_u32 v14, v14, v79, v117
    v_max3_u32 v14, v14, v119, v119
    v_cmp_eq_u32 vcc, -1, v14
    s_cbranch_vccnz L_op_slow1
L_op_ok1:
    s_waitcnt lgkmcnt(10)
    v_mfma_f32_16x16x32_bf16 v[28:31], v[228:231], v[64:67], v[28:31]
    buffer_load_dwordx4 v[96:99], v7, s[44:47], s7 offen offset:0 sc1
    ds_read_b64_tr_b16 v[208:209], v3 offset:0
    ds_read_b64_tr_b16 v[210:211], v3 offset:3200
    v_mfma_f32_16x16x32_bf16 v[32:35], v[232:235], v[64:67], v[32:35]
    buffer_load_dwordx4 v[100:103], v7, s[44:47], s7 offen offset:1024 sc1
    ds_read_b64_tr_b16 v[212:213], v3 offset:32
    ds_read_b64_tr_b16 v[214:215], v3 offset:3232
    v_mfma_f32_16x16x32_bf16 v[36:39], v[236:239], v[64:67], v[36:39]
    buffer_load_dwordx4 v[104:107], v7, s[44:47], s7 offen offset:2048 sc1
    ds_read_b64_tr_b16 v[216:217], v3 offset:64
    ds_read_b64_tr_b16 v[218:219], v3 offset:3264
    v_mfma_f32_16x16x32_bf16 v[40:43], v[240:243], v[64:67], v[40:43]
    buffer_load_dwordx4 v[108:111], v7, s[44:47], s7 offen offset:3072 sc1
    ds_read_b64_tr_b16 v[220:221], v3 offset:96
    ds_read_b64_tr_b16 v[222:223], v3 offset:3296
    v_mfma_f32_16x16x32_bf16 v[44:47], v[244:247], v[64:67], v[44:47]
    buffer_load_dwordx2 v[124:125], v8, s[44:47], s8 offen offset:3072 sc1
    ds_read_b64_tr_b16 v[224:225], v3 offset:128
    ds_read_b64_tr_b16 v[226:227], v3 offset:3328
    s_waitcnt lgkmcnt(10)
    v_mfma_f32_16x16x32_bf16 v[28:31], v[128:131], v[68:71], v[28:31]
    buffer_load_dwordx2 v[126:127], v8, s[44:47], s8 offen offset:3584 sc1
    ds_read_b64_tr_b16 v[228:229], v3 offset:6400
    ds_read_b64_tr_b16 v[230:231], v3 offset:9600
    v_mfma_f32_16x16x32_bf16 v[32:35], v[132:135], v[68:71], v[32:35]
    ds_read_b64_tr_b16 v[232:233], v3 offset:6432
    ds_read_b64_tr_b16 v[234:235], v3 offset:9632
    v_mfma_f32_16x16x32_bf16 v[36:39], v[136:139], v[68:71], v[36:39]
    ds_read_b64_tr_b16 v[236:237], v3 offset:6464
    ds_read_b64_tr_b16 v[238:239], v3 offset:9664
    v_mfma_f32_16x16x32_bf16 v[40:43], v[140:143], v[68:71], v[40:43]
    ds_read_b64_tr_b16 v[240:241], v3 offset:6496
    ds_read_b64_tr_b16 v[242:243], v3 offset:9696
    v_mfma_f32_16x16x32_bf16 v[44:47], v[144:147], v[68:71], v[44:47]
    ds_read_b64_tr_b16 v[244:245], v3 offset:6528
    ds_read_b64_tr_b16 v[246:247], v3 offset:9728
    s_waitcnt lgkmcnt(10)
    v_mfma_f32_16x16x32_bf16 v[28:31], v[148:151], v[72:75], v[28:31]
    ds_read_b64_tr_b16 v[128:129], v3 offset:12800
    ds_read_b64_tr_b16 v[130:131], v3 offset:16000
    v_mfma_f32_16x16x32_bf16 v[32:35], v[152:155], v[72:75], v[32:35]
    ds_read_b64_tr_b16 v[132:133], v3 offset:12832
    ds_read_b64_tr_b16 v[134:135], v3 offset:16032
    v_mfma_f32_16x16x32_bf16 v[36:39], v[156:159], v[72:75], v[36:39]
    ds_read_b64_tr_b16 v[136:137], v3 offset:12864
    ds_read_b64_tr_b16 v[138:139], v3 offset:16064
    v_mfma_f32_16x16x32_bf16 v[40:43], v[160:163], v[72:75], v[40:43]
    ds_read_b64_tr_b16 v[140:141], v3 offset:12896
    ds_read_b64_tr_b16 v[142:143], v3 offset:16096
    v_mfma_f32_16x16x32_bf16 v[44:47], v[164:167], v[72:75], v[44:47]
    ds_read_b64_tr_b16 v[144:145], v3 offset:12928
    ds_read_b64_tr_b16 v[146:147], v3 offset:16128
    s_waitcnt lgkmcnt(10)
    v_mfma_f32_16x16x32_bf16 v[28:31], v[168:171], v[76:79], v[28:31]
    ds_read_b64_tr_b16 v[148:149], v3 offset:19200
    ds_read_b64_tr_b16 v[150:151], v3 offset:22400
    v_mfma_f32_16x16x32_bf16 v[32:35], v[172:175], v[76:79], v[32:35]
    ds_read_b64_tr_b16 v[152:153], v3 offset:19232
    ds_read_b64_tr_b16 v[154:155], v3 offset:22432
    v_mfma_f32_16x16x32_bf16 v[36:39], v[176:179], v[76:79], v[36:39]
    ds_read_b64_tr_b16 v[156:157], v3 offset:19264
    ds_read_b64_tr_b16 v[158:159], v3 offset:22464
    v_mfma_f32_16x16x32_bf16 v[40:43], v[180:183], v[76:79], v[40:43]
    ds_read_b64_tr_b16 v[160:161], v3 offset:19296
    ds_read_b64_tr_b16 v[162:163], v3 offset:22496
    v_mfma_f32_16x16x32_bf16 v[44:47], v[184:187], v[76:79], v[44:47]
    ds_read_b64_tr_b16 v[164:165], v3 offset:19328
    ds_read_b64_tr_b16 v[166:167], v3 offset:22528
    s_waitcnt lgkmcnt(10)
    v_mfma_f32_16x16x32_bf16 v[28:31], v[188:191], v[116:119], v[28:31]
    ds_read_b64_tr_b16 v[168:169], v5 offset:0
    ds_read_b64_tr_b16 v[170:171], v5 offset:12800
    v_mfma_f32_16x16x32_bf16 v[32:35], v[192:195], v[116:119], v[32:35]
    ds_read_b64_tr_b16 v[172:173], v5 offset:32
    ds_read_b64_tr_b16 v[174:175], v5 offset:12832
    v_mfma_f32_16x16x32_bf16 v[36:39], v[196:199], v[116:119], v[36:39]
    ds_read_b64_tr_b16 v[176:177], v5 offset:64
    ds_read_b64_tr_b16 v[178:179], v5 offset:12864
    v_mfma_f32_16x16x32_bf16 v[40:43], v[200:203], v[116:119], v[40:43]
    ds_read_b64_tr_b16 v[180:181], v5 offset:96
    ds_read_b64_tr_b16 v[182:183], v5 offset:12896
    v_mfma_f32_16x16x32_bf16 v[44:47], v[204:207], v[116:119], v[44:47]
    ds_read_b64_tr_b16 v[184:185], v5 offset:128
    ds_read_b64_tr_b16 v[186:187], v5 offset:12928
L_op_chk2:
    s_waitcnt vmcnt(6)
    v_max3_u32 v14, v83, v87, v91
    v_max3_u32 v14, v14, v95, v121
    v_max3_u32 v14, v14, v123, v123
    v_cmp_eq_u32 vcc, -1, v14
    s_cbranch_vccnz L_op_slow2
L_op_ok2:
    s_waitcnt lgkmcnt(10)
    v_mfma_f32_16x16x32_bf16 v[28:31], v[208:211], v[80:83], v[28:31]
    buffer_load_dwordx4 v[16:19], v9, s[44:47], 0 offen sc1
    ds_read_b64_tr_b16 v[188:189], v3 offset:25600
    ds_read_b64_tr_b16 v[190:191], v3 offset:28800
    v_mfma_f32_16x16x32_bf16 v[32:35], v[212:215], v[80:83], v[32:35]
    buffer_load_dwordx4 v[20:23], v9, s[44:47], s9 offen sc1
    ds_read_b64_tr_b16 v[192:193], v3 offset:25632
    ds_read_b64_tr_b16 v[194:195], v3 offset:28832
    v_mfma_f32_16x16x32_bf16 v[36:39], v[216:219], v[80:83], v[36:39]
    buffer_load_dwordx2 v[24:25], v10, s[44:47], 0 offen sc1
    ds_read_b64_tr_b16 v[196:197], v3 offset:25664
    ds_read_b64_tr_b16 v[198:199], v3 offset:28864
    v_mfma_f32_16x16x32_bf16 v[40:43], v[220:223], v[80:83], v[40:43]
    buffer_load_dword v15, v11, s[44:47], 0 offen sc1
    ds_read_b64_tr_b16 v[200:201], v3 offset:25696
    ds_read_b64_tr_b16 v[202:203], v3 offset:28896
    v_mfma_f32_16x16x32_bf16 v[44:47], v[224:227], v[80:83], v[44:47]
    ds_read_b64_tr_b16 v[204:205], v3 offset:25728
    ds_read_b64_tr_b16 v[206:207], v3 offset:28928
    s_waitcnt lgkmcnt(10)
    v_mfma_f32_16x16x32_bf16 v[28:31], v[228:231], v[84:87], v[28:31]
    ds_read_b64_tr_b16 v[208:209], v3 offset:32000
    ds_read_b64_tr_b16 v[210:211], v3 offset:35200
    v_mfma_f32_16x16x32_bf16 v[32:35], v[232:235], v[84:87], v[32:35]
    ds_read_b64_tr_b16 v[212:213], v3 offset:32032
    ds_read_b64_tr_b16 v[214:215], v3 offset:35232
    v_mfma_f32_16x16x32_bf16 v[36:39], v[236:239], v[84:87], v[36:39]
    ds_read_b64_tr_b16 v[216:217], v3 offset:32064
    ds_read_b64_tr_b16 v[218:219], v3 offset:35264
    v_mfma_f32_16x16x32_bf16 v[40:43], v[240:243], v[84:87], v[40:43]
    ds_read_b64_tr_b16 v[220:221], v3 offset:32096
    ds_read_b64_tr_b16 v[222:223], v3 offset:35296
    v_mfma_f32_16x16x32_bf16 v[44:47], v[244:247], v[84:87], v[44:47]
    ds_read_b64_tr_b16 v[224:225], v3 offset:32128
    ds_read_b64_tr_b16 v[226:227], v3 offset:35328
    s_waitcnt lgkmcnt(10)
    v_mfma_f32_16x16x32_bf16 v[28:31], v[128:131], v[88:91], v[28:31]
    ds_read_b64_tr_b16 v[228:229], v3 offset:38400
    ds_read_b64_tr_b16 v[230:231], v3 offset:41600
    v_mfma_f32_16x16x32_bf16 v[32:35], v[132:135], v[88:91], v[32:35]
    ds_read_b64_tr_b16 v[232:233], v3 offset:38432
    ds_read_b64_tr_b16 v[234:235], v3 offset:41632
    v_mfma_f32_16x16x32_bf16 v[36:39], v[136:139], v[88:91], v[36:39]
    ds_read_b64_tr_b16 v[236:237], v3 offset:38464
    ds_read_b64_tr_b16 v[238:239], v3 offset:41664
    v_mfma_f32_16x16x32_bf16 v[40:43], v[140:143], v[88:91], v[40:43]
    ds_read_b64_tr_b16 v[240:241], v3 offset:38496
    ds_read_b64_tr_b16 v[242:243], v3 offset:41696
    v_mfma_f32_16x16x32_bf16 v[44:47], v[144:147], v[88:91], v[44:47]
    ds_read_b64_tr_b16 v[244:245], v3 offset:38528
    ds_read_b64_tr_b16 v[246:247], v3 offset:41728
    s_waitcnt lgkmcnt(10)
    v_mfma_f32_16x16x32_bf16 v[28:31], v[148:151], v[92:95], v[28:31]
    ds_read_b64_tr_b16 v[128:129], v3 offset:44800
    ds_read_b64_tr_b16 v[130:131], v3 offset:48000
    v_mfma_f32_16x16x32_bf16 v[32:35], v[152:155], v[92:95], v[32:35]
    ds_read_b64_tr_b16 v[132:133], v3 offset:44832
    ds_read_b64_tr_b16 v[134:135], v3 offset:48032
    v_mfma_f32_16x16x32_bf16 v[36:39], v[156:159], v[92:95], v[36:39]
    ds_read_b64_tr_b16 v[136:137], v3 offset:44864
    ds_read_b64_tr_b16 v[138:139], v3 offset:48064
    v_mfma_f32_16x16x32_bf16 v[40:43], v[160:163], v[92:95], v[40:43]
    ds_read_b64_tr_b16 v[140:141], v3 offset:44896
    ds_read_b64_tr_b16 v[142:143], v3 offset:48096
    v_mfma_f32_16x16x32_bf16 v[44:47], v[164:167], v[92:95], v[44:47]
    ds_read_b64_tr_b16 v[144:145], v3 offset:44928
    ds_read_b64_tr_b16 v[146:147], v3 offset:48128
    s_waitcnt lgkmcnt(10)
    v_mfma_f32_16x16x32_bf16 v[28:31], v[168:171], v[120:123], v[28:31]
    ds_read_b64_tr_b16 v[148:149], v5 offset:25600
    ds_read_b64_tr_b16 v[150:151], v5 offset:38400
    v_mfma_f32_16x16x32_bf16 v[32:35], v[172:175], v[120:123], v[32:35]
    ds_read_b64_tr_b16 v[152:153], v5 offset:25632
    ds_read_b64_tr_b16 v[154:155], v5 offset:38432
    v_mfma_f32_16x16x32_bf16 v[36:39], v[176:179], v[120:123], v[36:39]
    ds_read_b64_tr_b16 v[156:157], v5 offset:25664
    ds_read_b64_tr_b16 v[158:159], v5 offset:38464
    v_mfma_f32_16x16x32_bf16 v[40:43], v[180:183], v[120:123], v[40:43]
    ds_read_b64_tr_b16 v[160:161], v5 offset:25696
    ds_read_b64_tr_b16 v[162:163], v5 offset:38496
    v_mfma_f32_16x16x32_bf16 v[44:47], v[184:187], v[120:123], v[44:47]
    ds_read_b64_tr_b16 v[164:165], v5 offset:25728
    ds_read_b64_tr_b16 v[166:167], v5 offset:38528
L_op_chk3:
    s_waitcnt vmcnt(4)
    v_max3_u32 v14, v99, v103, v107
    v_max3_u32 v14, v14, v111, v125
    v_max3_u32 v14, v14, v127, v127
    v_cmp_eq_u32 vcc, -1, v14
    s_cbranch_vccnz L_op_slow3
L_op_ok3:
    s_waitcnt lgkmcnt(10)
    v_mfma_f32_16x16x32_bf16 v[28:31], v[188:191], v[96:99], v[28:31]
    v_mfma_f32_16x16x32_bf16 v[32:35], v[192:195], v[96:99], v[32:35]
    v_mfma_f32_16x16x32_bf16 v[36:39], v[196:199], v[96:99], v[36:39]
    v_mfma_f32_16x16x32_bf16 v[40:43], v[200:203], v[96:99], v[40:43]
    v_mfma_f32_16x16x32_bf16 v[44:47], v[204:207], v[96:99], v[44:47]
    s_waitcnt lgkmcnt(10)
    v_mfma_f32_16x16x32_bf16 v[28:31], v[208:211], v[100:103], v[28:31]
    v_mfma_f32_16x16x32_bf16 v[32:35], v[212:215], v[100:103], v[32:35]
    v_mfma_f32_16x16x32_bf16 v[36:39], v[216:219], v[100:103], v[36:39]
    v_mfma_f32_16x16x32_bf16 v[40:43], v[220:223], v[100:103], v[40:43]
    v_mfma_f32_16x16x32_bf16 v[44:47], v[224:227], v[100:103], v[44:47]
    s_waitcnt lgkmcnt(10)
    v_mfma_f32_16x16x32_bf16 v[28:31], v[228:231], v[104:107], v[28:31]
    v_mfma_f32_16x16x32_bf16 v[32:35], v[232:235], v[104:107], v[32:35]
    v_mfma_f32_16x16x32_bf16 v[36:39], v[236:239], v[104:107], v[36:39]
    v_mfma_f32_16x16x32_bf16 v[40:43], v[240:243], v[104:107], v[40:43]
    v_mfma_f32_16x16x32_bf16 v[44:47], v[244:247], v[104:107], v[44:47]
    s_waitcnt lgkmcnt(10)
    v_mfma_f32_16x16x32_bf16 v[28:31], v[128:131], v[108:111], v[28:31]
    v_mfma_f32_16x16x32_bf16 v[32:35], v[132:135], v[108:111], v[32:35]
    v_mfma_f32_16x16x32_bf16 v[36:39], v[136:139], v[108:111], v[36:39]
    v_mfma_f32_16x16x32_bf16 v[40:43], v[140:143], v[108:111], v[40:43]
    v_mfma_f32_16x16x32_bf16 v[44:47], v[144:147], v[108:111], v[44:47]
    s_waitcnt lgkmcnt(0)
    v_mfma_f32_16x16x32_bf16 v[28:31], v[148:151], v[124:127], v[28:31]
    v_mfma_f32_16x16x32_bf16 v[32:35], v[152:155], v[124:127], v[32:35]
    v_mfma_f32_16x16x32_bf16 v[36:39], v[156:159], v[124:127], v[36:39]
    v_mfma_f32_16x16x32_bf16 v[40:43], v[160:163], v[124:127], v[40:43]
    v_mfma_f32_16x16x32_bf16 v[44:47], v[164:167], v[124:127], v[44:47]
L_op_chk4:
    s_waitcnt vmcnt(0)
    v_max3_u32 v14, v19, v23, v25
    v_max3_u32 v14, v14, v15, v15
    v_cmp_eq_u32 vcc, -1, v14
    s_cbranch_vccnz L_op_slow4
L_op_ok4:
    v_lshlrev_b32 v48, 16, v16
    v_and_b32 v49, 0xffff0000, v16
    v_lshlrev_b32 v50, 16, v17
    v_and_b32 v51, 0xffff0000, v17
    v_lshlrev_b32 v52, 16, v18
    v_and_b32 v53, 0xffff0000, v18
    v_lshlrev_b32 v54, 16, v19
    v_and_b32 v55, 0xffff0000, v19
    v_lshlrev_b32 v56, 16, v20
    v_and_b32 v57, 0xffff0000, v20
    v_lshlrev_b32 v58, 16, v21
    v_and_b32 v59, 0xffff0000, v21
    v_lshlrev_b32 v60, 16, v22
    v_and_b32 v61, 0xffff0000, v22
    v_lshlrev_b32 v62, 16, v23
    v_and_b32 v63, 0xffff0000, v23
    v_lshlrev_b32 v64, 16, v24
    v_and_b32 v65, 0xffff0000, v24
    v_lshlrev_b32 v66, 16, v25
    v_and_b32 v67, 0xffff0000, v25
    v_permlane16_swap_b32 v28, v32
    v_permlane16_swap_b32 v29, v33
    v_permlane16_swap_b32 v30, v34
    v_permlane16_swap_b32 v31, v35
    v_permlane16_swap_b32 v36, v40
    v_permlane16_swap_b32 v37, v41
    v_permlane16_swap_b32 v38, v42
    v_permlane16_swap_b32 v39, v43
    v_sub_f32 v28, v28, v48
    v_sub_f32 v29, v29, v49
    v_sub_f32 v30, v30, v50
    v_sub_f32 v31, v31, v51
    v_sub_f32 v32, v32, v52
    v_sub_f32 v33, v33, v53
    v_sub_f32 v34, v34, v54
    v_sub_f32 v35, v35, v55
    v_sub_f32 v36, v36, v56
    v_sub_f32 v37, v37, v57
    v_sub_f32 v38, v38, v58
    v_sub_f32 v39, v39, v59
    v_sub_f32 v40, v40, v60
    v_sub_f32 v41, v41, v61
    v_sub_f32 v42, v42, v62
    v_sub_f32 v43, v43, v63
    v_sub_f32 v44, v44, v64
    v_sub_f32 v45, v45, v65
    v_sub_f32 v46, v46, v66
    v_sub_f32 v47, v47, v67
    v_fma_f32 v28, v28, v15, v48
    v_fma_f32 v29, v29, v15, v49
    v_fma_f32 v30, v30, v15, v50
    v_fma_f32 v31, v31, v15, v51
    v_fma_f32 v32, v32, v15, v52
    v_fma_f32 v33, v33, v15, v53
    v_fma_f32 v34, v34, v15, v54
    v_fma_f32 v35, v35, v15, v55
    v_fma_f32 v36, v36, v15, v56
    v_fma_f32 v37, v37, v15, v57
    v_fma_f32 v38, v38, v15, v58
    v_fma_f32 v39, v39, v15, v59
    v_fma_f32 v40, v40, v15, v60
    v_fma_f32 v41, v41, v15, v61
    v_fma_f32 v42, v42, v15, v62
    v_fma_f32 v43, v43, v15, v63
    v_fma_f32 v44, v44, v15, v64
    v_fma_f32 v45, v45, v15, v65
    v_fma_f32 v46, v46, v15, v66
    v_fma_f32 v47, v47, v15, v67
    v_cvt_pk_bf16_f32 v16, v28, v29
    v_cvt_pk_bf16_f32 v17, v30, v31
    v_cvt_pk_bf16_f32 v18, v32, v33
    v_cvt_pk_bf16_f32 v19, v34, v35
    v_cvt_pk_bf16_f32 v20, v36, v37
    v_cvt_pk_bf16_f32 v21, v38, v39
    v_cvt_pk_bf16_f32 v22, v40, v41
    v_cvt_pk_bf16_f32 v23, v42, v43
    v_cvt_pk_bf16_f32 v24, v44, v45
    v_cvt_pk_bf16_f32 v25, v46, v47
    buffer_store_dwordx4 v[16:19], v12, s[52:55], 0 offen
    buffer_store_dwordx4 v[20:23], v12, s[52:55], 0 offen offset:64
    buffer_store_dwordx2 v[24:25], v13, s[52:55], 0 offen
    s_branch L_end
L_op_slow0:
    s_waitcnt vmcnt(0)
    s_add_u32 s63, s63, 1
    s_cmp_ge_u32 s63, 200000
    s_cbranch_scc1 L_op_ok0
    v_cmp_eq_u32_e64 s[12:13], -1, v51
    v_cmp_eq_u32_e64 s[14:15], -1, v55
    v_cmp_eq_u32_e64 s[16:17], -1, v59
    v_cmp_eq_u32_e64 s[18:19], -1, v63
    v_cmp_eq_u32_e64 s[20:21], -1, v113
    v_cmp_eq_u32_e64 s[22:23], -1, v115
    v_cmp_eq_u32_e64 s[24:25], -1, v67
    v_cmp_eq_u32_e64 s[26:27], -1, v71
    v_cmp_eq_u32_e64 s[28:29], -1, v75
    v_cmp_eq_u32_e64 s[30:31], -1, v79
    s_mov_b64 exec, s[12:13]
    buffer_load_dwordx4 v[48:51], v7, s[44:47], s4 offen offset:0 sc1
    s_mov_b64 exec, s[14:15]
    buffer_load_dwordx4 v[52:55], v7, s[44:47], s4 offen offset:1024 sc1
    s_mov_b64 exec, s[16:17]
    buffer_load_dwordx4 v[56:59], v7, s[44:47], s4 offen offset:2048 sc1
    s_mov_b64 exec, s[18:19]
    buffer_load_dwordx4 v[60:63], v7, s[44:47], s4 offen offset:3072 sc1
    s_mov_b64 exec, s[20:21]
    buffer_load_dwordx2 v[112:113], v8, s[44:47], s8 offen offset:0 sc1
    s_mov_b64 exec, s[22:23]
    buffer_load_dwordx2 v[114:115], v8, s[44:47], s8 offen offset:512 sc1
    s_mov_b64 exec, s[24:25]
    buffer_load_dwordx4 v[64:67], v7, s[44:47], s5 offen offset:0 sc1
    s_mov_b64 exec, s[26:27]
    buffer_load_dwordx4 v[68:71], v7, s[44:47], s5 offen offset:1024 sc1
    s_mov_b64 exec, s[28:29]
    buffer_load_dwordx4 v[72:75], v7, s[44:47], s5 offen offset:2048 sc1
    s_mov_b64 exec, s[30:31]
    buffer_load_dwordx4 v[76:79], v7, s[44:47], s5 offen offset:3072 sc1
    s_mov_b64 exec, -1
    v_cmp_eq_u32_e64 s[12:13], -1, v117
    v_cmp_eq_u32_e64 s[14:15], -1, v119
    s_mov_b64 exec, s[12:13]
    buffer_load_dwordx2 v[116:117], v8, s[44:47], s8 offen offset:1024 sc1
    s_mov_b64 exec, s[14:15]
    buffer_load_dwordx2 v[118:119], v8, s[44:47], s8 offen offset:1536 sc1
    s_mov_b64 exec, -1
    s_waitcnt vmcnt(0)
    s_branch L_op_chk0
L_op_slow1:
    s_waitcnt vmcnt(0)
    s_add_u32 s63, s63, 1
    s_cmp_ge_u32 s63, 200000
    s_cbranch_scc1 L_op_ok1
    v_cmp_eq_u32_e64 s[12:13], -1, v67
    v_cmp_eq_u32_e64 s[14:15], -1, v71
    v_cmp_eq_u32_e64 s[16:17], -1, v75
    v_cmp_eq_u32_e64 s[18:19], -1, v79
    v_cmp_eq_u32_e64 s[20:21], -1, v117
    v_cmp_eq_u32_e64 s[22:23], -1, v119
    v_cmp_eq_u32_e64 s[24:25], -1, v83
    v_cmp_eq_u32_e64 s[26:27], -1, v87
    v_cmp_eq_u32_e64 s[28:29], -1, v91
    v_cmp_eq_u32_e64 s[30:31], -1, v95
    s_mov_b64 exec, s[12:13]
    buffer_load_dwordx4 v[64:67], v7, s[44:47], s5 offen offset:0 sc1
    s_mov_b64 exec, s[14:15]
    buffer_load_dwordx4 v[68:71], v7, s[44:47], s5 offen offset:1024 sc1
    s_mov_b64 exec, s[16:17]
    buffer_load_dwordx4 v[72:75], v7, s[44:47], s5 offen offset:2048 sc1
    s_mov_b64 exec, s[18:19]
    buffer_load_dwordx4 v[76:79], v7, s[44:47], s5 offen offset:3072 sc1
    s_mov_b64 exec, s[20:21]
    buffer_load_dwordx2 v[116:117], v8, s[44:47], s8 offen offset:1024 sc1
    s_mov_b64 exec, s[22:23]
    buffer_load_dwordx2 v[118:119], v8, s[44:47], s8 offen offset:1536 sc1
    s_mov_b64 exec, s[24:25]
    buffer_load_dwordx4 v[80:83], v7, s[44:47], s6 offen offset:0 sc1
    s_mov_b64 exec, s[26:27]
    buffer_load_dwordx4 v[84:87], v7, s[44:47], s6 offen offset:1024 sc1
    s_mov_b64 exec, s[28:29]
    buffer_load_dwordx4 v[88:91], v7, s[44:47], s6 offen offset:2048 sc1
    s_mov_b64 exec, s[30:31]
    buffer_load_dwordx4 v[92:95], v7, s[44:47], s6 offen offset:3072 sc1
    s_mov_b64 exec, -1
    v_cmp_eq_u32_e64 s[12:13], -1, v121
    v_cmp_eq_u32_e64 s[14:15], -1, v123
    s_mov_b64 exec, s[12:13]
    buffer_load_dwordx2 v[120:121], v8, s[44:47], s8 offen offset:2048 sc1
    s_mov_b64 exec, s[14:15]
    buffer_load_dwordx2 v[122:123], v8, s[44:47], s8 offen offset:2560 sc1
    s_mov_b64 exec, -1
    s_waitcnt vmcnt(0)
    s_branch L_op_chk1
L_op_slow2:
    s_waitcnt vmcnt(0)
    s_add_u32 s63, s63, 1
    s_cmp_ge_u32 s63, 200000
    s_cbranch_scc1 L_op_ok2
    v_cmp_eq_u32_e64 s[12:13], -1, v83
    v_cmp_eq_u32_e64 s[14:15], -1, v87
    v_cmp_eq_u32_e64 s[16:17], -1, v91
    v_cmp_eq_u32_e64 s[18:19], -1, v95
    v_cmp_eq_u32_e64 s[20:21], -1, v121
    v_cmp_eq_u32_e64 s[22:23], -1, v123
    v_cmp_eq_u32_e64 s[24:25], -1, v99
    v_cmp_eq_u32_e64 s[26:27], -1, v103
    v_cmp_eq_u32_e64 s[28:29], -1, v107
    v_cmp_eq_u32_e64 s[30:31], -1, v111
    s_mov_b64 exec, s[12:13]
    buffer_load_dwordx4 v[80:83], v7, s[44:47], s6 offen offset:0 sc1
    s_mov_b64 exec, s[14:15]
    buffer_load_dwordx4 v[84:87], v7, s[44:47], s6 offen offset:1024 sc1
    s_mov_b64 exec, s[16:17]
    buffer_load_dwordx4 v[88:91], v7, s[44:47], s6 offen offset:2048 sc1
    s_mov_b64 exec, s[18:19]
    buffer_load_dwordx4 v[92:95], v7, s[44:47], s6 offen offset:3072 sc1
    s_mov_b64 exec, s[20:21]
    buffer_load_dwordx2 v[120:121], v8, s[44:47], s8 offen offset:2048 sc1
    s_mov_b64 exec, s[22:23]
    buffer_load_dwordx2 v[122:123], v8, s[44:47], s8 offen offset:2560 sc1
    s_mov_b64 exec, s[24:25]
    buffer_load_dwordx4 v[96:99], v7, s[44:47], s7 offen offset:0 sc1
    s_mov_b64 exec, s[26:27]
    buffer_load_dwordx4 v[100:103], v7, s[44:47], s7 offen offset:1024 sc1
    s_mov_b64 exec, s[28:29]
    buffer_load_dwordx4 v[104:107], v7, s[44:47], s7 offen offset:2048 sc1
    s_mov_b64 exec, s[30:31]
    buffer_load_dwordx4 v[108:111], v7, s[44:47], s7 offen offset:3072 sc1
    s_mov_b64 exec, -1
    v_cmp_eq_u32_e64 s[12:13], -1, v125
    v_cmp_eq_u32_e64 s[14:15], -1, v127
    s_mov_b64 exec, s[12:13]
    buffer_load_dwordx2 v[124:125], v8, s[44:47], s8 offen offset:3072 sc1
    s_mov_b64 exec, s[14:15]
    buffer_load_dwordx2 v[126:127], v8, s[44:47], s8 offen offset:3584 sc1
    s_mov_b64 exec, -1
    s_waitcnt vmcnt(0)
    s_branch L_op_chk2
L_op_slow3:
    s_waitcnt vmcnt(0)
    s_add_u32 s63, s63, 1
    s_cmp_ge_u32 s63, 200000
    s_cbranch_scc1 L_op_ok3
    v_cmp_eq_u32_e64 s[12:13], -1, v99
    v_cmp_eq_u32_e64 s[14:15], -1, v103
    v_cmp_eq_u32_e64 s[16:17], -1, v107
    v_cmp_eq_u32_e64 s[18:19], -1, v111
    v_cmp_eq_u32_e64 s[20:21], -1, v125
    v_cmp_eq_u32_e64 s[22:23], -1, v127
    v_cmp_eq_u32_e64 s[24:25], -1, v19
    v_cmp_eq_u32_e64 s[26:27], -1, v23
    v_cmp_eq_u32_e64 s[28:29], -1, v25
    v_cmp_eq_u32_e64 s[30:31], -1, v15
    s_mov_b64 exec, s[12:13]
    buffer_load_dwordx4 v[96:99], v7, s[44:47], s7 offen offset:0 sc1
    s_mov_b64 exec, s[14:15]
    buffer_load_dwordx4 v[100:103], v7, s[44:47], s7 offen offset:1024 sc1
    s_mov_b64 exec, s[16:17]
    buffer_load_dwordx4 v[104:107], v7, s[44:47], s7 offen offset:2048 sc1
    s_mov_b64 exec, s[18:19]
    buffer_load_dwordx4 v[108:111], v7, s[44:47], s7 offen offset:3072 sc1
    s_mov_b64 exec, s[20:21]
    buffer_load_dwordx2 v[124:125], v8, s[44:47], s8 offen offset:3072 sc1
    s_mov_b64 exec, s[22:23]
    buffer_load_dwordx2 v[126:127], v8, s[44:47], s8 offen offset:3584 sc1
    s_mov_b64 exec, s[24:25]
    buffer_load_dwordx4 v[16:19], v9, s[44:47], 0 offen sc1
    s_mov_b64 exec, s[26:27]
    buffer_load_dwordx4 v[20:23], v9, s[44:47], s9 offen sc1
    s_mov_b64 exec, s[28:29]
    buffer_load_dwordx2 v[24:25], v10, s[44:47], 0 offen sc1
    s_mov_b64 exec, s[30:31]
    buffer_load_dword v15, v11, s[44:47], 0 offen sc1
    s_mov_b64 exec, -1
    s_waitcnt vmcnt(0)
    s_branch L_op_chk3
L_op_slow4:
    s_waitcnt vmcnt(0)
    s_add_u32 s63, s63, 1
    s_cmp_ge_u32 s63, 200000
    s_cbranch_scc1 L_op_ok4
    v_cmp_eq_u32_e64 s[12:13], -1, v19
    v_cmp_eq_u32_e64 s[14:15], -1, v23
    v_cmp_eq_u32_e64 s[16:17], -1, v25
    v_cmp_eq_u32_e64 s[18:19], -1, v15
    s_mov_b64 exec, s[12:13]
    buffer_load_dwordx4 v[16:19], v9, s[44:47], 0 offen sc1
    s_mov_b64 exec, s[14:15]
    buffer_load_dwordx4 v[20:23], v9, s[44:47], s9 offen sc1
    s_mov_b64 exec, s[16:17]
    buffer_load_dwordx2 v[24:25], v10, s[44:47], 0 offen sc1
    s_mov_b64 exec, s[18:19]
    buffer_load_dword v15, v11, s[44:47], 0 offen sc1
    s_mov_b64 exec, -1
    s_waitcnt vmcnt(0)
    s_branch L_op_chk4
L_end:
    s_endpgm
L_exit:
    s_endpgm

.section .rodata,"a"
.p2align 6
.amdhsa_kernel gated_mix__linear_attn_block__ssm_conv_s4d__prompt_kernel
  .amdhsa_next_free_vgpr 256
  .amdhsa_next_free_sgpr 102
  .amdhsa_accum_offset 256
  .amdhsa_group_segment_fixed_size 0
  .amdhsa_kernarg_size 112
  .amdhsa_user_sgpr_count 2
  .amdhsa_user_sgpr_kernarg_segment_ptr 1
  .amdhsa_system_sgpr_workgroup_id_x 1
  .amdhsa_float_denorm_mode_32 3
.end_amdhsa_kernel
```
